```python
import torch

def _softmax(x, axis=-1):
    return torch.softmax(x, dim=axis)
def _gelu(x):
    return torch.nn.functional.gelu(x, approximate="tanh")
def _silu(x):
    return torch.nn.functional.silu(x)
def _sigmoid(x):
    return torch.sigmoid(x)
def _layernorm(x, axis=-1, eps=1e-5):
    m = x.mean(dim=axis, keepdim=True)
    v = x.var(dim=axis, keepdim=True, unbiased=False)
    return (x - m) / torch.sqrt(v + eps)
def _scatter_add(tgt, idx, src, axis=0):
    return tgt.clone().index_add_(axis, idx, src)
def _segment_sum(src, seg, n):
    out = torch.zeros((n,) + src.shape[1:], dtype=src.dtype)
    return out.index_add_(0, seg, src)
def _pad(x, pw):
    flat = tuple(v for pair in reversed(pw) for v in pair)
    return torch.nn.functional.pad(x, flat)

kernel_name = 'concat_heads__gqa_block_cached__mha_block_cached__near_ridge'

def setup_inputs():

    _w = (lambda a: (lambda t: t.to(torch.bfloat16) if t.is_floating_point() else t)(torch.as_tensor(a)))
    def _A_setup():
        B, Sq, D = 8, 64, 512
        Hq, Hkv, Sk, Dh = 32, 8, 1024, 128
        assert Hq % Hkv == 0, (Hq, Hkv)
        return {
            "x": _w((lambda *s: torch.randn(*s, dtype=torch.bfloat16) * 0.8)(B, Sq, D)),
            "k_cache": _w((lambda *s: torch.randn(*s, dtype=torch.bfloat16) * 0.8)(B, Hkv, Sk, Dh)),
            "v_cache": _w((lambda *s: torch.randn(*s, dtype=torch.bfloat16) * 0.05)(B, Hkv, Sk, Dh)),
            "wq": _w((lambda *s: torch.randn(*s, dtype=torch.bfloat16) * 0.8)(D, Hq * Dh) * (D ** -0.5)),
            "wo": _w((lambda *s: torch.randn(*s, dtype=torch.bfloat16) * 0.05)(Hq * Dh, D) * ((Hq * Dh) ** -0.5)),
        }
    _A_in = _A_setup()

    def _B_setup():
        B, Sq, D = 8, 64, 512
        H, Sk, Dh = 32, 1024, 128
        return {
            "x": _w((lambda *s: torch.randn(*s, dtype=torch.bfloat16) * 0.8)(B, Sq, D)),
            "k_cache": _w((lambda *s: torch.randn(*s, dtype=torch.bfloat16) * 0.8)(B, H, Sk, Dh)),
            "v_cache": _w((lambda *s: torch.randn(*s, dtype=torch.bfloat16) * 0.05)(B, H, Sk, Dh)),
            "wq": _w((lambda *s: torch.randn(*s, dtype=torch.bfloat16) * 0.8)(D, H * Dh) * (D ** -0.5)),
            "wo": _w((lambda *s: torch.randn(*s, dtype=torch.bfloat16) * 0.05)(H * Dh, D) * ((H * Dh) ** -0.5)),
        }
    _B_in = _B_setup()

    return {
        "A_x": _A_in["x"],
        "A_k_cache": _A_in["k_cache"],
        "A_v_cache": _A_in["v_cache"],
        "A_wq": _A_in["wq"],
        "A_wo": _A_in["wo"],
        "B_x": _B_in["x"],
        "B_k_cache": _B_in["k_cache"],
        "B_v_cache": _B_in["v_cache"],
        "B_wq": _B_in["wq"],
        "B_wo": _B_in["wo"],
    }

def reference(A_x, A_k_cache, A_v_cache, A_wq, A_wo, B_x, B_k_cache, B_v_cache, B_wq, B_wo):
    def _A_ref(x, k_cache, v_cache, wq, wo):
        B, Sq, D = x.shape
        Hq, Dh = 32, 128
        Hkv = k_cache.shape[1]
        rep = Hq // Hkv
        q = (lambda x, *d: x.permute(*d))((x @ wq).reshape(B, Sq, Hq, Dh), 0, 2, 1, 3)
        k = (lambda x, n, axis: torch.repeat_interleave(x, n, dim=axis))(k_cache, rep, axis=1)
        v = (lambda x, n, axis: torch.repeat_interleave(x, n, dim=axis))(v_cache, rep, axis=1)
        scores = torch.einsum("bhqd,bhkd->bhqk", q, k) * (Dh ** -0.5)
        p = _softmax(scores, axis=-1)
        o = torch.einsum("bhqk,bhkd->bhqd", p, v)
        return (lambda x, *d: x.permute(*d))(o, 0, 2, 1, 3).reshape(B, Sq, Hq * Dh) @ wo

    def _B_ref(x, k_cache, v_cache, wq, wo):
        B, Sq, D = x.shape
        H, Dh = 32, 128
        q = (lambda x, *d: x.permute(*d))((x @ wq).reshape(B, Sq, H, Dh), 0, 2, 1, 3)
        scores = torch.einsum("bhqd,bhkd->bhqk", q, k_cache) * (Dh ** -0.5)
        p = _softmax(scores, axis=-1)
        o = torch.einsum("bhqk,bhkd->bhqd", p, v_cache)
        return (lambda x, *d: x.permute(*d))(o, 0, 2, 1, 3).reshape(B, Sq, H * Dh) @ wo

    a = _A_ref(A_x, A_k_cache, A_v_cache, A_wq, A_wo)
    b = _B_ref(B_x, B_k_cache, B_v_cache, B_wq, B_wo)
    return torch.concatenate([a, b], axis=-1)
```

```asm
; @launch grid=(256,1,1) block=(256,1,1) lds=163840
.amdgcn_target "amdgcn-amd-amdhsa--gfx950"
.text
.globl concat_heads__gqa_block_cached__mha_block_cached__near_ridge_kernel
.p2align 8
.type concat_heads__gqa_block_cached__mha_block_cached__near_ridge_kernel,@function
concat_heads__gqa_block_cached__mha_block_cached__near_ridge_kernel:
    s_cmp_ge_u32 s2, 256
    s_cbranch_scc1 L_end1
    s_load_dwordx16 s[48:63], s[0:1], 0
    s_load_dwordx2 s[64:65], s[0:1], 64
    s_load_dwordx2 s[66:67], s[0:1], 96
    s_load_dwordx2 s[86:87], s[0:1], 72
    s_load_dwordx2 s[72:73], s[0:1], 80
    s_load_dwordx2 s[68:69], s[0:1], 88
    s_memrealtime s[90:91]
    v_lshrrev_b32 v1, 6, v0
    v_and_b32 v0, 63, v0
    v_readfirstlane_b32 s24, v1
    s_and_b32 s3, s2, 7
    s_lshr_b32 s45, s2, 3
    s_cmp_ge_u32 s45, 16
    s_cselect_b32 s25, 1, 0
    s_mov_b32 s31, 0x3e0293ee
    s_mov_b32 s42, 0x41000000
    s_lshr_b32 s46, s24, 1
    s_and_b32 s47, s24, 1
    s_lshl_b32 s28, s24, 15
    s_lshl_b32 s80, s24, 11
    s_waitcnt lgkmcnt(0)
    s_cmp_eq_u32 s25, 1
    s_cbranch_scc1 L_setupA
    s_and_b32 s76, s45, 3
    s_lshl_b32 s77, s3, 2
    s_add_u32 s76, s76, s77
    s_lshr_b32 s77, s45, 2
    s_lshl_b32 s79, s46, 2
    s_add_u32 s79, s79, s77
    s_lshl_b32 s78, s79, 5
    s_add_u32 s78, s78, s76
    s_lshl_b32 s78, s78, 18
    s_add_u32 s4, s60, s78
    s_addc_u32 s5, s61, 0
    s_add_u32 s8, s62, s78
    s_addc_u32 s9, s63, 0
    s_mov_b32 s12, s58
    s_mov_b32 s13, s59
    s_mov_b32 s16, s64
    s_mov_b32 s17, s65
    s_lshl_b32 s29, s77, 16
    s_lshl_b32 s82, s77, 1
    s_and_b32 s83, s45, 3
    s_add_u32 s82, s82, s83
    s_and_b32 s82, s82, 7
    s_lshl_b32 s30, s76, 8
    s_add_u32 s89, s79, 8
    s_lshl_b32 s89, s89, 5
    s_add_u32 s89, s89, s76
    s_branch L_setup_done
L_setupA:
    s_sub_u32 s45, s45, 16
    s_lshr_b32 s77, s45, 1
    s_and_b32 s76, s45, 1
    s_lshl_b32 s76, s76, 1
    s_lshl_b32 s78, s3, 2
    s_add_u32 s76, s76, s78
    s_lshl_b32 s78, s77, 3
    s_add_u32 s78, s78, s3
    s_lshl_b32 s78, s78, 18
    s_add_u32 s4, s50, s78
    s_addc_u32 s5, s51, 0
    s_add_u32 s8, s52, s78
    s_addc_u32 s9, s53, 0
    s_mov_b32 s12, s48
    s_mov_b32 s13, s49
    s_mov_b32 s16, s54
    s_mov_b32 s17, s55
    s_lshl_b32 s29, s77, 16
    s_lshl_b32 s30, s76, 8
    s_and_b32 s82, s45, 1
    s_lshl_b32 s82, s82, 2
    s_add_u32 s82, s82, s77
    s_and_b32 s82, s82, 7
    s_lshl_b32 s89, s77, 5
    s_add_u32 s89, s89, s76
    s_add_u32 s89, s89, s46
L_setup_done:
    s_lshl_b32 s89, s89, 1
    s_add_u32 s89, s89, s47
    s_lshl_b32 s44, s89, 13
    s_lshl_b32 s89, s89, 3
    s_add_u32 s89, s89, 25165824
    s_mov_b32 s64, s86
    s_mov_b32 s65, s87
    s_mov_b32 s70, 256
    s_mov_b32 s71, 0x00020000
    s_mov_b32 s74, 1048576
    s_mov_b32 s75, 0x00020000
    s_or_b32 s37, s24, s2
    s_cbranch_scc1 L_nononce
    s_or_b32 s90, s90, 1
    v_mov_b32 v244, s90
    v_mov_b32 v245, s91
    v_mov_b32 v248, 0
    s_mov_b64 exec, 1
    buffer_store_dwordx2 v[244:245], v248, s[68:71], 0 offen sc1
    s_mov_b64 exec, -1
L_nononce:
    s_mov_b32 s6, 262144
    s_mov_b32 s10, 262144
    s_mov_b32 s7, 0x00020000
    s_mov_b32 s11, 0x00020000
    s_mov_b32 s14, 524288
    s_mov_b32 s15, 0x00020000
    s_mov_b32 s18, 4194304
    s_mov_b32 s19, 0x00020000
    s_mov_b32 s20, s66
    s_mov_b32 s21, s67
    s_mov_b32 s22, 26214400
    s_mov_b32 s23, 0x00020000
    s_lshl_b32 s26, s47, 13
    v_lshlrev_b32 v27, 4, v0
    v_lshrrev_b32 v40, 4, v0
    v_and_b32 v41, 15, v0
    v_lshlrev_b32 v42, 2, v40
    v_xor_b32 v42, v42, v41
    v_lshlrev_b32 v42, 4, v42
    v_lshl_add_u32 v5, v40, 8, v42
    v_xor_b32 v6, 16, v5
    v_xor_b32 v7, 32, v5
    v_xor_b32 v8, 48, v5
    v_and_b32 v43, 3, v41
    v_lshlrev_b32 v43, 2, v43
    v_lshrrev_b32 v44, 2, v41
    v_or_b32 v43, v43, v44
    v_lshrrev_b32 v44, 5, v0
    v_xor_b32 v45, v44, v43
    v_lshlrev_b32 v45, 4, v45
    v_and_b32 v46, 31, v0
    v_lshl_add_u32 v28, v46, 8, v45
    v_add_u32 v224, s28, v28
    v_xor_b32 v225, 32, v224
    v_xor_b32 v226, 64, v224
    v_xor_b32 v227, 96, v224
    v_xor_b32 v228, 128, v224
    v_xor_b32 v229, 160, v224
    v_xor_b32 v230, 192, v224
    v_xor_b32 v231, 224, v224
    v_lshlrev_b32 v26, 13, v46
    v_lshl_add_u32 v26, v44, 4, v26
    s_lshl_b32 s37, s47, 7
    v_add_u32 v26, s37, v26
    v_lshrrev_b32 v45, 2, v41
    v_and_b32 v46, 1, v40
    v_and_b32 v47, 1, v41
    v_lshl_add_u32 v47, v46, 1, v47
    v_xor_b32 v47, v47, v44
    v_lshl_add_u32 v47, v45, 2, v47
    v_lshlrev_b32 v47, 4, v47
    v_bfe_u32 v46, v41, 1, 1
    v_lshl_add_u32 v47, v46, 3, v47
    v_lshl_add_u32 v45, v44, 2, v45
    v_lshl_add_u32 v47, v45, 8, v47
    v_add_u32 v232, s28, v47
    v_xor_b32 v233, 32, v232
    v_xor_b32 v234, 64, v232
    v_xor_b32 v235, 96, v232
    v_xor_b32 v236, 128, v232
    v_xor_b32 v237, 160, v232
    v_xor_b32 v238, 192, v232
    v_xor_b32 v239, 224, v232
    v_lshrrev_b32 v44, 4, v0
    v_and_b32 v45, 7, v0
    v_xor_b32 v45, v45, v44
    v_lshlrev_b32 v45, 4, v45
    v_lshrrev_b32 v44, 3, v0
    s_lshl_b32 s37, s24, 4
    v_add_u32 v44, s37, v44
    s_mov_b32 s37, 1024
    v_mul_lo_u32 v44, v44, s37
    v_add_u32 v32, v44, v45
    v_xor_b32 v45, 64, v45
    v_add_u32 v33, v44, v45
    v_add_u32 v33, 7168, v33
    v_lshrrev_b32 v44, 4, v0
    v_and_b32 v45, 15, v0
    v_lshlrev_b32 v34, 2, v44
    v_xor_b32 v45, v45, v34
    s_lshl_b32 s37, s24, 1
    s_and_b32 s37, s37, 3
    v_xor_b32 v45, s37, v45
    v_lshlrev_b32 v45, 4, v45
    s_lshl_b32 s37, s24, 3
    v_add_u32 v44, s37, v44
    s_mov_b32 s37, 8192
    v_mul_lo_u32 v44, v44, s37
    v_add_u32 v34, v44, v45
    v_xor_b32 v45, 16, v45
    v_add_u32 v35, v44, v45
    v_add_u32 v35, 31744, v35
    v_bfe_u32 v44, v0, 1, 3
    v_lshrrev_b32 v45, 5, v0
    v_xor_b32 v44, v44, v45
    v_lshlrev_b32 v44, 4, v44
    v_and_b32 v45, 31, v0
    v_lshl_add_u32 v36, v45, 7, v44
    v_xor_b32 v37, 32, v36
    v_xor_b32 v38, 64, v36
    v_xor_b32 v39, 96, v36
    v_bfe_u32 v44, v0, 4, 1
    v_and_b32 v45, 1, v0
    v_lshl_add_u32 v44, v44, 1, v45
    v_lshrrev_b32 v45, 5, v0
    v_lshlrev_b32 v41, 1, v45
    v_xor_b32 v44, v44, v41
    v_bfe_u32 v41, v0, 2, 2
    v_lshl_add_u32 v44, v41, 2, v44
    v_lshlrev_b32 v44, 4, v44
    v_lshl_add_u32 v45, v45, 3, v41
    v_lshl_add_u32 v44, v45, 8, v44
    v_bfe_u32 v45, v0, 1, 1
    v_lshl_add_u32 v44, v45, 3, v44
    s_lshl_b32 s37, s47, 7
    v_xor_b32 v40, s37, v44
    v_xor_b32 v41, 16, v40
    v_xor_b32 v42, 64, v40
    v_xor_b32 v43, 80, v40
    s_cmp_eq_u32 s25, 1
    s_cbranch_scc1 L_typeA
    s_lshl_b32 s83, s82, 7
    s_add_u32 s83, s83, s29
    s_mul_i32 s84, s82, 524288
    s_add_u32 s84, s84, s30
    s_add_u32 s82, s82, 1
    s_and_b32 s82, s82, 7
    s_add_u32 m0, s80, 0
    s_add_u32 s37, s83, 0
    buffer_load_dwordx4 v32, s[12:15], s37 offen lds
    buffer_load_dwordx4 v33, s[12:15], s37 offen offset:1024 lds
    s_add_u32 m0, s80, 32768
    s_add_u32 s37, s83, 262144
    buffer_load_dwordx4 v32, s[12:15], s37 offen lds
    buffer_load_dwordx4 v33, s[12:15], s37 offen offset:1024 lds
    s_add_u32 m0, s80, 65536
    s_add_u32 s37, s84, 0
    buffer_load_dwordx4 v34, s[16:19], s37 offen lds
    buffer_load_dwordx4 v35, s[16:19], s37 offen offset:1024 lds
    s_add_u32 m0, s80, 98304
    s_add_u32 s37, s84, 262144
    buffer_load_dwordx4 v34, s[16:19], s37 offen lds
    buffer_load_dwordx4 v35, s[16:19], s37 offen offset:1024 lds
    s_lshl_b32 s83, s82, 7
    s_add_u32 s83, s83, s29
    s_mul_i32 s84, s82, 524288
    s_add_u32 s84, s84, s30
    s_add_u32 s82, s82, 1
    s_and_b32 s82, s82, 7
    s_add_u32 m0, s80, 8192
    s_add_u32 s37, s83, 0
    buffer_load_dwordx4 v32, s[12:15], s37 offen lds
    buffer_load_dwordx4 v33, s[12:15], s37 offen offset:1024 lds
    s_add_u32 m0, s80, 40960
    s_add_u32 s37, s83, 262144
    buffer_load_dwordx4 v32, s[12:15], s37 offen lds
    buffer_load_dwordx4 v33, s[12:15], s37 offen offset:1024 lds
    s_add_u32 m0, s80, 73728
    s_add_u32 s37, s84, 0
    buffer_load_dwordx4 v34, s[16:19], s37 offen lds
    buffer_load_dwordx4 v35, s[16:19], s37 offen offset:1024 lds
    s_add_u32 m0, s80, 106496
    s_add_u32 s37, s84, 262144
    buffer_load_dwordx4 v34, s[16:19], s37 offen lds
    buffer_load_dwordx4 v35, s[16:19], s37 offen offset:1024 lds
    s_lshl_b32 s83, s82, 7
    s_add_u32 s83, s83, s29
    s_mul_i32 s84, s82, 524288
    s_add_u32 s84, s84, s30
    s_add_u32 s82, s82, 1
    s_and_b32 s82, s82, 7
    s_add_u32 m0, s80, 16384
    s_add_u32 s37, s83, 0
    buffer_load_dwordx4 v32, s[12:15], s37 offen lds
    buffer_load_dwordx4 v33, s[12:15], s37 offen offset:1024 lds
    s_add_u32 m0, s80, 49152
    s_add_u32 s37, s83, 262144
    buffer_load_dwordx4 v32, s[12:15], s37 offen lds
    buffer_load_dwordx4 v33, s[12:15], s37 offen offset:1024 lds
    s_add_u32 m0, s80, 81920
    s_add_u32 s37, s84, 0
    buffer_load_dwordx4 v34, s[16:19], s37 offen lds
    buffer_load_dwordx4 v35, s[16:19], s37 offen offset:1024 lds
    s_add_u32 m0, s80, 114688
    s_add_u32 s37, s84, 262144
    buffer_load_dwordx4 v34, s[16:19], s37 offen lds
    buffer_load_dwordx4 v35, s[16:19], s37 offen offset:1024 lds
    v_mov_b32 v192, 0
    v_mov_b32 v193, 0
    v_mov_b32 v194, 0
    v_mov_b32 v195, 0
    v_mov_b32 v196, 0
    v_mov_b32 v197, 0
    v_mov_b32 v198, 0
    v_mov_b32 v199, 0
    v_mov_b32 v200, 0
    v_mov_b32 v201, 0
    v_mov_b32 v202, 0
    v_mov_b32 v203, 0
    v_mov_b32 v204, 0
    v_mov_b32 v205, 0
    v_mov_b32 v206, 0
    v_mov_b32 v207, 0
    v_mov_b32 v208, 0
    v_mov_b32 v209, 0
    v_mov_b32 v210, 0
    v_mov_b32 v211, 0
    v_mov_b32 v212, 0
    v_mov_b32 v213, 0
    v_mov_b32 v214, 0
    v_mov_b32 v215, 0
    v_mov_b32 v216, 0
    v_mov_b32 v217, 0
    v_mov_b32 v218, 0
    v_mov_b32 v219, 0
    v_mov_b32 v220, 0
    v_mov_b32 v221, 0
    v_mov_b32 v222, 0
    v_mov_b32 v223, 0
    v_mov_b32 v240, 0x3f803f80
    v_mov_b32 v241, 0x3f803f80
    v_mov_b32 v242, 0x3f803f80
    v_mov_b32 v243, 0x3f803f80
    s_mov_b32 s41, 0xff800000
    s_nop 1
    v_mfma_f32_32x32x16_bf16 a[0:15], v[192:195], v[192:195], 0
    v_mfma_f32_32x32x16_bf16 a[16:31], v[192:195], v[192:195], 0
    v_mfma_f32_32x32x16_bf16 a[32:47], v[192:195], v[192:195], 0
    v_mfma_f32_32x32x16_bf16 a[48:63], v[192:195], v[192:195], 0
    v_mfma_f32_32x32x16_bf16 a[64:79], v[192:195], v[192:195], 0
    v_mfma_f32_32x32x16_bf16 a[80:95], v[192:195], v[192:195], 0
    v_mfma_f32_32x32x16_bf16 a[96:111], v[192:195], v[192:195], 0
    v_mfma_f32_32x32x16_bf16 a[112:127], v[192:195], v[192:195], 0
    v_mfma_f32_32x32x16_bf16 a[128:143], v[192:195], v[192:195], 0
    v_mfma_f32_32x32x16_bf16 a[144:159], v[192:195], v[192:195], 0
    s_waitcnt vmcnt(16)
    s_barrier
    s_mov_b32 s38, 0
    s_cmp_eq_u32 s46, 0
    s_cselect_b32 s38, s38, 32768
    v_add_u32 v44, s38, v36
    ds_read_b128 v[64:67], v44 offset:0
    ds_read_b128 v[80:83], v44 offset:4096
    v_add_u32 v44, s38, v37
    ds_read_b128 v[68:71], v44 offset:0
    ds_read_b128 v[84:87], v44 offset:4096
    v_add_u32 v44, 65536, v40
    ds_read_b64_tr_b16 v[96:97], v44 offset:0
    ds_read_b64_tr_b16 v[100:101], v44 offset:4096
    v_add_u32 v45, 65536, v41
    ds_read_b64_tr_b16 v[98:99], v45 offset:1024
    ds_read_b64_tr_b16 v[102:103], v45 offset:5120
    v_add_u32 v44, 65536, v42
    ds_read_b64_tr_b16 v[112:113], v44 offset:0
    ds_read_b64_tr_b16 v[116:117], v44 offset:4096
    v_add_u32 v45, 65536, v43
    ds_read_b64_tr_b16 v[114:115], v45 offset:1024
    ds_read_b64_tr_b16 v[118:119], v45 offset:5120
    s_lshl_b32 s83, s82, 7
    s_add_u32 s83, s83, s29
    s_mul_i32 s84, s82, 524288
    s_add_u32 s84, s84, s30
    s_add_u32 s82, s82, 1
    s_and_b32 s82, s82, 7
    s_add_u32 m0, s80, 24576
    s_add_u32 s37, s83, 0
    buffer_load_dwordx4 v32, s[12:15], s37 offen lds
    buffer_load_dwordx4 v33, s[12:15], s37 offen offset:1024 lds
    s_add_u32 m0, s80, 57344
    s_add_u32 s37, s83, 262144
    buffer_load_dwordx4 v32, s[12:15], s37 offen lds
    buffer_load_dwordx4 v33, s[12:15], s37 offen offset:1024 lds
    s_add_u32 m0, s80, 90112
    s_waitcnt lgkmcnt(0)
    v_mfma_f32_32x32x16_bf16 v[128:143], v[96:99], v[64:67], 0
    v_add_u32 v44, s38, v38
    ds_read_b128 v[72:75], v44 offset:0
    ds_read_b128 v[88:91], v44 offset:4096
    v_mfma_f32_32x32x16_bf16 v[144:159], v[96:99], v[80:83], 0
    v_add_u32 v44, s38, v39
    ds_read_b128 v[76:79], v44 offset:0
    v_mfma_f32_32x32x16_bf16 v[160:175], v[112:115], v[64:67], 0
    ds_read_b128 v[92:95], v44 offset:4096
    v_add_u32 v44, 98304, v40
    v_mfma_f32_32x32x16_bf16 v[176:191], v[112:115], v[80:83], 0
    ds_read_b64_tr_b16 v[104:105], v44 offset:0
    ds_read_b64_tr_b16 v[108:109], v44 offset:4096
    v_mfma_f32_32x32x16_bf16 v[128:143], v[100:103], v[68:71], v[128:143]
    v_add_u32 v45, 98304, v41
    ds_read_b64_tr_b16 v[106:107], v45 offset:1024
    ds_read_b64_tr_b16 v[110:111], v45 offset:5120
    v_mfma_f32_32x32x16_bf16 v[144:159], v[100:103], v[84:87], v[144:159]
    v_add_u32 v44, 98304, v42
    ds_read_b64_tr_b16 v[120:121], v44 offset:0
    v_mfma_f32_32x32x16_bf16 v[160:175], v[116:119], v[68:71], v[160:175]
    ds_read_b64_tr_b16 v[124:125], v44 offset:4096
    v_add_u32 v45, 98304, v43
    v_mfma_f32_32x32x16_bf16 v[176:191], v[116:119], v[84:87], v[176:191]
    ds_read_b64_tr_b16 v[122:123], v45 offset:1024
    ds_read_b64_tr_b16 v[126:127], v45 offset:5120
    s_waitcnt lgkmcnt(0)
    v_mfma_f32_32x32x16_bf16 v[128:143], v[104:107], v[72:75], v[128:143]
    s_add_u32 s37, s84, 0
    buffer_load_dwordx4 v34, s[16:19], s37 offen lds
    buffer_load_dwordx4 v35, s[16:19], s37 offen offset:1024 lds
    s_add_u32 m0, s80, 122880
    v_mfma_f32_32x32x16_bf16 v[144:159], v[104:107], v[88:91], v[144:159]
    s_add_u32 s37, s84, 262144
    buffer_load_dwordx4 v34, s[16:19], s37 offen lds
    buffer_load_dwordx4 v35, s[16:19], s37 offen offset:1024 lds
    v_mfma_f32_32x32x16_bf16 v[160:175], v[120:123], v[72:75], v[160:175]
    s_lshl_b32 s83, s82, 7
    s_add_u32 s83, s83, s29
    s_mul_i32 s84, s82, 524288
    s_add_u32 s84, s84, s30
    s_add_u32 s82, s82, 1
    v_mfma_f32_32x32x16_bf16 v[176:191], v[120:123], v[88:91], v[176:191]
    s_and_b32 s82, s82, 7
    s_add_u32 m0, s80, 131072
    s_add_u32 s37, s83, 0
    buffer_load_dwordx4 v32, s[12:15], s37 offen lds
    v_mfma_f32_32x32x16_bf16 v[128:143], v[108:111], v[76:79], v[128:143]
    buffer_load_dwordx4 v33, s[12:15], s37 offen offset:1024 lds
    s_add_u32 m0, s80, 139264
    s_add_u32 s37, s83, 262144
    v_mfma_f32_32x32x16_bf16 v[144:159], v[108:111], v[92:95], v[144:159]
    buffer_load_dwordx4 v32, s[12:15], s37 offen lds
    buffer_load_dwordx4 v33, s[12:15], s37 offen offset:1024 lds
    s_add_u32 m0, s80, 147456
    s_add_u32 s37, s84, 0
    v_mfma_f32_32x32x16_bf16 v[160:175], v[124:127], v[76:79], v[160:175]
    buffer_load_dwordx4 v34, s[16:19], s37 offen lds
    buffer_load_dwordx4 v35, s[16:19], s37 offen offset:1024 lds
    s_add_u32 m0, s80, 155648
    v_mfma_f32_32x32x16_bf16 v[176:191], v[124:127], v[92:95], v[176:191]
    s_add_u32 s37, s84, 262144
    buffer_load_dwordx4 v34, s[16:19], s37 offen lds
    buffer_load_dwordx4 v35, s[16:19], s37 offen offset:1024 lds
    s_waitcnt vmcnt(24)
    s_barrier
    s_mov_b32 s38, 8192
    s_cmp_eq_u32 s46, 0
    s_cselect_b32 s38, s38, 40960
    v_add_u32 v44, s38, v36
    ds_read_b128 v[64:67], v44 offset:0
    ds_read_b128 v[80:83], v44 offset:4096
    v_add_u32 v44, s38, v37
    ds_read_b128 v[68:71], v44 offset:0
    ds_read_b128 v[84:87], v44 offset:4096
    v_add_u32 v44, 73728, v40
    ds_read_b64_tr_b16 v[96:97], v44 offset:0
    ds_read_b64_tr_b16 v[100:101], v44 offset:4096
    v_add_u32 v45, 73728, v41
    ds_read_b64_tr_b16 v[98:99], v45 offset:1024
    ds_read_b64_tr_b16 v[102:103], v45 offset:5120
    v_add_u32 v44, 73728, v42
    ds_read_b64_tr_b16 v[112:113], v44 offset:0
    ds_read_b64_tr_b16 v[116:117], v44 offset:4096
    v_add_u32 v45, 73728, v43
    ds_read_b64_tr_b16 v[114:115], v45 offset:1024
    ds_read_b64_tr_b16 v[118:119], v45 offset:5120
    s_add_u32 m0, s28, 0
    s_add_u32 s37, s26, 0
    buffer_load_dwordx4 v5, s[4:7], s37 offen offset:0 nt lds
    buffer_load_dwordx4 v6, s[4:7], s37 offen offset:1024 nt lds
    s_waitcnt lgkmcnt(0)
    v_mfma_f32_32x32x16_bf16 v[128:143], v[96:99], v[64:67], v[128:143]
    v_add_u32 v44, s38, v38
    ds_read_b128 v[72:75], v44 offset:0
    ds_read_b128 v[88:91], v44 offset:4096
    v_mfma_f32_32x32x16_bf16 v[144:159], v[96:99], v[80:83], v[144:159]
    v_add_u32 v44, s38, v39
    ds_read_b128 v[76:79], v44 offset:0
    v_mfma_f32_32x32x16_bf16 v[160:175], v[112:115], v[64:67], v[160:175]
    ds_read_b128 v[92:95], v44 offset:4096
    v_add_u32 v44, 106496, v40
    v_mfma_f32_32x32x16_bf16 v[176:191], v[112:115], v[80:83], v[176:191]
    ds_read_b64_tr_b16 v[104:105], v44 offset:0
    ds_read_b64_tr_b16 v[108:109], v44 offset:4096
    v_mfma_f32_32x32x16_bf16 v[128:143], v[100:103], v[68:71], v[128:143]
    v_add_u32 v45, 106496, v41
    ds_read_b64_tr_b16 v[106:107], v45 offset:1024
    ds_read_b64_tr_b16 v[110:111], v45 offset:5120
    v_mfma_f32_32x32x16_bf16 v[144:159], v[100:103], v[84:87], v[144:159]
    v_add_u32 v44, 106496, v42
    ds_read_b64_tr_b16 v[120:121], v44 offset:0
    v_mfma_f32_32x32x16_bf16 v[160:175], v[116:119], v[68:71], v[160:175]
    ds_read_b64_tr_b16 v[124:125], v44 offset:4096
    v_add_u32 v45, 106496, v43
    v_mfma_f32_32x32x16_bf16 v[176:191], v[116:119], v[84:87], v[176:191]
    ds_read_b64_tr_b16 v[122:123], v45 offset:1024
    ds_read_b64_tr_b16 v[126:127], v45 offset:5120
    s_waitcnt lgkmcnt(0)
    v_mfma_f32_32x32x16_bf16 v[128:143], v[104:107], v[72:75], v[128:143]
    buffer_load_dwordx4 v7, s[4:7], s37 offen offset:2048 nt lds
    v_mfma_f32_32x32x16_bf16 v[144:159], v[104:107], v[88:91], v[144:159]
    buffer_load_dwordx4 v8, s[4:7], s37 offen offset:3072 nt lds
    v_mfma_f32_32x32x16_bf16 v[160:175], v[120:123], v[72:75], v[160:175]
    s_add_u32 m0, s28, 4096
    v_mfma_f32_32x32x16_bf16 v[176:191], v[120:123], v[88:91], v[176:191]
    s_add_u32 s37, s26, 4096
    v_mfma_f32_32x32x16_bf16 v[128:143], v[108:111], v[76:79], v[128:143]
    buffer_load_dwordx4 v5, s[4:7], s37 offen offset:0 nt lds
    v_mfma_f32_32x32x16_bf16 v[144:159], v[108:111], v[92:95], v[144:159]
    buffer_load_dwordx4 v6, s[4:7], s37 offen offset:1024 nt lds
    v_mfma_f32_32x32x16_bf16 v[160:175], v[124:127], v[76:79], v[160:175]
    buffer_load_dwordx4 v7, s[4:7], s37 offen offset:2048 nt lds
    v_mfma_f32_32x32x16_bf16 v[176:191], v[124:127], v[92:95], v[176:191]
    buffer_load_dwordx4 v8, s[4:7], s37 offen offset:3072 nt lds
    s_waitcnt vmcnt(24)
    s_barrier
    s_mov_b32 s38, 16384
    s_cmp_eq_u32 s46, 0
    s_cselect_b32 s38, s38, 49152
    v_add_u32 v44, s38, v36
    ds_read_b128 v[64:67], v44 offset:0
    ds_read_b128 v[80:83], v44 offset:4096
    v_add_u32 v44, s38, v37
    ds_read_b128 v[68:71], v44 offset:0
    ds_read_b128 v[84:87], v44 offset:4096
    v_add_u32 v44, 81920, v40
    ds_read_b64_tr_b16 v[96:97], v44 offset:0
    ds_read_b64_tr_b16 v[100:101], v44 offset:4096
    v_add_u32 v45, 81920, v41
    ds_read_b64_tr_b16 v[98:99], v45 offset:1024
    ds_read_b64_tr_b16 v[102:103], v45 offset:5120
    v_add_u32 v44, 81920, v42
    ds_read_b64_tr_b16 v[112:113], v44 offset:0
    ds_read_b64_tr_b16 v[116:117], v44 offset:4096
    v_add_u32 v45, 81920, v43
    ds_read_b64_tr_b16 v[114:115], v45 offset:1024
    ds_read_b64_tr_b16 v[118:119], v45 offset:5120
    s_add_u32 m0, s28, 8192
    s_add_u32 s37, s26, 0
    buffer_load_dwordx4 v5, s[8:11], s37 offen offset:0 nt lds
    buffer_load_dwordx4 v6, s[8:11], s37 offen offset:1024 nt lds
    s_waitcnt lgkmcnt(0)
    v_mfma_f32_32x32x16_bf16 v[128:143], v[96:99], v[64:67], v[128:143]
    v_add_u32 v44, s38, v38
    ds_read_b128 v[72:75], v44 offset:0
    ds_read_b128 v[88:91], v44 offset:4096
    v_mfma_f32_32x32x16_bf16 v[144:159], v[96:99], v[80:83], v[144:159]
    v_add_u32 v44, s38, v39
    ds_read_b128 v[76:79], v44 offset:0
    v_mfma_f32_32x32x16_bf16 v[160:175], v[112:115], v[64:67], v[160:175]
    ds_read_b128 v[92:95], v44 offset:4096
    v_add_u32 v44, 114688, v40
    v_mfma_f32_32x32x16_bf16 v[176:191], v[112:115], v[80:83], v[176:191]
    ds_read_b64_tr_b16 v[104:105], v44 offset:0
    ds_read_b64_tr_b16 v[108:109], v44 offset:4096
    v_mfma_f32_32x32x16_bf16 v[128:143], v[100:103], v[68:71], v[128:143]
    v_add_u32 v45, 114688, v41
    ds_read_b64_tr_b16 v[106:107], v45 offset:1024
    ds_read_b64_tr_b16 v[110:111], v45 offset:5120
    v_mfma_f32_32x32x16_bf16 v[144:159], v[100:103], v[84:87], v[144:159]
    v_add_u32 v44, 114688, v42
    ds_read_b64_tr_b16 v[120:121], v44 offset:0
    v_mfma_f32_32x32x16_bf16 v[160:175], v[116:119], v[68:71], v[160:175]
    ds_read_b64_tr_b16 v[124:125], v44 offset:4096
    v_add_u32 v45, 114688, v43
    v_mfma_f32_32x32x16_bf16 v[176:191], v[116:119], v[84:87], v[176:191]
    ds_read_b64_tr_b16 v[122:123], v45 offset:1024
    ds_read_b64_tr_b16 v[126:127], v45 offset:5120
    s_waitcnt lgkmcnt(0)
    v_mfma_f32_32x32x16_bf16 v[128:143], v[104:107], v[72:75], v[128:143]
    buffer_load_dwordx4 v7, s[8:11], s37 offen offset:2048 nt lds
    v_mfma_f32_32x32x16_bf16 v[144:159], v[104:107], v[88:91], v[144:159]
    buffer_load_dwordx4 v8, s[8:11], s37 offen offset:3072 nt lds
    v_mfma_f32_32x32x16_bf16 v[160:175], v[120:123], v[72:75], v[160:175]
    s_add_u32 m0, s28, 12288
    v_mfma_f32_32x32x16_bf16 v[176:191], v[120:123], v[88:91], v[176:191]
    s_add_u32 s37, s26, 4096
    v_mfma_f32_32x32x16_bf16 v[128:143], v[108:111], v[76:79], v[128:143]
    buffer_load_dwordx4 v5, s[8:11], s37 offen offset:0 nt lds
    v_mfma_f32_32x32x16_bf16 v[144:159], v[108:111], v[92:95], v[144:159]
    buffer_load_dwordx4 v6, s[8:11], s37 offen offset:1024 nt lds
    v_mfma_f32_32x32x16_bf16 v[160:175], v[124:127], v[76:79], v[160:175]
    buffer_load_dwordx4 v7, s[8:11], s37 offen offset:2048 nt lds
    v_mfma_f32_32x32x16_bf16 v[176:191], v[124:127], v[92:95], v[176:191]
    buffer_load_dwordx4 v8, s[8:11], s37 offen offset:3072 nt lds
    s_waitcnt vmcnt(24)
    s_barrier
    s_mov_b32 s38, 24576
    s_cmp_eq_u32 s46, 0
    s_cselect_b32 s38, s38, 57344
    v_add_u32 v44, s38, v36
    ds_read_b128 v[64:67], v44 offset:0
    ds_read_b128 v[80:83], v44 offset:4096
    v_add_u32 v44, s38, v37
    ds_read_b128 v[68:71], v44 offset:0
    ds_read_b128 v[84:87], v44 offset:4096
    v_add_u32 v44, 90112, v40
    ds_read_b64_tr_b16 v[96:97], v44 offset:0
    ds_read_b64_tr_b16 v[100:101], v44 offset:4096
    v_add_u32 v45, 90112, v41
    ds_read_b64_tr_b16 v[98:99], v45 offset:1024
    ds_read_b64_tr_b16 v[102:103], v45 offset:5120
    v_add_u32 v44, 90112, v42
    ds_read_b64_tr_b16 v[112:113], v44 offset:0
    ds_read_b64_tr_b16 v[116:117], v44 offset:4096
    v_add_u32 v45, 90112, v43
    ds_read_b64_tr_b16 v[114:115], v45 offset:1024
    ds_read_b64_tr_b16 v[118:119], v45 offset:5120
    s_lshl_b32 s83, s82, 7
    s_add_u32 s83, s83, s29
    s_mul_i32 s84, s82, 524288
    s_add_u32 s84, s84, s30
    s_add_u32 s82, s82, 1
    s_and_b32 s82, s82, 7
    s_add_u32 m0, s80, 114688
    s_add_u32 s37, s83, 0
    s_waitcnt lgkmcnt(0)
    v_mfma_f32_32x32x16_bf16 v[128:143], v[96:99], v[64:67], v[128:143]
    v_add_u32 v44, s38, v38
    ds_read_b128 v[72:75], v44 offset:0
    ds_read_b128 v[88:91], v44 offset:4096
    v_mfma_f32_32x32x16_bf16 v[144:159], v[96:99], v[80:83], v[144:159]
    v_add_u32 v44, s38, v39
    ds_read_b128 v[76:79], v44 offset:0
    v_mfma_f32_32x32x16_bf16 v[160:175], v[112:115], v[64:67], v[160:175]
    ds_read_b128 v[92:95], v44 offset:4096
    v_add_u32 v44, 122880, v40
    v_mfma_f32_32x32x16_bf16 v[176:191], v[112:115], v[80:83], v[176:191]
    ds_read_b64_tr_b16 v[104:105], v44 offset:0
    ds_read_b64_tr_b16 v[108:109], v44 offset:4096
    v_mfma_f32_32x32x16_bf16 v[128:143], v[100:103], v[68:71], v[128:143]
    v_add_u32 v45, 122880, v41
    ds_read_b64_tr_b16 v[106:107], v45 offset:1024
    ds_read_b64_tr_b16 v[110:111], v45 offset:5120
    v_mfma_f32_32x32x16_bf16 v[144:159], v[100:103], v[84:87], v[144:159]
    v_add_u32 v44, 122880, v42
    ds_read_b64_tr_b16 v[120:121], v44 offset:0
    v_mfma_f32_32x32x16_bf16 v[160:175], v[116:119], v[68:71], v[160:175]
    ds_read_b64_tr_b16 v[124:125], v44 offset:4096
    v_add_u32 v45, 122880, v43
    v_mfma_f32_32x32x16_bf16 v[176:191], v[116:119], v[84:87], v[176:191]
    ds_read_b64_tr_b16 v[122:123], v45 offset:1024
    ds_read_b64_tr_b16 v[126:127], v45 offset:5120
    s_waitcnt lgkmcnt(0)
    v_mfma_f32_32x32x16_bf16 v[128:143], v[104:107], v[72:75], v[128:143]
    buffer_load_dwordx4 v32, s[12:15], s37 offen lds
    buffer_load_dwordx4 v33, s[12:15], s37 offen offset:1024 lds
    v_mfma_f32_32x32x16_bf16 v[144:159], v[104:107], v[88:91], v[144:159]
    s_add_u32 m0, s80, 81920
    s_add_u32 s37, s83, 262144
    v_mfma_f32_32x32x16_bf16 v[160:175], v[120:123], v[72:75], v[160:175]
    buffer_load_dwordx4 v32, s[12:15], s37 offen lds
    buffer_load_dwordx4 v33, s[12:15], s37 offen offset:1024 lds
    v_mfma_f32_32x32x16_bf16 v[176:191], v[120:123], v[88:91], v[176:191]
    s_add_u32 m0, s80, 49152
    v_mfma_f32_32x32x16_bf16 v[128:143], v[108:111], v[76:79], v[128:143]
    s_add_u32 s37, s84, 0
    buffer_load_dwordx4 v34, s[16:19], s37 offen lds
    buffer_load_dwordx4 v35, s[16:19], s37 offen offset:1024 lds
    v_mfma_f32_32x32x16_bf16 v[144:159], v[108:111], v[92:95], v[144:159]
    s_add_u32 m0, s80, 16384
    v_mfma_f32_32x32x16_bf16 v[160:175], v[124:127], v[76:79], v[160:175]
    s_add_u32 s37, s84, 262144
    buffer_load_dwordx4 v34, s[16:19], s37 offen lds
    v_mfma_f32_32x32x16_bf16 v[176:191], v[124:127], v[92:95], v[176:191]
    buffer_load_dwordx4 v35, s[16:19], s37 offen offset:1024 lds
    s_waitcnt vmcnt(24)
    s_barrier
    s_mov_b32 s38, 131072
    s_cmp_eq_u32 s46, 0
    s_cselect_b32 s38, s38, 139264
    v_add_u32 v44, s38, v36
    ds_read_b128 v[64:67], v44 offset:0
    ds_read_b128 v[80:83], v44 offset:4096
    v_add_u32 v44, s38, v37
    ds_read_b128 v[68:71], v44 offset:0
    ds_read_b128 v[84:87], v44 offset:4096
    v_add_u32 v44, 147456, v40
    ds_read_b64_tr_b16 v[96:97], v44 offset:0
    ds_read_b64_tr_b16 v[100:101], v44 offset:4096
    v_add_u32 v45, 147456, v41
    ds_read_b64_tr_b16 v[98:99], v45 offset:1024
    ds_read_b64_tr_b16 v[102:103], v45 offset:5120
    v_add_u32 v44, 147456, v42
    ds_read_b64_tr_b16 v[112:113], v44 offset:0
    ds_read_b64_tr_b16 v[116:117], v44 offset:4096
    v_add_u32 v45, 147456, v43
    ds_read_b64_tr_b16 v[114:115], v45 offset:1024
    ds_read_b64_tr_b16 v[118:119], v45 offset:5120
    s_lshl_b32 s83, s82, 7
    s_add_u32 s83, s83, s29
    s_mul_i32 s84, s82, 524288
    s_add_u32 s84, s84, s30
    s_add_u32 s82, s82, 1
    s_and_b32 s82, s82, 7
    s_add_u32 m0, s80, 122880
    s_add_u32 s37, s83, 0
    s_waitcnt lgkmcnt(0)
    v_mfma_f32_32x32x16_bf16 v[128:143], v[96:99], v[64:67], v[128:143]
    v_add_u32 v44, s38, v38
    ds_read_b128 v[72:75], v44 offset:0
    ds_read_b128 v[88:91], v44 offset:4096
    v_mfma_f32_32x32x16_bf16 v[144:159], v[96:99], v[80:83], v[144:159]
    v_add_u32 v44, s38, v39
    ds_read_b128 v[76:79], v44 offset:0
    v_mfma_f32_32x32x16_bf16 v[160:175], v[112:115], v[64:67], v[160:175]
    ds_read_b128 v[92:95], v44 offset:4096
    v_add_u32 v44, 155648, v40
    v_mfma_f32_32x32x16_bf16 v[176:191], v[112:115], v[80:83], v[176:191]
    ds_read_b64_tr_b16 v[104:105], v44 offset:0
    ds_read_b64_tr_b16 v[108:109], v44 offset:4096
    v_mfma_f32_32x32x16_bf16 v[128:143], v[100:103], v[68:71], v[128:143]
    v_add_u32 v45, 155648, v41
    ds_read_b64_tr_b16 v[106:107], v45 offset:1024
    ds_read_b64_tr_b16 v[110:111], v45 offset:5120
    v_mfma_f32_32x32x16_bf16 v[144:159], v[100:103], v[84:87], v[144:159]
    v_add_u32 v44, 155648, v42
    ds_read_b64_tr_b16 v[120:121], v44 offset:0
    v_mfma_f32_32x32x16_bf16 v[160:175], v[116:119], v[68:71], v[160:175]
    ds_read_b64_tr_b16 v[124:125], v44 offset:4096
    v_add_u32 v45, 155648, v43
    v_mfma_f32_32x32x16_bf16 v[176:191], v[116:119], v[84:87], v[176:191]
    ds_read_b64_tr_b16 v[122:123], v45 offset:1024
    ds_read_b64_tr_b16 v[126:127], v45 offset:5120
    s_waitcnt lgkmcnt(0)
    v_mfma_f32_32x32x16_bf16 v[128:143], v[104:107], v[72:75], v[128:143]
    buffer_load_dwordx4 v32, s[12:15], s37 offen lds
    buffer_load_dwordx4 v33, s[12:15], s37 offen offset:1024 lds
    v_mfma_f32_32x32x16_bf16 v[144:159], v[104:107], v[88:91], v[144:159]
    s_add_u32 m0, s80, 90112
    s_add_u32 s37, s83, 262144
    v_mfma_f32_32x32x16_bf16 v[160:175], v[120:123], v[72:75], v[160:175]
    buffer_load_dwordx4 v32, s[12:15], s37 offen lds
    buffer_load_dwordx4 v33, s[12:15], s37 offen offset:1024 lds
    v_mfma_f32_32x32x16_bf16 v[176:191], v[120:123], v[88:91], v[176:191]
    s_add_u32 m0, s80, 57344
    v_mfma_f32_32x32x16_bf16 v[128:143], v[108:111], v[76:79], v[128:143]
    s_add_u32 s37, s84, 0
    buffer_load_dwordx4 v34, s[16:19], s37 offen lds
    buffer_load_dwordx4 v35, s[16:19], s37 offen offset:1024 lds
    v_mfma_f32_32x32x16_bf16 v[144:159], v[108:111], v[92:95], v[144:159]
    s_add_u32 m0, s80, 24576
    v_mfma_f32_32x32x16_bf16 v[160:175], v[124:127], v[76:79], v[160:175]
    s_add_u32 s37, s84, 262144
    buffer_load_dwordx4 v34, s[16:19], s37 offen lds
    v_mfma_f32_32x32x16_bf16 v[176:191], v[124:127], v[92:95], v[176:191]
    buffer_load_dwordx4 v35, s[16:19], s37 offen offset:1024 lds
    s_waitcnt vmcnt(8)
    s_barrier
    s_mov_b32 s38, 114688
    s_cmp_eq_u32 s46, 0
    s_cselect_b32 s38, s38, 81920
    v_add_u32 v44, s38, v36
    ds_read_b128 v[64:67], v44 offset:0
    ds_read_b128 v[80:83], v44 offset:4096
    v_add_u32 v44, s38, v37
    ds_read_b128 v[68:71], v44 offset:0
    ds_read_b128 v[84:87], v44 offset:4096
    v_add_u32 v44, 49152, v40
    ds_read_b64_tr_b16 v[96:97], v44 offset:0
    ds_read_b64_tr_b16 v[100:101], v44 offset:4096
    v_add_u32 v45, 49152, v41
    ds_read_b64_tr_b16 v[98:99], v45 offset:1024
    ds_read_b64_tr_b16 v[102:103], v45 offset:5120
    v_add_u32 v44, 49152, v42
    ds_read_b64_tr_b16 v[112:113], v44 offset:0
    ds_read_b64_tr_b16 v[116:117], v44 offset:4096
    v_add_u32 v45, 49152, v43
    ds_read_b64_tr_b16 v[114:115], v45 offset:1024
    ds_read_b64_tr_b16 v[118:119], v45 offset:5120
    s_lshl_b32 s83, s82, 7
    s_add_u32 s83, s83, s29
    s_mul_i32 s84, s82, 524288
    s_add_u32 s84, s84, s30
    s_add_u32 s82, s82, 1
    s_and_b32 s82, s82, 7
    s_add_u32 m0, s80, 155648
    s_add_u32 s37, s83, 0
    s_waitcnt lgkmcnt(0)
    v_mfma_f32_32x32x16_bf16 v[128:143], v[96:99], v[64:67], v[128:143]
    v_add_u32 v44, s38, v38
    ds_read_b128 v[72:75], v44 offset:0
    ds_read_b128 v[88:91], v44 offset:4096
    v_mfma_f32_32x32x16_bf16 v[144:159], v[96:99], v[80:83], v[144:159]
    v_add_u32 v44, s38, v39
    ds_read_b128 v[76:79], v44 offset:0
    v_mfma_f32_32x32x16_bf16 v[160:175], v[112:115], v[64:67], v[160:175]
    ds_read_b128 v[92:95], v44 offset:4096
    v_add_u32 v44, 16384, v40
    v_mfma_f32_32x32x16_bf16 v[176:191], v[112:115], v[80:83], v[176:191]
    ds_read_b64_tr_b16 v[104:105], v44 offset:0
    ds_read_b64_tr_b16 v[108:109], v44 offset:4096
    v_mfma_f32_32x32x16_bf16 v[128:143], v[100:103], v[68:71], v[128:143]
    v_add_u32 v45, 16384, v41
    ds_read_b64_tr_b16 v[106:107], v45 offset:1024
    ds_read_b64_tr_b16 v[110:111], v45 offset:5120
    v_mfma_f32_32x32x16_bf16 v[144:159], v[100:103], v[84:87], v[144:159]
    v_add_u32 v44, 16384, v42
    ds_read_b64_tr_b16 v[120:121], v44 offset:0
    v_mfma_f32_32x32x16_bf16 v[160:175], v[116:119], v[68:71], v[160:175]
    ds_read_b64_tr_b16 v[124:125], v44 offset:4096
    v_add_u32 v45, 16384, v43
    v_mfma_f32_32x32x16_bf16 v[176:191], v[116:119], v[84:87], v[176:191]
    ds_read_b64_tr_b16 v[122:123], v45 offset:1024
    ds_read_b64_tr_b16 v[126:127], v45 offset:5120
    s_waitcnt lgkmcnt(0)
    v_mfma_f32_32x32x16_bf16 v[128:143], v[104:107], v[72:75], v[128:143]
    buffer_load_dwordx4 v32, s[12:15], s37 offen lds
    buffer_load_dwordx4 v33, s[12:15], s37 offen offset:1024 lds
    v_mfma_f32_32x32x16_bf16 v[144:159], v[104:107], v[88:91], v[144:159]
    s_add_u32 m0, s80, 147456
    s_add_u32 s37, s83, 262144
    v_mfma_f32_32x32x16_bf16 v[160:175], v[120:123], v[72:75], v[160:175]
    buffer_load_dwordx4 v32, s[12:15], s37 offen lds
    buffer_load_dwordx4 v33, s[12:15], s37 offen offset:1024 lds
    v_mfma_f32_32x32x16_bf16 v[176:191], v[120:123], v[88:91], v[176:191]
    s_add_u32 m0, s80, 139264
    v_mfma_f32_32x32x16_bf16 v[128:143], v[108:111], v[76:79], v[128:143]
    s_add_u32 s37, s84, 0
    buffer_load_dwordx4 v34, s[16:19], s37 offen lds
    buffer_load_dwordx4 v35, s[16:19], s37 offen offset:1024 lds
    v_mfma_f32_32x32x16_bf16 v[144:159], v[108:111], v[92:95], v[144:159]
    s_add_u32 m0, s80, 131072
    v_mfma_f32_32x32x16_bf16 v[160:175], v[124:127], v[76:79], v[160:175]
    s_add_u32 s37, s84, 262144
    buffer_load_dwordx4 v34, s[16:19], s37 offen lds
    v_mfma_f32_32x32x16_bf16 v[176:191], v[124:127], v[92:95], v[176:191]
    buffer_load_dwordx4 v35, s[16:19], s37 offen offset:1024 lds
    s_waitcnt vmcnt(8)
    s_barrier
    s_mov_b32 s38, 122880
    s_cmp_eq_u32 s46, 0
    s_cselect_b32 s38, s38, 90112
    v_add_u32 v44, s38, v36
    ds_read_b128 v[64:67], v44 offset:0
    ds_read_b128 v[80:83], v44 offset:4096
    v_add_u32 v44, s38, v37
    ds_read_b128 v[68:71], v44 offset:0
    ds_read_b128 v[84:87], v44 offset:4096
    v_add_u32 v44, 57344, v40
    ds_read_b64_tr_b16 v[96:97], v44 offset:0
    ds_read_b64_tr_b16 v[100:101], v44 offset:4096
    v_add_u32 v45, 57344, v41
    ds_read_b64_tr_b16 v[98:99], v45 offset:1024
    ds_read_b64_tr_b16 v[102:103], v45 offset:5120
    v_add_u32 v44, 57344, v42
    ds_read_b64_tr_b16 v[112:113], v44 offset:0
    ds_read_b64_tr_b16 v[116:117], v44 offset:4096
    v_add_u32 v45, 57344, v43
    ds_read_b64_tr_b16 v[114:115], v45 offset:1024
    ds_read_b64_tr_b16 v[118:119], v45 offset:5120
    s_add_u32 m0, s28, 16384
    s_add_u32 s37, s26, 16384
    buffer_load_dwordx4 v5, s[4:7], s37 offen offset:0 nt lds
    buffer_load_dwordx4 v6, s[4:7], s37 offen offset:1024 nt lds
    s_waitcnt lgkmcnt(0)
    v_mfma_f32_32x32x16_bf16 v[128:143], v[96:99], v[64:67], v[128:143]
    v_add_u32 v44, s38, v38
    ds_read_b128 v[72:75], v44 offset:0
    ds_read_b128 v[88:91], v44 offset:4096
    v_mfma_f32_32x32x16_bf16 v[144:159], v[96:99], v[80:83], v[144:159]
    v_add_u32 v44, s38, v39
    ds_read_b128 v[76:79], v44 offset:0
    v_mfma_f32_32x32x16_bf16 v[160:175], v[112:115], v[64:67], v[160:175]
    ds_read_b128 v[92:95], v44 offset:4096
    v_add_u32 v44, 24576, v40
    v_mfma_f32_32x32x16_bf16 v[176:191], v[112:115], v[80:83], v[176:191]
    ds_read_b64_tr_b16 v[104:105], v44 offset:0
    ds_read_b64_tr_b16 v[108:109], v44 offset:4096
    v_mfma_f32_32x32x16_bf16 v[128:143], v[100:103], v[68:71], v[128:143]
    v_add_u32 v45, 24576, v41
    ds_read_b64_tr_b16 v[106:107], v45 offset:1024
    ds_read_b64_tr_b16 v[110:111], v45 offset:5120
    v_mfma_f32_32x32x16_bf16 v[144:159], v[100:103], v[84:87], v[144:159]
    v_add_u32 v44, 24576, v42
    ds_read_b64_tr_b16 v[120:121], v44 offset:0
    v_mfma_f32_32x32x16_bf16 v[160:175], v[116:119], v[68:71], v[160:175]
    ds_read_b64_tr_b16 v[124:125], v44 offset:4096
    v_add_u32 v45, 24576, v43
    v_mfma_f32_32x32x16_bf16 v[176:191], v[116:119], v[84:87], v[176:191]
    ds_read_b64_tr_b16 v[122:123], v45 offset:1024
    ds_read_b64_tr_b16 v[126:127], v45 offset:5120
    s_waitcnt lgkmcnt(0)
    v_mfma_f32_32x32x16_bf16 v[128:143], v[104:107], v[72:75], v[128:143]
    buffer_load_dwordx4 v7, s[4:7], s37 offen offset:2048 nt lds
    v_mfma_f32_32x32x16_bf16 v[144:159], v[104:107], v[88:91], v[144:159]
    buffer_load_dwordx4 v8, s[4:7], s37 offen offset:3072 nt lds
    v_mfma_f32_32x32x16_bf16 v[160:175], v[120:123], v[72:75], v[160:175]
    s_add_u32 m0, s28, 20480
    v_mfma_f32_32x32x16_bf16 v[176:191], v[120:123], v[88:91], v[176:191]
    s_add_u32 s37, s26, 20480
    v_mfma_f32_32x32x16_bf16 v[128:143], v[108:111], v[76:79], v[128:143]
    buffer_load_dwordx4 v5, s[4:7], s37 offen offset:0 nt lds
    v_mfma_f32_32x32x16_bf16 v[144:159], v[108:111], v[92:95], v[144:159]
    buffer_load_dwordx4 v6, s[4:7], s37 offen offset:1024 nt lds
    v_mfma_f32_32x32x16_bf16 v[160:175], v[124:127], v[76:79], v[160:175]
    buffer_load_dwordx4 v7, s[4:7], s37 offen offset:2048 nt lds
    v_mfma_f32_32x32x16_bf16 v[176:191], v[124:127], v[92:95], v[176:191]
    buffer_load_dwordx4 v8, s[4:7], s37 offen offset:3072 nt lds
    s_waitcnt vmcnt(8)
    s_barrier
    s_mov_b32 s38, 155648
    s_cmp_eq_u32 s46, 0
    s_cselect_b32 s38, s38, 147456
    v_add_u32 v44, s38, v36
    ds_read_b128 v[64:67], v44 offset:0
    ds_read_b128 v[80:83], v44 offset:4096
    v_add_u32 v44, s38, v37
    ds_read_b128 v[68:71], v44 offset:0
    ds_read_b128 v[84:87], v44 offset:4096
    v_add_u32 v44, 139264, v40
    ds_read_b64_tr_b16 v[96:97], v44 offset:0
    ds_read_b64_tr_b16 v[100:101], v44 offset:4096
    v_add_u32 v45, 139264, v41
    ds_read_b64_tr_b16 v[98:99], v45 offset:1024
    ds_read_b64_tr_b16 v[102:103], v45 offset:5120
    v_add_u32 v44, 139264, v42
    ds_read_b64_tr_b16 v[112:113], v44 offset:0
    ds_read_b64_tr_b16 v[116:117], v44 offset:4096
    v_add_u32 v45, 139264, v43
    ds_read_b64_tr_b16 v[114:115], v45 offset:1024
    ds_read_b64_tr_b16 v[118:119], v45 offset:5120
    s_add_u32 m0, s28, 24576
    s_add_u32 s37, s26, 16384
    buffer_load_dwordx4 v5, s[8:11], s37 offen offset:0 nt lds
    buffer_load_dwordx4 v6, s[8:11], s37 offen offset:1024 nt lds
    s_waitcnt lgkmcnt(0)
    v_mfma_f32_32x32x16_bf16 v[128:143], v[96:99], v[64:67], v[128:143]
    v_add_u32 v44, s38, v38
    ds_read_b128 v[72:75], v44 offset:0
    ds_read_b128 v[88:91], v44 offset:4096
    v_mfma_f32_32x32x16_bf16 v[144:159], v[96:99], v[80:83], v[144:159]
    v_add_u32 v44, s38, v39
    ds_read_b128 v[76:79], v44 offset:0
    v_mfma_f32_32x32x16_bf16 v[160:175], v[112:115], v[64:67], v[160:175]
    ds_read_b128 v[92:95], v44 offset:4096
    v_add_u32 v44, 131072, v40
    v_mfma_f32_32x32x16_bf16 v[176:191], v[112:115], v[80:83], v[176:191]
    ds_read_b64_tr_b16 v[104:105], v44 offset:0
    ds_read_b64_tr_b16 v[108:109], v44 offset:4096
    v_mfma_f32_32x32x16_bf16 v[128:143], v[100:103], v[68:71], v[128:143]
    v_add_u32 v45, 131072, v41
    ds_read_b64_tr_b16 v[106:107], v45 offset:1024
    ds_read_b64_tr_b16 v[110:111], v45 offset:5120
    v_mfma_f32_32x32x16_bf16 v[144:159], v[100:103], v[84:87], v[144:159]
    v_add_u32 v44, 131072, v42
    ds_read_b64_tr_b16 v[120:121], v44 offset:0
    v_mfma_f32_32x32x16_bf16 v[160:175], v[116:119], v[68:71], v[160:175]
    ds_read_b64_tr_b16 v[124:125], v44 offset:4096
    v_add_u32 v45, 131072, v43
    v_mfma_f32_32x32x16_bf16 v[176:191], v[116:119], v[84:87], v[176:191]
    ds_read_b64_tr_b16 v[122:123], v45 offset:1024
    ds_read_b64_tr_b16 v[126:127], v45 offset:5120
    s_waitcnt lgkmcnt(0)
    v_mfma_f32_32x32x16_bf16 v[128:143], v[104:107], v[72:75], v[128:143]
    buffer_load_dwordx4 v7, s[8:11], s37 offen offset:2048 nt lds
    v_mfma_f32_32x32x16_bf16 v[144:159], v[104:107], v[88:91], v[144:159]
    buffer_load_dwordx4 v8, s[8:11], s37 offen offset:3072 nt lds
    v_mfma_f32_32x32x16_bf16 v[160:175], v[120:123], v[72:75], v[160:175]
    s_add_u32 m0, s28, 28672
    v_mfma_f32_32x32x16_bf16 v[176:191], v[120:123], v[88:91], v[176:191]
    s_add_u32 s37, s26, 20480
    v_mfma_f32_32x32x16_bf16 v[128:143], v[108:111], v[76:79], v[128:143]
    buffer_load_dwordx4 v5, s[8:11], s37 offen offset:0 nt lds
    v_mfma_f32_32x32x16_bf16 v[144:159], v[108:111], v[92:95], v[144:159]
    buffer_load_dwordx4 v6, s[8:11], s37 offen offset:1024 nt lds
    v_mfma_f32_32x32x16_bf16 v[160:175], v[124:127], v[76:79], v[160:175]
    buffer_load_dwordx4 v7, s[8:11], s37 offen offset:2048 nt lds
    v_mfma_f32_32x32x16_bf16 v[176:191], v[124:127], v[92:95], v[176:191]
    buffer_load_dwordx4 v8, s[8:11], s37 offen offset:3072 nt lds
    s_barrier
    s_add_u32 s26, s26, 32768
    s_lshl_b32 s37, s47, 7
    v_xor_b32 v29, s37, v28
    s_lshl_b32 s37, s46, 14
    s_add_u32 s37, s37, 131072
    v_add_u32 v29, s37, v29
    s_nop 7
    v_mul_f32 v128, s31, v128
    v_mul_f32 v129, s31, v129
    v_mul_f32 v130, s31, v130
    v_mul_f32 v131, s31, v131
    v_mul_f32 v132, s31, v132
    v_mul_f32 v133, s31, v133
    v_mul_f32 v134, s31, v134
    v_mul_f32 v135, s31, v135
    v_cvt_pk_bf16_f32 v64, v128, v129
    v_cvt_pk_bf16_f32 v65, v130, v131
    v_cvt_pk_bf16_f32 v66, v132, v133
    v_cvt_pk_bf16_f32 v67, v134, v135
    ds_write_b128 v29, v[64:67] offset:0
    v_mul_f32 v144, s31, v144
    v_mul_f32 v145, s31, v145
    v_mul_f32 v146, s31, v146
    v_mul_f32 v147, s31, v147
    v_mul_f32 v148, s31, v148
    v_mul_f32 v149, s31, v149
    v_mul_f32 v150, s31, v150
    v_mul_f32 v151, s31, v151
    v_cvt_pk_bf16_f32 v68, v144, v145
    v_cvt_pk_bf16_f32 v69, v146, v147
    v_cvt_pk_bf16_f32 v70, v148, v149
    v_cvt_pk_bf16_f32 v71, v150, v151
    ds_write_b128 v29, v[68:71] offset:8192
    v_xor_b32 v30, 32, v29
    v_mul_f32 v136, s31, v136
    v_mul_f32 v137, s31, v137
    v_mul_f32 v138, s31, v138
    v_mul_f32 v139, s31, v139
    v_mul_f32 v140, s31, v140
    v_mul_f32 v141, s31, v141
    v_mul_f32 v142, s31, v142
    v_mul_f32 v143, s31, v143
    v_cvt_pk_bf16_f32 v72, v136, v137
    v_cvt_pk_bf16_f32 v73, v138, v139
    v_cvt_pk_bf16_f32 v74, v140, v141
    v_cvt_pk_bf16_f32 v75, v142, v143
    ds_write_b128 v30, v[72:75] offset:0
    v_mul_f32 v152, s31, v152
    v_mul_f32 v153, s31, v153
    v_mul_f32 v154, s31, v154
    v_mul_f32 v155, s31, v155
    v_mul_f32 v156, s31, v156
    v_mul_f32 v157, s31, v157
    v_mul_f32 v158, s31, v158
    v_mul_f32 v159, s31, v159
    v_cvt_pk_bf16_f32 v76, v152, v153
    v_cvt_pk_bf16_f32 v77, v154, v155
    v_cvt_pk_bf16_f32 v78, v156, v157
    v_cvt_pk_bf16_f32 v79, v158, v159
    ds_write_b128 v30, v[76:79] offset:8192
    v_xor_b32 v30, 64, v29
    v_mul_f32 v160, s31, v160
    v_mul_f32 v161, s31, v161
    v_mul_f32 v162, s31, v162
    v_mul_f32 v163, s31, v163
    v_mul_f32 v164, s31, v164
    v_mul_f32 v165, s31, v165
    v_mul_f32 v166, s31, v166
    v_mul_f32 v167, s31, v167
    v_cvt_pk_bf16_f32 v80, v160, v161
    v_cvt_pk_bf16_f32 v81, v162, v163
    v_cvt_pk_bf16_f32 v82, v164, v165
    v_cvt_pk_bf16_f32 v83, v166, v167
    ds_write_b128 v30, v[80:83] offset:0
    v_mul_f32 v176, s31, v176
    v_mul_f32 v177, s31, v177
    v_mul_f32 v178, s31, v178
    v_mul_f32 v179, s31, v179
    v_mul_f32 v180, s31, v180
    v_mul_f32 v181, s31, v181
    v_mul_f32 v182, s31, v182
    v_mul_f32 v183, s31, v183
    v_cvt_pk_bf16_f32 v84, v176, v177
    v_cvt_pk_bf16_f32 v85, v178, v179
    v_cvt_pk_bf16_f32 v86, v180, v181
    v_cvt_pk_bf16_f32 v87, v182, v183
    ds_write_b128 v30, v[84:87] offset:8192
    v_xor_b32 v30, 96, v29
    v_mul_f32 v168, s31, v168
    v_mul_f32 v169, s31, v169
    v_mul_f32 v170, s31, v170
    v_mul_f32 v171, s31, v171
    v_mul_f32 v172, s31, v172
    v_mul_f32 v173, s31, v173
    v_mul_f32 v174, s31, v174
    v_mul_f32 v175, s31, v175
    v_cvt_pk_bf16_f32 v88, v168, v169
    v_cvt_pk_bf16_f32 v89, v170, v171
    v_cvt_pk_bf16_f32 v90, v172, v173
    v_cvt_pk_bf16_f32 v91, v174, v175
    ds_write_b128 v30, v[88:91] offset:0
    v_mul_f32 v184, s31, v184
    v_mul_f32 v185, s31, v185
    v_mul_f32 v186, s31, v186
    v_mul_f32 v187, s31, v187
    v_mul_f32 v188, s31, v188
    v_mul_f32 v189, s31, v189
    v_mul_f32 v190, s31, v190
    v_mul_f32 v191, s31, v191
    v_cvt_pk_bf16_f32 v92, v184, v185
    v_cvt_pk_bf16_f32 v93, v186, v187
    v_cvt_pk_bf16_f32 v94, v188, v189
    v_cvt_pk_bf16_f32 v95, v190, v191
    ds_write_b128 v30, v[92:95] offset:8192
    s_waitcnt lgkmcnt(0)
    s_barrier
    v_add_u32 v29, s37, v28
    ds_read_b128 v[128:131], v29 offset:0
    ds_read_b128 v[160:163], v29 offset:8192
    v_xor_b32 v30, 32, v29
    ds_read_b128 v[132:135], v30 offset:0
    ds_read_b128 v[164:167], v30 offset:8192
    v_xor_b32 v30, 64, v29
    ds_read_b128 v[136:139], v30 offset:0
    ds_read_b128 v[168:171], v30 offset:8192
    v_xor_b32 v30, 96, v29
    ds_read_b128 v[140:143], v30 offset:0
    ds_read_b128 v[172:175], v30 offset:8192
    v_xor_b32 v30, 128, v29
    ds_read_b128 v[144:147], v30 offset:0
    ds_read_b128 v[176:179], v30 offset:8192
    v_xor_b32 v30, 160, v29
    ds_read_b128 v[148:151], v30 offset:0
    ds_read_b128 v[180:183], v30 offset:8192
    s_waitcnt lgkmcnt(4)
    v_xor_b32 v30, 192, v29
    ds_read_b128 v[152:155], v30 offset:0
    ds_read_b128 v[184:187], v30 offset:8192
    v_xor_b32 v30, 224, v29
    ds_read_b128 v[156:159], v30 offset:0
    ds_read_b128 v[188:191], v30 offset:8192
    s_waitcnt lgkmcnt(0)
    s_barrier
    s_lshr_b32 s45, s2, 3
    s_bfe_u32 s77, s45, 0x20002
    s_and_b32 s78, s45, 3
    s_mov_b32 s16, s56
    s_mov_b32 s17, s57
    s_lshl_b32 s30, s3, 19
    s_lshl_b32 s59, s78, 8
    s_add_u32 s30, s30, s59
    v_lshrrev_b32 v246, 4, v0
    v_and_b32 v247, 15, v0
    v_lshlrev_b32 v252, 2, v246
    v_xor_b32 v247, v247, v252
    s_lshl_b32 s37, s24, 1
    s_and_b32 s37, s37, 3
    v_xor_b32 v247, s37, v247
    v_lshlrev_b32 v247, 4, v247
    s_lshl_b32 s37, s24, 3
    v_add_u32 v246, s37, v246
    v_lshlrev_b32 v246, 10, v246
    v_add_u32 v252, v246, v247
    v_xor_b32 v247, 16, v247
    v_add_u32 v253, v246, v247
    v_add_u32 v253, 3072, v253
    v_min_u32 v246, 12, v0
    v_lshlrev_b32 v246, 21, v246
    buffer_load_dword v247, v246, s[20:23], 0 offen sc1
    v_and_b32 v246, 15, v0
    v_lshlrev_b32 v246, 16, v246
    buffer_load_dword v248, v246, s[72:75], 0 offen sc1
    v_mov_b32 v246, 0
    buffer_load_dwordx2 v[244:245], v246, s[68:71], 0 offen sc1
    s_waitcnt vmcnt(27)
    ds_read_b128 v[64:67], v224 offset:0
    ds_read_b128 v[68:71], v225 offset:0
    ds_read_b128 v[72:75], v226 offset:0
    ds_read_b128 v[76:79], v227 offset:0
    ds_read_b128 v[80:83], v228 offset:0
    ds_read_b128 v[84:87], v229 offset:0
    ds_read_b128 v[88:91], v230 offset:0
    ds_read_b128 v[92:95], v231 offset:0
    s_mov_b32 s27, 0
L_tile_b:
    s_waitcnt vmcnt(16) lgkmcnt(0)
    v_mfma_f32_32x32x16_bf16 v[96:111], v[64:67], v[128:131], v[192:207]
    ds_read_b64_tr_b16 v[32:33], v232 offset:8192
    ds_read_b64_tr_b16 v[36:37], v232 offset:12288
    ds_read_b64_tr_b16 v[34:35], v233 offset:10240
    v_mfma_f32_32x32x16_bf16 v[96:111], v[68:71], v[132:135], v[96:111]
    ds_read_b64_tr_b16 v[38:39], v233 offset:14336
    ds_read_b64_tr_b16 v[40:41], v234 offset:8192
    ds_read_b64_tr_b16 v[44:45], v234 offset:12288
    v_mfma_f32_32x32x16_bf16 v[96:111], v[72:75], v[136:139], v[96:111]
    ds_read_b64_tr_b16 v[42:43], v235 offset:10240
    ds_read_b64_tr_b16 v[46:47], v235 offset:14336
    s_waitcnt lgkmcnt(4)
    v_mfma_f32_32x32x16_bf16 v[96:111], v[76:79], v[140:143], v[96:111]
    s_add_u32 m0, s28, 0
    s_nop 0
    buffer_load_dwordx4 v5, s[4:7], s26 offen offset:0 nt lds
    v_mfma_f32_32x32x16_bf16 v[96:111], v[80:83], v[144:147], v[96:111]
    ds_read_b64_tr_b16 v[48:49], v236 offset:8192
    ds_read_b64_tr_b16 v[52:53], v236 offset:12288
    ds_read_b64_tr_b16 v[50:51], v237 offset:10240
    v_mfma_f32_32x32x16_bf16 v[96:111], v[84:87], v[148:151], v[96:111]
    ds_read_b64_tr_b16 v[54:55], v237 offset:14336
    ds_read_b64_tr_b16 v[56:57], v238 offset:8192
    ds_read_b64_tr_b16 v[60:61], v238 offset:12288
    v_mfma_f32_32x32x16_bf16 v[96:111], v[88:91], v[152:155], v[96:111]
    ds_read_b64_tr_b16 v[58:59], v239 offset:10240
    ds_read_b64_tr_b16 v[62:63], v239 offset:14336
    buffer_load_dwordx4 v6, s[4:7], s26 offen offset:1024 nt lds
    v_mfma_f32_32x32x16_bf16 v[96:111], v[92:95], v[156:159], v[96:111]
    buffer_load_dwordx4 v7, s[4:7], s26 offen offset:2048 nt lds
    buffer_load_dwordx4 v8, s[4:7], s26 offen offset:3072 nt lds
    v_mfma_f32_32x32x16_bf16 v[112:127], v[64:67], v[160:163], v[208:223]
    s_add_u32 m0, s28, 4096
    s_add_u32 s37, s26, 4096
    buffer_load_dwordx4 v5, s[4:7], s37 offen offset:0 nt lds
    buffer_load_dwordx4 v6, s[4:7], s37 offen offset:1024 nt lds
    buffer_load_dwordx4 v7, s[4:7], s37 offen offset:2048 nt lds
    buffer_load_dwordx4 v8, s[4:7], s37 offen offset:3072 nt lds
    v_mfma_f32_32x32x16_bf16 v[112:127], v[68:71], v[164:167], v[112:127]
    s_nop 3
    v_max3_f32 v18, v96, v97, v98
    v_max3_f32 v19, v99, v100, v101
    v_max3_f32 v20, v102, v103, v104
    v_max3_f32 v21, v105, v106, v107
    v_mfma_f32_32x32x16_bf16 v[112:127], v[72:75], v[168:171], v[112:127]
    v_max3_f32 v22, v108, v109, v110
    v_max3_f32 v18, v18, v19, v111
    v_max3_f32 v20, v20, v21, v22
    v_max_f32 v17, v18, v20
    v_cmp_lt_f32 vcc, s41, v17
    v_mfma_f32_32x32x16_bf16 v[112:127], v[76:79], v[172:175], v[112:127]
    s_cbranch_vccnz L_slow_b00
L_back_b00:
    v_exp_f32 v96, v96
    v_exp_f32 v97, v97
    v_exp_f32 v98, v98
    v_exp_f32 v99, v99
    v_mfma_f32_32x32x16_bf16 v[112:127], v[80:83], v[176:179], v[112:127]
    v_cvt_pk_bf16_f32 v96, v96, v97
    v_exp_f32 v100, v100
    v_exp_f32 v101, v101
    v_cvt_pk_bf16_f32 v97, v98, v99
    v_exp_f32 v102, v102
    v_exp_f32 v103, v103
    v_mfma_f32_32x32x16_bf16 v[112:127], v[84:87], v[180:183], v[112:127]
    v_cvt_pk_bf16_f32 v98, v100, v101
    v_exp_f32 v104, v104
    v_exp_f32 v105, v105
    v_cvt_pk_bf16_f32 v99, v102, v103
    v_exp_f32 v106, v106
    v_mfma_f32_32x32x16_bf16 v[112:127], v[88:91], v[184:187], v[112:127]
    v_exp_f32 v107, v107
    v_cvt_pk_bf16_f32 v100, v104, v105
    v_exp_f32 v108, v108
    v_exp_f32 v109, v109
    v_cvt_pk_bf16_f32 v101, v106, v107
    v_mfma_f32_32x32x16_bf16 v[112:127], v[92:95], v[188:191], v[112:127]
    v_exp_f32 v110, v110
    v_exp_f32 v111, v111
    v_cvt_pk_bf16_f32 v102, v108, v109
    s_nop 0
    v_cvt_pk_bf16_f32 v103, v110, v111
    s_waitcnt lgkmcnt(0)
    s_nop 0
    v_mfma_f32_32x32x16_bf16 a[0:15], v[32:35], v[96:99], a[0:15]
    s_add_u32 m0, s28, 8192
    s_nop 0
    buffer_load_dwordx4 v5, s[8:11], s26 offen offset:0 nt lds
    buffer_load_dwordx4 v6, s[8:11], s26 offen offset:1024 nt lds
    buffer_load_dwordx4 v7, s[8:11], s26 offen offset:2048 nt lds
    v_mfma_f32_32x32x16_bf16 a[16:31], v[40:43], v[96:99], a[16:31]
    buffer_load_dwordx4 v8, s[8:11], s26 offen offset:3072 nt lds
    s_nop 3
    v_max3_f32 v18, v112, v113, v114
    v_max3_f32 v19, v115, v116, v117
    v_max3_f32 v20, v118, v119, v120
    v_mfma_f32_32x32x16_bf16 a[32:47], v[48:51], v[96:99], a[32:47]
    v_max3_f32 v21, v121, v122, v123
    v_max3_f32 v22, v124, v125, v126
    v_max3_f32 v18, v18, v19, v127
    v_max3_f32 v20, v20, v21, v22
    v_max_f32 v17, v18, v20
    v_mfma_f32_32x32x16_bf16 a[48:63], v[56:59], v[96:99], a[48:63]
    v_cmp_lt_f32 vcc, s41, v17
    s_cbranch_vccnz L_slow_b01
L_back_b01:
    s_add_u32 m0, s28, 12288
    s_add_u32 s37, s26, 4096
    buffer_load_dwordx4 v5, s[8:11], s37 offen offset:0 nt lds
    v_mfma_f32_32x32x16_bf16 a[128:143], v[240:243], v[96:99], a[128:143]
    v_exp_f32 v112, v112
    v_exp_f32 v113, v113
    v_exp_f32 v114, v114
    v_exp_f32 v115, v115
    v_mfma_f32_32x32x16_bf16 a[0:15], v[36:39], v[100:103], a[0:15]
    v_cvt_pk_bf16_f32 v112, v112, v113
    v_exp_f32 v116, v116
    v_exp_f32 v117, v117
    v_cvt_pk_bf16_f32 v113, v114, v115
    v_exp_f32 v118, v118
    v_mfma_f32_32x32x16_bf16 a[16:31], v[44:47], v[100:103], a[16:31]
    v_exp_f32 v119, v119
    v_cvt_pk_bf16_f32 v114, v116, v117
    v_exp_f32 v120, v120
    buffer_load_dwordx4 v6, s[8:11], s37 offen offset:1024 nt lds
    buffer_load_dwordx4 v7, s[8:11], s37 offen offset:2048 nt lds
    v_mfma_f32_32x32x16_bf16 a[32:47], v[52:55], v[100:103], a[32:47]
    buffer_load_dwordx4 v8, s[8:11], s37 offen offset:3072 nt lds
    v_exp_f32 v121, v121
    v_cvt_pk_bf16_f32 v115, v118, v119
    v_exp_f32 v122, v122
    v_exp_f32 v123, v123
    v_mfma_f32_32x32x16_bf16 a[48:63], v[60:63], v[100:103], a[48:63]
    v_cvt_pk_bf16_f32 v116, v120, v121
    v_exp_f32 v124, v124
    v_exp_f32 v125, v125
    v_cvt_pk_bf16_f32 v117, v122, v123
    v_exp_f32 v126, v126
    v_mfma_f32_32x32x16_bf16 a[128:143], v[240:243], v[100:103], a[128:143]
    v_exp_f32 v127, v127
    v_cvt_pk_bf16_f32 v118, v124, v125
    s_nop 0
    v_cvt_pk_bf16_f32 v119, v126, v127
    s_nop 1
    v_mfma_f32_32x32x16_bf16 a[64:79], v[32:35], v[112:115], a[64:79]
    s_add_u32 s26, s26, 16384
    s_add_u32 s27, s27, 1
    v_mfma_f32_32x32x16_bf16 a[80:95], v[40:43], v[112:115], a[80:95]
    s_mov_b32 s41, s42
    v_mfma_f32_32x32x16_bf16 a[96:111], v[48:51], v[112:115], a[96:111]
    s_waitcnt vmcnt(24)
    v_mfma_f32_32x32x16_bf16 a[112:127], v[56:59], v[112:115], a[112:127]
    ds_read_b128 v[64:67], v224 offset:16384
    v_mfma_f32_32x32x16_bf16 a[144:159], v[240:243], v[112:115], a[144:159]
    ds_read_b128 v[68:71], v225 offset:16384
    v_mfma_f32_32x32x16_bf16 a[64:79], v[36:39], v[116:119], a[64:79]
    ds_read_b128 v[72:75], v226 offset:16384
    ds_read_b128 v[76:79], v227 offset:16384
    v_mfma_f32_32x32x16_bf16 a[80:95], v[44:47], v[116:119], a[80:95]
    ds_read_b128 v[80:83], v228 offset:16384
    v_mfma_f32_32x32x16_bf16 a[96:111], v[52:55], v[116:119], a[96:111]
    ds_read_b128 v[84:87], v229 offset:16384
    v_mfma_f32_32x32x16_bf16 a[112:127], v[60:63], v[116:119], a[112:127]
    ds_read_b128 v[88:91], v230 offset:16384
    v_mfma_f32_32x32x16_bf16 a[144:159], v[240:243], v[116:119], a[144:159]
    ds_read_b128 v[92:95], v231 offset:16384
    s_waitcnt vmcnt(16) lgkmcnt(0)
    v_mfma_f32_32x32x16_bf16 v[96:111], v[64:67], v[128:131], v[192:207]
    ds_read_b64_tr_b16 v[32:33], v232 offset:24576
    ds_read_b64_tr_b16 v[36:37], v232 offset:28672
    ds_read_b64_tr_b16 v[34:35], v233 offset:26624
    v_mfma_f32_32x32x16_bf16 v[96:111], v[68:71], v[132:135], v[96:111]
    ds_read_b64_tr_b16 v[38:39], v233 offset:30720
    ds_read_b64_tr_b16 v[40:41], v234 offset:24576
    ds_read_b64_tr_b16 v[44:45], v234 offset:28672
    v_mfma_f32_32x32x16_bf16 v[96:111], v[72:75], v[136:139], v[96:111]
    ds_read_b64_tr_b16 v[42:43], v235 offset:26624
    ds_read_b64_tr_b16 v[46:47], v235 offset:30720
    s_waitcnt lgkmcnt(4)
    v_mfma_f32_32x32x16_bf16 v[96:111], v[76:79], v[140:143], v[96:111]
    s_add_u32 m0, s28, 16384
    s_nop 0
    buffer_load_dwordx4 v5, s[4:7], s26 offen offset:0 nt lds
    v_mfma_f32_32x32x16_bf16 v[96:111], v[80:83], v[144:147], v[96:111]
    ds_read_b64_tr_b16 v[48:49], v236 offset:24576
    ds_read_b64_tr_b16 v[52:53], v236 offset:28672
    ds_read_b64_tr_b16 v[50:51], v237 offset:26624
    v_mfma_f32_32x32x16_bf16 v[96:111], v[84:87], v[148:151], v[96:111]
    ds_read_b64_tr_b16 v[54:55], v237 offset:30720
    ds_read_b64_tr_b16 v[56:57], v238 offset:24576
    ds_read_b64_tr_b16 v[60:61], v238 offset:28672
    v_mfma_f32_32x32x16_bf16 v[96:111], v[88:91], v[152:155], v[96:111]
    ds_read_b64_tr_b16 v[58:59], v239 offset:26624
    ds_read_b64_tr_b16 v[62:63], v239 offset:30720
    buffer_load_dwordx4 v6, s[4:7], s26 offen offset:1024 nt lds
    v_mfma_f32_32x32x16_bf16 v[96:111], v[92:95], v[156:159], v[96:111]
    buffer_load_dwordx4 v7, s[4:7], s26 offen offset:2048 nt lds
    buffer_load_dwordx4 v8, s[4:7], s26 offen offset:3072 nt lds
    v_mfma_f32_32x32x16_bf16 v[112:127], v[64:67], v[160:163], v[208:223]
    s_add_u32 m0, s28, 20480
    s_add_u32 s37, s26, 4096
    buffer_load_dwordx4 v5, s[4:7], s37 offen offset:0 nt lds
    buffer_load_dwordx4 v6, s[4:7], s37 offen offset:1024 nt lds
    buffer_load_dwordx4 v7, s[4:7], s37 offen offset:2048 nt lds
    buffer_load_dwordx4 v8, s[4:7], s37 offen offset:3072 nt lds
    v_mfma_f32_32x32x16_bf16 v[112:127], v[68:71], v[164:167], v[112:127]
    s_nop 3
    v_max3_f32 v18, v96, v97, v98
    v_max3_f32 v19, v99, v100, v101
    v_max3_f32 v20, v102, v103, v104
    v_max3_f32 v21, v105, v106, v107
    v_mfma_f32_32x32x16_bf16 v[112:127], v[72:75], v[168:171], v[112:127]
    v_max3_f32 v22, v108, v109, v110
    v_max3_f32 v18, v18, v19, v111
    v_max3_f32 v20, v20, v21, v22
    v_max_f32 v17, v18, v20
    v_cmp_lt_f32 vcc, s41, v17
    v_mfma_f32_32x32x16_bf16 v[112:127], v[76:79], v[172:175], v[112:127]
    s_cbranch_vccnz L_slow_b10
L_back_b10:
    v_exp_f32 v96, v96
    v_exp_f32 v97, v97
    v_exp_f32 v98, v98
    v_exp_f32 v99, v99
    v_mfma_f32_32x32x16_bf16 v[112:127], v[80:83], v[176:179], v[112:127]
    v_cvt_pk_bf16_f32 v96, v96, v97
    v_exp_f32 v100, v100
    v_exp_f32 v101, v101
    v_cvt_pk_bf16_f32 v97, v98, v99
    v_exp_f32 v102, v102
    v_exp_f32 v103, v103
    v_mfma_f32_32x32x16_bf16 v[112:127], v[84:87], v[180:183], v[112:127]
    v_cvt_pk_bf16_f32 v98, v100, v101
    v_exp_f32 v104, v104
    v_exp_f32 v105, v105
    v_cvt_pk_bf16_f32 v99, v102, v103
    v_exp_f32 v106, v106
    v_mfma_f32_32x32x16_bf16 v[112:127], v[88:91], v[184:187], v[112:127]
    v_exp_f32 v107, v107
    v_cvt_pk_bf16_f32 v100, v104, v105
    v_exp_f32 v108, v108
    v_exp_f32 v109, v109
    v_cvt_pk_bf16_f32 v101, v106, v107
    v_mfma_f32_32x32x16_bf16 v[112:127], v[92:95], v[188:191], v[112:127]
    v_exp_f32 v110, v110
    v_exp_f32 v111, v111
    v_cvt_pk_bf16_f32 v102, v108, v109
    s_nop 0
    v_cvt_pk_bf16_f32 v103, v110, v111
    s_waitcnt lgkmcnt(0)
    s_nop 0
    v_mfma_f32_32x32x16_bf16 a[0:15], v[32:35], v[96:99], a[0:15]
    s_add_u32 m0, s28, 24576
    s_nop 0
    buffer_load_dwordx4 v5, s[8:11], s26 offen offset:0 nt lds
    buffer_load_dwordx4 v6, s[8:11], s26 offen offset:1024 nt lds
    buffer_load_dwordx4 v7, s[8:11], s26 offen offset:2048 nt lds
    v_mfma_f32_32x32x16_bf16 a[16:31], v[40:43], v[96:99], a[16:31]
    buffer_load_dwordx4 v8, s[8:11], s26 offen offset:3072 nt lds
    s_nop 3
    v_max3_f32 v18, v112, v113, v114
    v_max3_f32 v19, v115, v116, v117
    v_max3_f32 v20, v118, v119, v120
    v_mfma_f32_32x32x16_bf16 a[32:47], v[48:51], v[96:99], a[32:47]
    v_max3_f32 v21, v121, v122, v123
    v_max3_f32 v22, v124, v125, v126
    v_max3_f32 v18, v18, v19, v127
    v_max3_f32 v20, v20, v21, v22
    v_max_f32 v17, v18, v20
    v_mfma_f32_32x32x16_bf16 a[48:63], v[56:59], v[96:99], a[48:63]
    v_cmp_lt_f32 vcc, s41, v17
    s_cbranch_vccnz L_slow_b11
L_back_b11:
    s_add_u32 m0, s28, 28672
    s_add_u32 s37, s26, 4096
    buffer_load_dwordx4 v5, s[8:11], s37 offen offset:0 nt lds
    v_mfma_f32_32x32x16_bf16 a[128:143], v[240:243], v[96:99], a[128:143]
    v_exp_f32 v112, v112
    v_exp_f32 v113, v113
    v_exp_f32 v114, v114
    v_exp_f32 v115, v115
    v_mfma_f32_32x32x16_bf16 a[0:15], v[36:39], v[100:103], a[0:15]
    v_cvt_pk_bf16_f32 v112, v112, v113
    v_exp_f32 v116, v116
    v_exp_f32 v117, v117
    v_cvt_pk_bf16_f32 v113, v114, v115
    v_exp_f32 v118, v118
    v_mfma_f32_32x32x16_bf16 a[16:31], v[44:47], v[100:103], a[16:31]
    v_exp_f32 v119, v119
    v_cvt_pk_bf16_f32 v114, v116, v117
    v_exp_f32 v120, v120
    buffer_load_dwordx4 v6, s[8:11], s37 offen offset:1024 nt lds
    buffer_load_dwordx4 v7, s[8:11], s37 offen offset:2048 nt lds
    v_mfma_f32_32x32x16_bf16 a[32:47], v[52:55], v[100:103], a[32:47]
    buffer_load_dwordx4 v8, s[8:11], s37 offen offset:3072 nt lds
    v_exp_f32 v121, v121
    v_cvt_pk_bf16_f32 v115, v118, v119
    v_exp_f32 v122, v122
    v_exp_f32 v123, v123
    v_mfma_f32_32x32x16_bf16 a[48:63], v[60:63], v[100:103], a[48:63]
    v_cvt_pk_bf16_f32 v116, v120, v121
    v_exp_f32 v124, v124
    v_exp_f32 v125, v125
    v_cvt_pk_bf16_f32 v117, v122, v123
    v_exp_f32 v126, v126
    v_mfma_f32_32x32x16_bf16 a[128:143], v[240:243], v[100:103], a[128:143]
    v_exp_f32 v127, v127
    v_cvt_pk_bf16_f32 v118, v124, v125
    s_nop 0
    v_cvt_pk_bf16_f32 v119, v126, v127
    s_nop 1
    v_mfma_f32_32x32x16_bf16 a[64:79], v[32:35], v[112:115], a[64:79]
    s_add_u32 s26, s26, 16384
    s_add_u32 s27, s27, 1
    v_mfma_f32_32x32x16_bf16 a[80:95], v[40:43], v[112:115], a[80:95]
    s_mov_b32 s41, s42
    v_mfma_f32_32x32x16_bf16 a[96:111], v[48:51], v[112:115], a[96:111]
    s_waitcnt vmcnt(24)
    v_mfma_f32_32x32x16_bf16 a[112:127], v[56:59], v[112:115], a[112:127]
    ds_read_b128 v[64:67], v224 offset:0
    v_mfma_f32_32x32x16_bf16 a[144:159], v[240:243], v[112:115], a[144:159]
    ds_read_b128 v[68:71], v225 offset:0
    v_mfma_f32_32x32x16_bf16 a[64:79], v[36:39], v[116:119], a[64:79]
    ds_read_b128 v[72:75], v226 offset:0
    ds_read_b128 v[76:79], v227 offset:0
    v_mfma_f32_32x32x16_bf16 a[80:95], v[44:47], v[116:119], a[80:95]
    ds_read_b128 v[80:83], v228 offset:0
    v_mfma_f32_32x32x16_bf16 a[96:111], v[52:55], v[116:119], a[96:111]
    ds_read_b128 v[84:87], v229 offset:0
    v_mfma_f32_32x32x16_bf16 a[112:127], v[60:63], v[116:119], a[112:127]
    ds_read_b128 v[88:91], v230 offset:0
    v_mfma_f32_32x32x16_bf16 a[144:159], v[240:243], v[116:119], a[144:159]
    ds_read_b128 v[92:95], v231 offset:0
    s_cmp_lt_u32 s27, 16
    s_cbranch_scc1 L_tile_b
    s_waitcnt lgkmcnt(0)
    s_nop 7
    s_nop 7
    v_accvgpr_read_b32 v21, a128
    v_sub_f32 v20, 0, v192
    v_accvgpr_read_b32 v23, a144
    v_sub_f32 v22, 0, v208
    s_add_u32 s37, s28, 16384
    v_lshlrev_b32 v40, 3, v0
    v_add_u32 v41, s37, v40
    v_add_u32 v42, s28, v27
    v_xor_b32 v43, 32768, v42
    s_waitcnt vmcnt(0)
    ds_write_b64 v41, v[20:21]
    ds_write_b64 v41, v[22:23] offset:512
    v_xor_b32 v41, 32768, v41
    s_cmp_eq_u32 s47, 1
    s_cbranch_scc1 L_cmb1_b
    ds_write_b128 v42, a[32:35] offset:0
    ds_write_b128 v42, a[36:39] offset:1024
    ds_write_b128 v42, a[40:43] offset:2048
    ds_write_b128 v42, a[44:47] offset:3072
    ds_write_b128 v42, a[48:51] offset:4096
    ds_write_b128 v42, a[52:55] offset:5120
    ds_write_b128 v42, a[56:59] offset:6144
    ds_write_b128 v42, a[60:63] offset:7168
    ds_write_b128 v42, a[96:99] offset:8192
    ds_write_b128 v42, a[100:103] offset:9216
    ds_write_b128 v42, a[104:107] offset:10240
    ds_write_b128 v42, a[108:111] offset:11264
    ds_write_b128 v42, a[112:115] offset:12288
    ds_write_b128 v42, a[116:119] offset:13312
    ds_write_b128 v42, a[120:123] offset:14336
    ds_write_b128 v42, a[124:127] offset:15360
    v_accvgpr_read_b32 v128, a0
    v_accvgpr_read_b32 v129, a1
    v_accvgpr_read_b32 v130, a2
    v_accvgpr_read_b32 v131, a3
    v_accvgpr_read_b32 v132, a4
    v_accvgpr_read_b32 v133, a5
    v_accvgpr_read_b32 v134, a6
    v_accvgpr_read_b32 v135, a7
    v_accvgpr_read_b32 v136, a8
    v_accvgpr_read_b32 v137, a9
    v_accvgpr_read_b32 v138, a10
    v_accvgpr_read_b32 v139, a11
    v_accvgpr_read_b32 v140, a12
    v_accvgpr_read_b32 v141, a13
    v_accvgpr_read_b32 v142, a14
    v_accvgpr_read_b32 v143, a15
    v_accvgpr_read_b32 v144, a16
    v_accvgpr_read_b32 v145, a17
    v_accvgpr_read_b32 v146, a18
    v_accvgpr_read_b32 v147, a19
    v_accvgpr_read_b32 v148, a20
    v_accvgpr_read_b32 v149, a21
    v_accvgpr_read_b32 v150, a22
    v_accvgpr_read_b32 v151, a23
    v_accvgpr_read_b32 v152, a24
    v_accvgpr_read_b32 v153, a25
    v_accvgpr_read_b32 v154, a26
    v_accvgpr_read_b32 v155, a27
    v_accvgpr_read_b32 v156, a28
    v_accvgpr_read_b32 v157, a29
    v_accvgpr_read_b32 v158, a30
    v_accvgpr_read_b32 v159, a31
    v_accvgpr_read_b32 v160, a64
    v_accvgpr_read_b32 v161, a65
    v_accvgpr_read_b32 v162, a66
    v_accvgpr_read_b32 v163, a67
    v_accvgpr_read_b32 v164, a68
    v_accvgpr_read_b32 v165, a69
    v_accvgpr_read_b32 v166, a70
    v_accvgpr_read_b32 v167, a71
    v_accvgpr_read_b32 v168, a72
    v_accvgpr_read_b32 v169, a73
    v_accvgpr_read_b32 v170, a74
    v_accvgpr_read_b32 v171, a75
    v_accvgpr_read_b32 v172, a76
    v_accvgpr_read_b32 v173, a77
    v_accvgpr_read_b32 v174, a78
    v_accvgpr_read_b32 v175, a79
    v_accvgpr_read_b32 v176, a80
    v_accvgpr_read_b32 v177, a81
    v_accvgpr_read_b32 v178, a82
    v_accvgpr_read_b32 v179, a83
    v_accvgpr_read_b32 v180, a84
    v_accvgpr_read_b32 v181, a85
    v_accvgpr_read_b32 v182, a86
    v_accvgpr_read_b32 v183, a87
    v_accvgpr_read_b32 v184, a88
    v_accvgpr_read_b32 v185, a89
    v_accvgpr_read_b32 v186, a90
    v_accvgpr_read_b32 v187, a91
    v_accvgpr_read_b32 v188, a92
    v_accvgpr_read_b32 v189, a93
    v_accvgpr_read_b32 v190, a94
    v_accvgpr_read_b32 v191, a95
    s_branch L_cmb2_b
L_cmb1_b:
    ds_write_b128 v42, a[0:3] offset:0
    ds_write_b128 v42, a[4:7] offset:1024
    ds_write_b128 v42, a[8:11] offset:2048
    ds_write_b128 v42, a[12:15] offset:3072
    ds_write_b128 v42, a[16:19] offset:4096
    ds_write_b128 v42, a[20:23] offset:5120
    ds_write_b128 v42, a[24:27] offset:6144
    ds_write_b128 v42, a[28:31] offset:7168
    ds_write_b128 v42, a[64:67] offset:8192
    ds_write_b128 v42, a[68:71] offset:9216
    ds_write_b128 v42, a[72:75] offset:10240
    ds_write_b128 v42, a[76:79] offset:11264
    ds_write_b128 v42, a[80:83] offset:12288
    ds_write_b128 v42, a[84:87] offset:13312
    ds_write_b128 v42, a[88:91] offset:14336
    ds_write_b128 v42, a[92:95] offset:15360
    v_accvgpr_read_b32 v128, a32
    v_accvgpr_read_b32 v129, a33
    v_accvgpr_read_b32 v130, a34
    v_accvgpr_read_b32 v131, a35
    v_accvgpr_read_b32 v132, a36
    v_accvgpr_read_b32 v133, a37
    v_accvgpr_read_b32 v134, a38
    v_accvgpr_read_b32 v135, a39
    v_accvgpr_read_b32 v136, a40
    v_accvgpr_read_b32 v137, a41
    v_accvgpr_read_b32 v138, a42
    v_accvgpr_read_b32 v139, a43
    v_accvgpr_read_b32 v140, a44
    v_accvgpr_read_b32 v141, a45
    v_accvgpr_read_b32 v142, a46
    v_accvgpr_read_b32 v143, a47
    v_accvgpr_read_b32 v144, a48
    v_accvgpr_read_b32 v145, a49
    v_accvgpr_read_b32 v146, a50
    v_accvgpr_read_b32 v147, a51
    v_accvgpr_read_b32 v148, a52
    v_accvgpr_read_b32 v149, a53
    v_accvgpr_read_b32 v150, a54
    v_accvgpr_read_b32 v151, a55
    v_accvgpr_read_b32 v152, a56
    v_accvgpr_read_b32 v153, a57
    v_accvgpr_read_b32 v154, a58
    v_accvgpr_read_b32 v155, a59
    v_accvgpr_read_b32 v156, a60
    v_accvgpr_read_b32 v157, a61
    v_accvgpr_read_b32 v158, a62
    v_accvgpr_read_b32 v159, a63
    v_accvgpr_read_b32 v160, a96
    v_accvgpr_read_b32 v161, a97
    v_accvgpr_read_b32 v162, a98
    v_accvgpr_read_b32 v163, a99
    v_accvgpr_read_b32 v164, a100
    v_accvgpr_read_b32 v165, a101
    v_accvgpr_read_b32 v166, a102
    v_accvgpr_read_b32 v167, a103
    v_accvgpr_read_b32 v168, a104
    v_accvgpr_read_b32 v169, a105
    v_accvgpr_read_b32 v170, a106
    v_accvgpr_read_b32 v171, a107
    v_accvgpr_read_b32 v172, a108
    v_accvgpr_read_b32 v173, a109
    v_accvgpr_read_b32 v174, a110
    v_accvgpr_read_b32 v175, a111
    v_accvgpr_read_b32 v176, a112
    v_accvgpr_read_b32 v177, a113
    v_accvgpr_read_b32 v178, a114
    v_accvgpr_read_b32 v179, a115
    v_accvgpr_read_b32 v180, a116
    v_accvgpr_read_b32 v181, a117
    v_accvgpr_read_b32 v182, a118
    v_accvgpr_read_b32 v183, a119
    v_accvgpr_read_b32 v184, a120
    v_accvgpr_read_b32 v185, a121
    v_accvgpr_read_b32 v186, a122
    v_accvgpr_read_b32 v187, a123
    v_accvgpr_read_b32 v188, a124
    v_accvgpr_read_b32 v189, a125
    v_accvgpr_read_b32 v190, a126
    v_accvgpr_read_b32 v191, a127
L_cmb2_b:
    s_waitcnt lgkmcnt(0)
    s_barrier
    ds_read_b64 v[36:37], v41
    ds_read_b64 v[38:39], v41 offset:512
    ds_read_b128 v[64:67], v43 offset:0
    ds_read_b128 v[68:71], v43 offset:1024
    ds_read_b128 v[72:75], v43 offset:2048
    ds_read_b128 v[76:79], v43 offset:3072
    ds_read_b128 v[80:83], v43 offset:4096
    ds_read_b128 v[84:87], v43 offset:5120
    ds_read_b128 v[88:91], v43 offset:6144
    ds_read_b128 v[92:95], v43 offset:7168
    ds_read_b128 v[96:99], v43 offset:8192
    ds_read_b128 v[100:103], v43 offset:9216
    ds_read_b128 v[104:107], v43 offset:10240
    ds_read_b128 v[108:111], v43 offset:11264
    s_waitcnt lgkmcnt(12)
    v_max_f32 v18, v20, v36
    v_sub_f32 v32, v20, v18
    v_sub_f32 v33, v36, v18
    v_exp_f32 v32, v32
    v_exp_f32 v33, v33
    s_nop 0
    v_mul_f32 v19, v32, v21
    v_fmac_f32 v19, v33, v37
    v_rcp_f32 v19, v19
    s_nop 0
    v_mul_f32 v48, v32, v19
    v_mul_f32 v49, v32, v19
    v_mul_f32 v50, v33, v19
    v_mul_f32 v51, v33, v19
    v_mul_f32 v32, v32, v19
    v_mul_f32 v33, v33, v19
    v_max_f32 v18, v22, v38
    v_sub_f32 v34, v22, v18
    v_sub_f32 v35, v38, v18
    v_exp_f32 v34, v34
    v_exp_f32 v35, v35
    s_nop 0
    v_mul_f32 v19, v34, v23
    v_fmac_f32 v19, v35, v39
    v_rcp_f32 v19, v19
    s_nop 0
    v_mul_f32 v52, v34, v19
    v_mul_f32 v53, v34, v19
    v_mul_f32 v54, v35, v19
    v_mul_f32 v55, v35, v19
    v_mul_f32 v34, v34, v19
    v_mul_f32 v35, v35, v19
    ds_read_b128 v[112:115], v43 offset:12288
    ds_read_b128 v[116:119], v43 offset:13312
    ds_read_b128 v[120:123], v43 offset:14336
    ds_read_b128 v[124:127], v43 offset:15360
    s_add_u32 s37, s44, 4096
    v_pk_mul_f32 v[128:129], v[48:49], v[128:129]
    v_pk_mul_f32 v[130:131], v[48:49], v[130:131]
    v_pk_mul_f32 v[132:133], v[48:49], v[132:133]
    v_pk_mul_f32 v[134:135], v[48:49], v[134:135]
    v_pk_mul_f32 v[136:137], v[48:49], v[136:137]
    v_pk_mul_f32 v[138:139], v[48:49], v[138:139]
    v_pk_mul_f32 v[140:141], v[48:49], v[140:141]
    v_pk_mul_f32 v[142:143], v[48:49], v[142:143]
    s_waitcnt lgkmcnt(12)
    v_pk_fma_f32 v[128:129], v[50:51], v[64:65], v[128:129]
    v_pk_fma_f32 v[130:131], v[50:51], v[66:67], v[130:131]
    v_pk_fma_f32 v[132:133], v[50:51], v[68:69], v[132:133]
    v_pk_fma_f32 v[134:135], v[50:51], v[70:71], v[134:135]
    v_pk_fma_f32 v[136:137], v[50:51], v[72:73], v[136:137]
    v_pk_fma_f32 v[138:139], v[50:51], v[74:75], v[138:139]
    v_pk_fma_f32 v[140:141], v[50:51], v[76:77], v[140:141]
    v_pk_fma_f32 v[142:143], v[50:51], v[78:79], v[142:143]
    v_cvt_pk_bf16_f32 v192, v128, v129
    v_cvt_pk_bf16_f32 v193, v130, v131
    v_cvt_pk_bf16_f32 v194, v132, v133
    v_cvt_pk_bf16_f32 v195, v134, v135
    buffer_store_dwordx4 v[192:195], v27, s[20:23], s44 offen offset:0 sc1
    v_cvt_pk_bf16_f32 v196, v136, v137
    v_cvt_pk_bf16_f32 v197, v138, v139
    v_cvt_pk_bf16_f32 v198, v140, v141
    v_cvt_pk_bf16_f32 v199, v142, v143
    buffer_store_dwordx4 v[196:199], v27, s[20:23], s44 offen offset:1024 sc1
    v_pk_mul_f32 v[144:145], v[48:49], v[144:145]
    v_pk_mul_f32 v[146:147], v[48:49], v[146:147]
    v_pk_mul_f32 v[148:149], v[48:49], v[148:149]
    v_pk_mul_f32 v[150:151], v[48:49], v[150:151]
    v_pk_mul_f32 v[152:153], v[48:49], v[152:153]
    v_pk_mul_f32 v[154:155], v[48:49], v[154:155]
    v_pk_mul_f32 v[156:157], v[48:49], v[156:157]
    v_pk_mul_f32 v[158:159], v[48:49], v[158:159]
    s_waitcnt lgkmcnt(8)
    v_pk_fma_f32 v[144:145], v[50:51], v[80:81], v[144:145]
    v_pk_fma_f32 v[146:147], v[50:51], v[82:83], v[146:147]
    v_pk_fma_f32 v[148:149], v[50:51], v[84:85], v[148:149]
    v_pk_fma_f32 v[150:151], v[50:51], v[86:87], v[150:151]
    v_pk_fma_f32 v[152:153], v[50:51], v[88:89], v[152:153]
    v_pk_fma_f32 v[154:155], v[50:51], v[90:91], v[154:155]
    v_pk_fma_f32 v[156:157], v[50:51], v[92:93], v[156:157]
    v_pk_fma_f32 v[158:159], v[50:51], v[94:95], v[158:159]
    v_cvt_pk_bf16_f32 v200, v144, v145
    v_cvt_pk_bf16_f32 v201, v146, v147
    v_cvt_pk_bf16_f32 v202, v148, v149
    v_cvt_pk_bf16_f32 v203, v150, v151
    buffer_store_dwordx4 v[200:203], v27, s[20:23], s44 offen offset:2048 sc1
    v_cvt_pk_bf16_f32 v204, v152, v153
    v_cvt_pk_bf16_f32 v205, v154, v155
    v_cvt_pk_bf16_f32 v206, v156, v157
    v_cvt_pk_bf16_f32 v207, v158, v159
    buffer_store_dwordx4 v[204:207], v27, s[20:23], s44 offen offset:3072 sc1
    v_pk_mul_f32 v[160:161], v[52:53], v[160:161]
    v_pk_mul_f32 v[162:163], v[52:53], v[162:163]
    v_pk_mul_f32 v[164:165], v[52:53], v[164:165]
    v_pk_mul_f32 v[166:167], v[52:53], v[166:167]
    v_pk_mul_f32 v[168:169], v[52:53], v[168:169]
    v_pk_mul_f32 v[170:171], v[52:53], v[170:171]
    v_pk_mul_f32 v[172:173], v[52:53], v[172:173]
    v_pk_mul_f32 v[174:175], v[52:53], v[174:175]
    s_waitcnt lgkmcnt(4)
    v_pk_fma_f32 v[160:161], v[54:55], v[96:97], v[160:161]
    v_pk_fma_f32 v[162:163], v[54:55], v[98:99], v[162:163]
    v_pk_fma_f32 v[164:165], v[54:55], v[100:101], v[164:165]
    v_pk_fma_f32 v[166:167], v[54:55], v[102:103], v[166:167]
    v_pk_fma_f32 v[168:169], v[54:55], v[104:105], v[168:169]
    v_pk_fma_f32 v[170:171], v[54:55], v[106:107], v[170:171]
    v_pk_fma_f32 v[172:173], v[54:55], v[108:109], v[172:173]
    v_pk_fma_f32 v[174:175], v[54:55], v[110:111], v[174:175]
    v_cvt_pk_bf16_f32 v208, v160, v161
    v_cvt_pk_bf16_f32 v209, v162, v163
    v_cvt_pk_bf16_f32 v210, v164, v165
    v_cvt_pk_bf16_f32 v211, v166, v167
    buffer_store_dwordx4 v[208:211], v27, s[20:23], s37 offen offset:0 sc1
    v_cvt_pk_bf16_f32 v212, v168, v169
    v_cvt_pk_bf16_f32 v213, v170, v171
    v_cvt_pk_bf16_f32 v214, v172, v173
    v_cvt_pk_bf16_f32 v215, v174, v175
    buffer_store_dwordx4 v[212:215], v27, s[20:23], s37 offen offset:1024 sc1
    v_pk_mul_f32 v[176:177], v[52:53], v[176:177]
    v_pk_mul_f32 v[178:179], v[52:53], v[178:179]
    v_pk_mul_f32 v[180:181], v[52:53], v[180:181]
    v_pk_mul_f32 v[182:183], v[52:53], v[182:183]
    v_pk_mul_f32 v[184:185], v[52:53], v[184:185]
    v_pk_mul_f32 v[186:187], v[52:53], v[186:187]
    v_pk_mul_f32 v[188:189], v[52:53], v[188:189]
    v_pk_mul_f32 v[190:191], v[52:53], v[190:191]
    s_waitcnt lgkmcnt(0)
    v_pk_fma_f32 v[176:177], v[54:55], v[112:113], v[176:177]
    v_pk_fma_f32 v[178:179], v[54:55], v[114:115], v[178:179]
    v_pk_fma_f32 v[180:181], v[54:55], v[116:117], v[180:181]
    v_pk_fma_f32 v[182:183], v[54:55], v[118:119], v[182:183]
    v_pk_fma_f32 v[184:185], v[54:55], v[120:121], v[184:185]
    v_pk_fma_f32 v[186:187], v[54:55], v[122:123], v[186:187]
    v_pk_fma_f32 v[188:189], v[54:55], v[124:125], v[188:189]
    v_pk_fma_f32 v[190:191], v[54:55], v[126:127], v[190:191]
    v_cvt_pk_bf16_f32 v216, v176, v177
    v_cvt_pk_bf16_f32 v217, v178, v179
    v_cvt_pk_bf16_f32 v218, v180, v181
    v_cvt_pk_bf16_f32 v219, v182, v183
    buffer_store_dwordx4 v[216:219], v27, s[20:23], s37 offen offset:2048 sc1
    v_cvt_pk_bf16_f32 v220, v184, v185
    v_cvt_pk_bf16_f32 v221, v186, v187
    v_cvt_pk_bf16_f32 v222, v188, v189
    v_cvt_pk_bf16_f32 v223, v190, v191
    buffer_store_dwordx4 v[220:223], v27, s[20:23], s37 offen offset:3072 sc1
    s_mov_b32 s85, 0
L_nn_b:
    s_waitcnt vmcnt(0)
    v_cmp_eq_u32 vcc, 0, v244
    s_cbranch_vccz L_nd_b
    v_mov_b32 v246, 0
    buffer_load_dwordx2 v[244:245], v246, s[68:71], 0 offen sc1
    s_add_u32 s85, s85, 1
    s_cmp_lt_u32 s85, 4000000
    s_cbranch_scc1 L_nn_b
L_nd_b:
    s_waitcnt vmcnt(0)
    v_mov_b32 v246, 0
    s_mov_b64 exec, 1
    buffer_store_dwordx2 v[244:245], v246, s[20:23], s89 offen sc1
    s_mov_b64 exec, -1
    s_and_b32 s60, s45, 15
    s_add_u32 s60, s60, 0
    s_lshl_b32 s88, s60, 2
    s_lshr_b32 s59, s3, 1
    s_add_u32 s88, s88, s59
    s_lshl_b32 s88, s88, 6
    s_add_u32 s88, s88, 25174016
    s_lshl_b32 s17, s3, 2
    s_add_u32 s17, s17, s24
    s_lshl_b32 s18, s60, 18
    s_lshl_b32 s19, s17, 10
    s_add_u32 s18, s18, s19
    s_add_u32 s18, s18, 8388608
    s_lshl_b32 s12, s77, 7
    s_lshr_b32 s13, s17, 3
    s_lshl_b32 s13, s13, 5
    s_add_u32 s12, s12, s13
    s_lshl_b32 s12, s12, 11
    s_lshl_b32 s13, s78, 8
    s_add_u32 s12, s12, s13
    s_and_b32 s13, s17, 7
    s_lshl_b32 s13, s13, 5
    s_add_u32 s12, s12, s13
    s_add_u32 s12, s12, 0
    v_lshlrev_b32 v1, 4, v0
    v_and_b32 v2, 31, v0
    v_lshlrev_b32 v2, 11, v2
    v_lshrrev_b32 v3, 5, v0
    v_lshl_add_u32 v2, v3, 4, v2
    s_mov_b32 s14, 0xffff0000
    s_cmp_lg_u32 s24, 0
    s_cbranch_scc1 L_pdone_pa
    v_lshlrev_b32 v246, 3, v0
    v_min_u32 v246, 56, v246
    s_mov_b32 s85, 0
L_poll_pa:
    buffer_load_dwordx2 v[248:249], v246, s[20:23], s88 offen sc1
    s_add_u32 s85, s85, 1
    s_waitcnt vmcnt(0)
    v_cmp_ne_u64 vcc, v[248:249], v[244:245]
    s_cbranch_vccz L_pdone_pa
    s_sleep 2
    s_cmp_lt_u32 s85, 4000000
    s_cbranch_scc1 L_poll_pa
L_pdone_pa:
    s_barrier
    buffer_load_dwordx4 v[64:67], v1, s[20:23], s18 offen sc1
    s_add_u32 s18, s18, 32768
    buffer_load_dwordx4 v[68:71], v1, s[20:23], s18 offen sc1
    s_add_u32 s18, s18, 32768
    buffer_load_dwordx4 v[72:75], v1, s[20:23], s18 offen sc1
    s_add_u32 s18, s18, 32768
    buffer_load_dwordx4 v[76:79], v1, s[20:23], s18 offen sc1
    s_add_u32 s18, s18, 32768
    buffer_load_dwordx4 v[80:83], v1, s[20:23], s18 offen sc1
    s_add_u32 s18, s18, 32768
    buffer_load_dwordx4 v[84:87], v1, s[20:23], s18 offen sc1
    s_add_u32 s18, s18, 32768
    buffer_load_dwordx4 v[88:91], v1, s[20:23], s18 offen sc1
    s_add_u32 s18, s18, 32768
    buffer_load_dwordx4 v[92:95], v1, s[20:23], s18 offen sc1
    s_add_u32 s18, s18, 32768
    s_waitcnt vmcnt(7)
    v_lshlrev_b32 v8, 16, v64
    v_and_b32 v9, s14, v64
    v_lshlrev_b32 v10, 16, v65
    v_and_b32 v11, s14, v65
    v_lshlrev_b32 v12, 16, v66
    v_and_b32 v13, s14, v66
    v_lshlrev_b32 v14, 16, v67
    v_and_b32 v15, s14, v67
    s_waitcnt vmcnt(6)
    v_lshlrev_b32 v16, 16, v68
    v_and_b32 v17, s14, v68
    v_lshlrev_b32 v18, 16, v69
    v_and_b32 v19, s14, v69
    v_lshlrev_b32 v20, 16, v70
    v_and_b32 v21, s14, v70
    v_lshlrev_b32 v22, 16, v71
    v_and_b32 v23, s14, v71
    v_add_f32 v8, v8, v16
    v_add_f32 v9, v9, v17
    v_add_f32 v10, v10, v18
    v_add_f32 v11, v11, v19
    v_add_f32 v12, v12, v20
    v_add_f32 v13, v13, v21
    v_add_f32 v14, v14, v22
    v_add_f32 v15, v15, v23
    s_waitcnt vmcnt(5)
    v_lshlrev_b32 v16, 16, v72
    v_and_b32 v17, s14, v72
    v_lshlrev_b32 v18, 16, v73
    v_and_b32 v19, s14, v73
    v_lshlrev_b32 v20, 16, v74
    v_and_b32 v21, s14, v74
    v_lshlrev_b32 v22, 16, v75
    v_and_b32 v23, s14, v75
    v_add_f32 v8, v8, v16
    v_add_f32 v9, v9, v17
    v_add_f32 v10, v10, v18
    v_add_f32 v11, v11, v19
    v_add_f32 v12, v12, v20
    v_add_f32 v13, v13, v21
    v_add_f32 v14, v14, v22
    v_add_f32 v15, v15, v23
    s_waitcnt vmcnt(4)
    v_lshlrev_b32 v16, 16, v76
    v_and_b32 v17, s14, v76
    v_lshlrev_b32 v18, 16, v77
    v_and_b32 v19, s14, v77
    v_lshlrev_b32 v20, 16, v78
    v_and_b32 v21, s14, v78
    v_lshlrev_b32 v22, 16, v79
    v_and_b32 v23, s14, v79
    v_add_f32 v8, v8, v16
    v_add_f32 v9, v9, v17
    v_add_f32 v10, v10, v18
    v_add_f32 v11, v11, v19
    v_add_f32 v12, v12, v20
    v_add_f32 v13, v13, v21
    v_add_f32 v14, v14, v22
    v_add_f32 v15, v15, v23
    s_waitcnt vmcnt(3)
    v_lshlrev_b32 v16, 16, v80
    v_and_b32 v17, s14, v80
    v_lshlrev_b32 v18, 16, v81
    v_and_b32 v19, s14, v81
    v_lshlrev_b32 v20, 16, v82
    v_and_b32 v21, s14, v82
    v_lshlrev_b32 v22, 16, v83
    v_and_b32 v23, s14, v83
    v_add_f32 v8, v8, v16
    v_add_f32 v9, v9, v17
    v_add_f32 v10, v10, v18
    v_add_f32 v11, v11, v19
    v_add_f32 v12, v12, v20
    v_add_f32 v13, v13, v21
    v_add_f32 v14, v14, v22
    v_add_f32 v15, v15, v23
    s_waitcnt vmcnt(2)
    v_lshlrev_b32 v16, 16, v84
    v_and_b32 v17, s14, v84
    v_lshlrev_b32 v18, 16, v85
    v_and_b32 v19, s14, v85
    v_lshlrev_b32 v20, 16, v86
    v_and_b32 v21, s14, v86
    v_lshlrev_b32 v22, 16, v87
    v_and_b32 v23, s14, v87
    v_add_f32 v8, v8, v16
    v_add_f32 v9, v9, v17
    v_add_f32 v10, v10, v18
    v_add_f32 v11, v11, v19
    v_add_f32 v12, v12, v20
    v_add_f32 v13, v13, v21
    v_add_f32 v14, v14, v22
    v_add_f32 v15, v15, v23
    s_waitcnt vmcnt(1)
    v_lshlrev_b32 v16, 16, v88
    v_and_b32 v17, s14, v88
    v_lshlrev_b32 v18, 16, v89
    v_and_b32 v19, s14, v89
    v_lshlrev_b32 v20, 16, v90
    v_and_b32 v21, s14, v90
    v_lshlrev_b32 v22, 16, v91
    v_and_b32 v23, s14, v91
    v_add_f32 v8, v8, v16
    v_add_f32 v9, v9, v17
    v_add_f32 v10, v10, v18
    v_add_f32 v11, v11, v19
    v_add_f32 v12, v12, v20
    v_add_f32 v13, v13, v21
    v_add_f32 v14, v14, v22
    v_add_f32 v15, v15, v23
    s_waitcnt vmcnt(0)
    v_lshlrev_b32 v16, 16, v92
    v_and_b32 v17, s14, v92
    v_lshlrev_b32 v18, 16, v93
    v_and_b32 v19, s14, v93
    v_lshlrev_b32 v20, 16, v94
    v_and_b32 v21, s14, v94
    v_lshlrev_b32 v22, 16, v95
    v_and_b32 v23, s14, v95
    v_add_f32 v8, v8, v16
    v_add_f32 v9, v9, v17
    v_add_f32 v10, v10, v18
    v_add_f32 v11, v11, v19
    v_add_f32 v12, v12, v20
    v_add_f32 v13, v13, v21
    v_add_f32 v14, v14, v22
    v_add_f32 v15, v15, v23
    v_cvt_pk_bf16_f32 v4, v8, v9
    v_cvt_pk_bf16_f32 v5, v10, v11
    v_cvt_pk_bf16_f32 v6, v12, v13
    v_cvt_pk_bf16_f32 v7, v14, v15
    buffer_store_dwordx4 v[4:7], v2, s[72:75], s12 offen
    s_and_b32 s60, s45, 15
    s_add_u32 s60, s60, 16
    s_lshl_b32 s88, s60, 2
    s_lshr_b32 s59, s3, 1
    s_add_u32 s88, s88, s59
    s_lshl_b32 s88, s88, 6
    s_add_u32 s88, s88, 25174016
    s_lshl_b32 s17, s3, 2
    s_add_u32 s17, s17, s24
    s_lshl_b32 s18, s60, 18
    s_lshl_b32 s19, s17, 10
    s_add_u32 s18, s18, s19
    s_add_u32 s18, s18, 8388608
    s_lshl_b32 s12, s77, 7
    s_lshr_b32 s13, s17, 3
    s_lshl_b32 s13, s13, 5
    s_add_u32 s12, s12, s13
    s_lshl_b32 s12, s12, 11
    s_lshl_b32 s13, s78, 8
    s_add_u32 s12, s12, s13
    s_and_b32 s13, s17, 7
    s_lshl_b32 s13, s13, 5
    s_add_u32 s12, s12, s13
    s_add_u32 s12, s12, 1024
    v_lshlrev_b32 v1, 4, v0
    v_and_b32 v2, 31, v0
    v_lshlrev_b32 v2, 11, v2
    v_lshrrev_b32 v3, 5, v0
    v_lshl_add_u32 v2, v3, 4, v2
    s_mov_b32 s14, 0xffff0000
    s_cmp_lg_u32 s24, 0
    s_cbranch_scc1 L_pdone_pb
    v_lshlrev_b32 v246, 3, v0
    v_min_u32 v246, 56, v246
    s_mov_b32 s85, 0
L_poll_pb:
    buffer_load_dwordx2 v[248:249], v246, s[20:23], s88 offen sc1
    s_add_u32 s85, s85, 1
    s_waitcnt vmcnt(0)
    v_cmp_ne_u64 vcc, v[248:249], v[244:245]
    s_cbranch_vccz L_pdone_pb
    s_sleep 2
    s_cmp_lt_u32 s85, 4000000
    s_cbranch_scc1 L_poll_pb
L_pdone_pb:
    s_barrier
    buffer_load_dwordx4 v[64:67], v1, s[20:23], s18 offen sc1
    s_add_u32 s18, s18, 32768
    buffer_load_dwordx4 v[68:71], v1, s[20:23], s18 offen sc1
    s_add_u32 s18, s18, 32768
    buffer_load_dwordx4 v[72:75], v1, s[20:23], s18 offen sc1
    s_add_u32 s18, s18, 32768
    buffer_load_dwordx4 v[76:79], v1, s[20:23], s18 offen sc1
    s_add_u32 s18, s18, 32768
    buffer_load_dwordx4 v[80:83], v1, s[20:23], s18 offen sc1
    s_add_u32 s18, s18, 32768
    buffer_load_dwordx4 v[84:87], v1, s[20:23], s18 offen sc1
    s_add_u32 s18, s18, 32768
    buffer_load_dwordx4 v[88:91], v1, s[20:23], s18 offen sc1
    s_add_u32 s18, s18, 32768
    buffer_load_dwordx4 v[92:95], v1, s[20:23], s18 offen sc1
    s_add_u32 s18, s18, 32768
    s_waitcnt vmcnt(7)
    v_lshlrev_b32 v8, 16, v64
    v_and_b32 v9, s14, v64
    v_lshlrev_b32 v10, 16, v65
    v_and_b32 v11, s14, v65
    v_lshlrev_b32 v12, 16, v66
    v_and_b32 v13, s14, v66
    v_lshlrev_b32 v14, 16, v67
    v_and_b32 v15, s14, v67
    s_waitcnt vmcnt(6)
    v_lshlrev_b32 v16, 16, v68
    v_and_b32 v17, s14, v68
    v_lshlrev_b32 v18, 16, v69
    v_and_b32 v19, s14, v69
    v_lshlrev_b32 v20, 16, v70
    v_and_b32 v21, s14, v70
    v_lshlrev_b32 v22, 16, v71
    v_and_b32 v23, s14, v71
    v_add_f32 v8, v8, v16
    v_add_f32 v9, v9, v17
    v_add_f32 v10, v10, v18
    v_add_f32 v11, v11, v19
    v_add_f32 v12, v12, v20
    v_add_f32 v13, v13, v21
    v_add_f32 v14, v14, v22
    v_add_f32 v15, v15, v23
    s_waitcnt vmcnt(5)
    v_lshlrev_b32 v16, 16, v72
    v_and_b32 v17, s14, v72
    v_lshlrev_b32 v18, 16, v73
    v_and_b32 v19, s14, v73
    v_lshlrev_b32 v20, 16, v74
    v_and_b32 v21, s14, v74
    v_lshlrev_b32 v22, 16, v75
    v_and_b32 v23, s14, v75
    v_add_f32 v8, v8, v16
    v_add_f32 v9, v9, v17
    v_add_f32 v10, v10, v18
    v_add_f32 v11, v11, v19
    v_add_f32 v12, v12, v20
    v_add_f32 v13, v13, v21
    v_add_f32 v14, v14, v22
    v_add_f32 v15, v15, v23
    s_waitcnt vmcnt(4)
    v_lshlrev_b32 v16, 16, v76
    v_and_b32 v17, s14, v76
    v_lshlrev_b32 v18, 16, v77
    v_and_b32 v19, s14, v77
    v_lshlrev_b32 v20, 16, v78
    v_and_b32 v21, s14, v78
    v_lshlrev_b32 v22, 16, v79
    v_and_b32 v23, s14, v79
    v_add_f32 v8, v8, v16
    v_add_f32 v9, v9, v17
    v_add_f32 v10, v10, v18
    v_add_f32 v11, v11, v19
    v_add_f32 v12, v12, v20
    v_add_f32 v13, v13, v21
    v_add_f32 v14, v14, v22
    v_add_f32 v15, v15, v23
    s_waitcnt vmcnt(3)
    v_lshlrev_b32 v16, 16, v80
    v_and_b32 v17, s14, v80
    v_lshlrev_b32 v18, 16, v81
    v_and_b32 v19, s14, v81
    v_lshlrev_b32 v20, 16, v82
    v_and_b32 v21, s14, v82
    v_lshlrev_b32 v22, 16, v83
    v_and_b32 v23, s14, v83
    v_add_f32 v8, v8, v16
    v_add_f32 v9, v9, v17
    v_add_f32 v10, v10, v18
    v_add_f32 v11, v11, v19
    v_add_f32 v12, v12, v20
    v_add_f32 v13, v13, v21
    v_add_f32 v14, v14, v22
    v_add_f32 v15, v15, v23
    s_waitcnt vmcnt(2)
    v_lshlrev_b32 v16, 16, v84
    v_and_b32 v17, s14, v84
    v_lshlrev_b32 v18, 16, v85
    v_and_b32 v19, s14, v85
    v_lshlrev_b32 v20, 16, v86
    v_and_b32 v21, s14, v86
    v_lshlrev_b32 v22, 16, v87
    v_and_b32 v23, s14, v87
    v_add_f32 v8, v8, v16
    v_add_f32 v9, v9, v17
    v_add_f32 v10, v10, v18
    v_add_f32 v11, v11, v19
    v_add_f32 v12, v12, v20
    v_add_f32 v13, v13, v21
    v_add_f32 v14, v14, v22
    v_add_f32 v15, v15, v23
    s_waitcnt vmcnt(1)
    v_lshlrev_b32 v16, 16, v88
    v_and_b32 v17, s14, v88
    v_lshlrev_b32 v18, 16, v89
    v_and_b32 v19, s14, v89
    v_lshlrev_b32 v20, 16, v90
    v_and_b32 v21, s14, v90
    v_lshlrev_b32 v22, 16, v91
    v_and_b32 v23, s14, v91
    v_add_f32 v8, v8, v16
    v_add_f32 v9, v9, v17
    v_add_f32 v10, v10, v18
    v_add_f32 v11, v11, v19
    v_add_f32 v12, v12, v20
    v_add_f32 v13, v13, v21
    v_add_f32 v14, v14, v22
    v_add_f32 v15, v15, v23
    s_waitcnt vmcnt(0)
    v_lshlrev_b32 v16, 16, v92
    v_and_b32 v17, s14, v92
    v_lshlrev_b32 v18, 16, v93
    v_and_b32 v19, s14, v93
    v_lshlrev_b32 v20, 16, v94
    v_and_b32 v21, s14, v94
    v_lshlrev_b32 v22, 16, v95
    v_and_b32 v23, s14, v95
    v_add_f32 v8, v8, v16
    v_add_f32 v9, v9, v17
    v_add_f32 v10, v10, v18
    v_add_f32 v11, v11, v19
    v_add_f32 v12, v12, v20
    v_add_f32 v13, v13, v21
    v_add_f32 v14, v14, v22
    v_add_f32 v15, v15, v23
    v_cvt_pk_bf16_f32 v4, v8, v9
    v_cvt_pk_bf16_f32 v5, v10, v11
    v_cvt_pk_bf16_f32 v6, v12, v13
    v_cvt_pk_bf16_f32 v7, v14, v15
    buffer_store_dwordx4 v[4:7], v2, s[72:75], s12 offen
    s_endpgm
L_slow_b00:
    v_mov_b32 v18, v17
    v_mov_b32 v19, v17
    s_nop 1
    v_permlane32_swap_b32 v18, v19
    s_nop 1
    v_max_f32 v18, v18, v19
    s_cmp_eq_u32 s27, 0
    s_cbranch_scc1 L_slow2_b00
    v_max_f32 v18, 0, v18
    v_sub_f32 v19, 0, v18
    v_exp_f32 v19, v19
    s_nop 7
    s_nop 7
    v_accvgpr_read_b32 v20, a0
    v_accvgpr_read_b32 v21, a1
    v_accvgpr_read_b32 v22, a2
    v_accvgpr_read_b32 v23, a3
    v_mul_f32 v20, v20, v19
    v_mul_f32 v21, v21, v19
    v_mul_f32 v22, v22, v19
    v_mul_f32 v23, v23, v19
    v_accvgpr_write_b32 a0, v20
    v_accvgpr_write_b32 a1, v21
    v_accvgpr_write_b32 a2, v22
    v_accvgpr_write_b32 a3, v23
    v_accvgpr_read_b32 v20, a4
    v_accvgpr_read_b32 v21, a5
    v_accvgpr_read_b32 v22, a6
    v_accvgpr_read_b32 v23, a7
    v_mul_f32 v20, v20, v19
    v_mul_f32 v21, v21, v19
    v_mul_f32 v22, v22, v19
    v_mul_f32 v23, v23, v19
    v_accvgpr_write_b32 a4, v20
    v_accvgpr_write_b32 a5, v21
    v_accvgpr_write_b32 a6, v22
    v_accvgpr_write_b32 a7, v23
    v_accvgpr_read_b32 v20, a8
    v_accvgpr_read_b32 v21, a9
    v_accvgpr_read_b32 v22, a10
    v_accvgpr_read_b32 v23, a11
    v_mul_f32 v20, v20, v19
    v_mul_f32 v21, v21, v19
    v_mul_f32 v22, v22, v19
    v_mul_f32 v23, v23, v19
    v_accvgpr_write_b32 a8, v20
    v_accvgpr_write_b32 a9, v21
    v_accvgpr_write_b32 a10, v22
    v_accvgpr_write_b32 a11, v23
    v_accvgpr_read_b32 v20, a12
    v_accvgpr_read_b32 v21, a13
    v_accvgpr_read_b32 v22, a14
    v_accvgpr_read_b32 v23, a15
    v_mul_f32 v20, v20, v19
    v_mul_f32 v21, v21, v19
    v_mul_f32 v22, v22, v19
    v_mul_f32 v23, v23, v19
    v_accvgpr_write_b32 a12, v20
    v_accvgpr_write_b32 a13, v21
    v_accvgpr_write_b32 a14, v22
    v_accvgpr_write_b32 a15, v23
    v_accvgpr_read_b32 v20, a16
    v_accvgpr_read_b32 v21, a17
    v_accvgpr_read_b32 v22, a18
    v_accvgpr_read_b32 v23, a19
    v_mul_f32 v20, v20, v19
    v_mul_f32 v21, v21, v19
    v_mul_f32 v22, v22, v19
    v_mul_f32 v23, v23, v19
    v_accvgpr_write_b32 a16, v20
    v_accvgpr_write_b32 a17, v21
    v_accvgpr_write_b32 a18, v22
    v_accvgpr_write_b32 a19, v23
    v_accvgpr_read_b32 v20, a20
    v_accvgpr_read_b32 v21, a21
    v_accvgpr_read_b32 v22, a22
    v_accvgpr_read_b32 v23, a23
    v_mul_f32 v20, v20, v19
    v_mul_f32 v21, v21, v19
    v_mul_f32 v22, v22, v19
    v_mul_f32 v23, v23, v19
    v_accvgpr_write_b32 a20, v20
    v_accvgpr_write_b32 a21, v21
    v_accvgpr_write_b32 a22, v22
    v_accvgpr_write_b32 a23, v23
    v_accvgpr_read_b32 v20, a24
    v_accvgpr_read_b32 v21, a25
    v_accvgpr_read_b32 v22, a26
    v_accvgpr_read_b32 v23, a27
    v_mul_f32 v20, v20, v19
    v_mul_f32 v21, v21, v19
    v_mul_f32 v22, v22, v19
    v_mul_f32 v23, v23, v19
    v_accvgpr_write_b32 a24, v20
    v_accvgpr_write_b32 a25, v21
    v_accvgpr_write_b32 a26, v22
    v_accvgpr_write_b32 a27, v23
    v_accvgpr_read_b32 v20, a28
    v_accvgpr_read_b32 v21, a29
    v_accvgpr_read_b32 v22, a30
    v_accvgpr_read_b32 v23, a31
    v_mul_f32 v20, v20, v19
    v_mul_f32 v21, v21, v19
    v_mul_f32 v22, v22, v19
    v_mul_f32 v23, v23, v19
    v_accvgpr_write_b32 a28, v20
    v_accvgpr_write_b32 a29, v21
    v_accvgpr_write_b32 a30, v22
    v_accvgpr_write_b32 a31, v23
    v_accvgpr_read_b32 v20, a32
    v_accvgpr_read_b32 v21, a33
    v_accvgpr_read_b32 v22, a34
    v_accvgpr_read_b32 v23, a35
    v_mul_f32 v20, v20, v19
    v_mul_f32 v21, v21, v19
    v_mul_f32 v22, v22, v19
    v_mul_f32 v23, v23, v19
    v_accvgpr_write_b32 a32, v20
    v_accvgpr_write_b32 a33, v21
    v_accvgpr_write_b32 a34, v22
    v_accvgpr_write_b32 a35, v23
    v_accvgpr_read_b32 v20, a36
    v_accvgpr_read_b32 v21, a37
    v_accvgpr_read_b32 v22, a38
    v_accvgpr_read_b32 v23, a39
    v_mul_f32 v20, v20, v19
    v_mul_f32 v21, v21, v19
    v_mul_f32 v22, v22, v19
    v_mul_f32 v23, v23, v19
    v_accvgpr_write_b32 a36, v20
    v_accvgpr_write_b32 a37, v21
    v_accvgpr_write_b32 a38, v22
    v_accvgpr_write_b32 a39, v23
    v_accvgpr_read_b32 v20, a40
    v_accvgpr_read_b32 v21, a41
    v_accvgpr_read_b32 v22, a42
    v_accvgpr_read_b32 v23, a43
    v_mul_f32 v20, v20, v19
    v_mul_f32 v21, v21, v19
    v_mul_f32 v22, v22, v19
    v_mul_f32 v23, v23, v19
    v_accvgpr_write_b32 a40, v20
    v_accvgpr_write_b32 a41, v21
    v_accvgpr_write_b32 a42, v22
    v_accvgpr_write_b32 a43, v23
    v_accvgpr_read_b32 v20, a44
    v_accvgpr_read_b32 v21, a45
    v_accvgpr_read_b32 v22, a46
    v_accvgpr_read_b32 v23, a47
    v_mul_f32 v20, v20, v19
    v_mul_f32 v21, v21, v19
    v_mul_f32 v22, v22, v19
    v_mul_f32 v23, v23, v19
    v_accvgpr_write_b32 a44, v20
    v_accvgpr_write_b32 a45, v21
    v_accvgpr_write_b32 a46, v22
    v_accvgpr_write_b32 a47, v23
    v_accvgpr_read_b32 v20, a48
    v_accvgpr_read_b32 v21, a49
    v_accvgpr_read_b32 v22, a50
    v_accvgpr_read_b32 v23, a51
    v_mul_f32 v20, v20, v19
    v_mul_f32 v21, v21, v19
    v_mul_f32 v22, v22, v19
    v_mul_f32 v23, v23, v19
    v_accvgpr_write_b32 a48, v20
    v_accvgpr_write_b32 a49, v21
    v_accvgpr_write_b32 a50, v22
    v_accvgpr_write_b32 a51, v23
    v_accvgpr_read_b32 v20, a52
    v_accvgpr_read_b32 v21, a53
    v_accvgpr_read_b32 v22, a54
    v_accvgpr_read_b32 v23, a55
    v_mul_f32 v20, v20, v19
    v_mul_f32 v21, v21, v19
    v_mul_f32 v22, v22, v19
    v_mul_f32 v23, v23, v19
    v_accvgpr_write_b32 a52, v20
    v_accvgpr_write_b32 a53, v21
    v_accvgpr_write_b32 a54, v22
    v_accvgpr_write_b32 a55, v23
    v_accvgpr_read_b32 v20, a56
    v_accvgpr_read_b32 v21, a57
    v_accvgpr_read_b32 v22, a58
    v_accvgpr_read_b32 v23, a59
    v_mul_f32 v20, v20, v19
    v_mul_f32 v21, v21, v19
    v_mul_f32 v22, v22, v19
    v_mul_f32 v23, v23, v19
    v_accvgpr_write_b32 a56, v20
    v_accvgpr_write_b32 a57, v21
    v_accvgpr_write_b32 a58, v22
    v_accvgpr_write_b32 a59, v23
    v_accvgpr_read_b32 v20, a60
    v_accvgpr_read_b32 v21, a61
    v_accvgpr_read_b32 v22, a62
    v_accvgpr_read_b32 v23, a63
    v_mul_f32 v20, v20, v19
    v_mul_f32 v21, v21, v19
    v_mul_f32 v22, v22, v19
    v_mul_f32 v23, v23, v19
    v_accvgpr_write_b32 a60, v20
    v_accvgpr_write_b32 a61, v21
    v_accvgpr_write_b32 a62, v22
    v_accvgpr_write_b32 a63, v23
    v_accvgpr_read_b32 v20, a128
    v_accvgpr_read_b32 v21, a129
    v_accvgpr_read_b32 v22, a130
    v_accvgpr_read_b32 v23, a131
    v_mul_f32 v20, v20, v19
    v_mul_f32 v21, v21, v19
    v_mul_f32 v22, v22, v19
    v_mul_f32 v23, v23, v19
    v_accvgpr_write_b32 a128, v20
    v_accvgpr_write_b32 a129, v21
    v_accvgpr_write_b32 a130, v22
    v_accvgpr_write_b32 a131, v23
L_slow2_b00:
    v_sub_f32 v96, v96, v18
    v_sub_f32 v97, v97, v18
    v_sub_f32 v98, v98, v18
    v_sub_f32 v99, v99, v18
    v_sub_f32 v100, v100, v18
    v_sub_f32 v101, v101, v18
    v_sub_f32 v102, v102, v18
    v_sub_f32 v103, v103, v18
    v_sub_f32 v104, v104, v18
    v_sub_f32 v105, v105, v18
    v_sub_f32 v106, v106, v18
    v_sub_f32 v107, v107, v18
    v_sub_f32 v108, v108, v18
    v_sub_f32 v109, v109, v18
    v_sub_f32 v110, v110, v18
    v_sub_f32 v111, v111, v18
    v_sub_f32 v192, v192, v18
    v_sub_f32 v193, v193, v18
    v_sub_f32 v194, v194, v18
    v_sub_f32 v195, v195, v18
    v_sub_f32 v196, v196, v18
    v_sub_f32 v197, v197, v18
    v_sub_f32 v198, v198, v18
    v_sub_f32 v199, v199, v18
    v_sub_f32 v200, v200, v18
    v_sub_f32 v201, v201, v18
    v_sub_f32 v202, v202, v18
    v_sub_f32 v203, v203, v18
    v_sub_f32 v204, v204, v18
    v_sub_f32 v205, v205, v18
    v_sub_f32 v206, v206, v18
    v_sub_f32 v207, v207, v18
    s_nop 1
    s_branch L_back_b00
L_slow_b01:
    v_mov_b32 v18, v17
    v_mov_b32 v19, v17
    s_nop 1
    v_permlane32_swap_b32 v18, v19
    s_nop 1
    v_max_f32 v18, v18, v19
    s_cmp_eq_u32 s27, 0
    s_cbranch_scc1 L_slow2_b01
    v_max_f32 v18, 0, v18
    v_sub_f32 v19, 0, v18
    v_exp_f32 v19, v19
    s_nop 7
    s_nop 7
    v_accvgpr_read_b32 v20, a64
    v_accvgpr_read_b32 v21, a65
    v_accvgpr_read_b32 v22, a66
    v_accvgpr_read_b32 v23, a67
    v_mul_f32 v20, v20, v19
    v_mul_f32 v21, v21, v19
    v_mul_f32 v22, v22, v19
    v_mul_f32 v23, v23, v19
    v_accvgpr_write_b32 a64, v20
    v_accvgpr_write_b32 a65, v21
    v_accvgpr_write_b32 a66, v22
    v_accvgpr_write_b32 a67, v23
    v_accvgpr_read_b32 v20, a68
    v_accvgpr_read_b32 v21, a69
    v_accvgpr_read_b32 v22, a70
    v_accvgpr_read_b32 v23, a71
    v_mul_f32 v20, v20, v19
    v_mul_f32 v21, v21, v19
    v_mul_f32 v22, v22, v19
    v_mul_f32 v23, v23, v19
    v_accvgpr_write_b32 a68, v20
    v_accvgpr_write_b32 a69, v21
    v_accvgpr_write_b32 a70, v22
    v_accvgpr_write_b32 a71, v23
    v_accvgpr_read_b32 v20, a72
    v_accvgpr_read_b32 v21, a73
    v_accvgpr_read_b32 v22, a74
    v_accvgpr_read_b32 v23, a75
    v_mul_f32 v20, v20, v19
    v_mul_f32 v21, v21, v19
    v_mul_f32 v22, v22, v19
    v_mul_f32 v23, v23, v19
    v_accvgpr_write_b32 a72, v20
    v_accvgpr_write_b32 a73, v21
    v_accvgpr_write_b32 a74, v22
    v_accvgpr_write_b32 a75, v23
    v_accvgpr_read_b32 v20, a76
    v_accvgpr_read_b32 v21, a77
    v_accvgpr_read_b32 v22, a78
    v_accvgpr_read_b32 v23, a79
    v_mul_f32 v20, v20, v19
    v_mul_f32 v21, v21, v19
    v_mul_f32 v22, v22, v19
    v_mul_f32 v23, v23, v19
    v_accvgpr_write_b32 a76, v20
    v_accvgpr_write_b32 a77, v21
    v_accvgpr_write_b32 a78, v22
    v_accvgpr_write_b32 a79, v23
    v_accvgpr_read_b32 v20, a80
    v_accvgpr_read_b32 v21, a81
    v_accvgpr_read_b32 v22, a82
    v_accvgpr_read_b32 v23, a83
    v_mul_f32 v20, v20, v19
    v_mul_f32 v21, v21, v19
    v_mul_f32 v22, v22, v19
    v_mul_f32 v23, v23, v19
    v_accvgpr_write_b32 a80, v20
    v_accvgpr_write_b32 a81, v21
    v_accvgpr_write_b32 a82, v22
    v_accvgpr_write_b32 a83, v23
    v_accvgpr_read_b32 v20, a84
    v_accvgpr_read_b32 v21, a85
    v_accvgpr_read_b32 v22, a86
    v_accvgpr_read_b32 v23, a87
    v_mul_f32 v20, v20, v19
    v_mul_f32 v21, v21, v19
    v_mul_f32 v22, v22, v19
    v_mul_f32 v23, v23, v19
    v_accvgpr_write_b32 a84, v20
    v_accvgpr_write_b32 a85, v21
    v_accvgpr_write_b32 a86, v22
    v_accvgpr_write_b32 a87, v23
    v_accvgpr_read_b32 v20, a88
    v_accvgpr_read_b32 v21, a89
    v_accvgpr_read_b32 v22, a90
    v_accvgpr_read_b32 v23, a91
    v_mul_f32 v20, v20, v19
    v_mul_f32 v21, v21, v19
    v_mul_f32 v22, v22, v19
    v_mul_f32 v23, v23, v19
    v_accvgpr_write_b32 a88, v20
    v_accvgpr_write_b32 a89, v21
    v_accvgpr_write_b32 a90, v22
    v_accvgpr_write_b32 a91, v23
    v_accvgpr_read_b32 v20, a92
    v_accvgpr_read_b32 v21, a93
    v_accvgpr_read_b32 v22, a94
    v_accvgpr_read_b32 v23, a95
    v_mul_f32 v20, v20, v19
    v_mul_f32 v21, v21, v19
    v_mul_f32 v22, v22, v19
    v_mul_f32 v23, v23, v19
    v_accvgpr_write_b32 a92, v20
    v_accvgpr_write_b32 a93, v21
    v_accvgpr_write_b32 a94, v22
    v_accvgpr_write_b32 a95, v23
    v_accvgpr_read_b32 v20, a96
    v_accvgpr_read_b32 v21, a97
    v_accvgpr_read_b32 v22, a98
    v_accvgpr_read_b32 v23, a99
    v_mul_f32 v20, v20, v19
    v_mul_f32 v21, v21, v19
    v_mul_f32 v22, v22, v19
    v_mul_f32 v23, v23, v19
    v_accvgpr_write_b32 a96, v20
    v_accvgpr_write_b32 a97, v21
    v_accvgpr_write_b32 a98, v22
    v_accvgpr_write_b32 a99, v23
    v_accvgpr_read_b32 v20, a100
    v_accvgpr_read_b32 v21, a101
    v_accvgpr_read_b32 v22, a102
    v_accvgpr_read_b32 v23, a103
    v_mul_f32 v20, v20, v19
    v_mul_f32 v21, v21, v19
    v_mul_f32 v22, v22, v19
    v_mul_f32 v23, v23, v19
    v_accvgpr_write_b32 a100, v20
    v_accvgpr_write_b32 a101, v21
    v_accvgpr_write_b32 a102, v22
    v_accvgpr_write_b32 a103, v23
    v_accvgpr_read_b32 v20, a104
    v_accvgpr_read_b32 v21, a105
    v_accvgpr_read_b32 v22, a106
    v_accvgpr_read_b32 v23, a107
    v_mul_f32 v20, v20, v19
    v_mul_f32 v21, v21, v19
    v_mul_f32 v22, v22, v19
    v_mul_f32 v23, v23, v19
    v_accvgpr_write_b32 a104, v20
    v_accvgpr_write_b32 a105, v21
    v_accvgpr_write_b32 a106, v22
    v_accvgpr_write_b32 a107, v23
    v_accvgpr_read_b32 v20, a108
    v_accvgpr_read_b32 v21, a109
    v_accvgpr_read_b32 v22, a110
    v_accvgpr_read_b32 v23, a111
    v_mul_f32 v20, v20, v19
    v_mul_f32 v21, v21, v19
    v_mul_f32 v22, v22, v19
    v_mul_f32 v23, v23, v19
    v_accvgpr_write_b32 a108, v20
    v_accvgpr_write_b32 a109, v21
    v_accvgpr_write_b32 a110, v22
    v_accvgpr_write_b32 a111, v23
    v_accvgpr_read_b32 v20, a112
    v_accvgpr_read_b32 v21, a113
    v_accvgpr_read_b32 v22, a114
    v_accvgpr_read_b32 v23, a115
    v_mul_f32 v20, v20, v19
    v_mul_f32 v21, v21, v19
    v_mul_f32 v22, v22, v19
    v_mul_f32 v23, v23, v19
    v_accvgpr_write_b32 a112, v20
    v_accvgpr_write_b32 a113, v21
    v_accvgpr_write_b32 a114, v22
    v_accvgpr_write_b32 a115, v23
    v_accvgpr_read_b32 v20, a116
    v_accvgpr_read_b32 v21, a117
    v_accvgpr_read_b32 v22, a118
    v_accvgpr_read_b32 v23, a119
    v_mul_f32 v20, v20, v19
    v_mul_f32 v21, v21, v19
    v_mul_f32 v22, v22, v19
    v_mul_f32 v23, v23, v19
    v_accvgpr_write_b32 a116, v20
    v_accvgpr_write_b32 a117, v21
    v_accvgpr_write_b32 a118, v22
    v_accvgpr_write_b32 a119, v23
    v_accvgpr_read_b32 v20, a120
    v_accvgpr_read_b32 v21, a121
    v_accvgpr_read_b32 v22, a122
    v_accvgpr_read_b32 v23, a123
    v_mul_f32 v20, v20, v19
    v_mul_f32 v21, v21, v19
    v_mul_f32 v22, v22, v19
    v_mul_f32 v23, v23, v19
    v_accvgpr_write_b32 a120, v20
    v_accvgpr_write_b32 a121, v21
    v_accvgpr_write_b32 a122, v22
    v_accvgpr_write_b32 a123, v23
    v_accvgpr_read_b32 v20, a124
    v_accvgpr_read_b32 v21, a125
    v_accvgpr_read_b32 v22, a126
    v_accvgpr_read_b32 v23, a127
    v_mul_f32 v20, v20, v19
    v_mul_f32 v21, v21, v19
    v_mul_f32 v22, v22, v19
    v_mul_f32 v23, v23, v19
    v_accvgpr_write_b32 a124, v20
    v_accvgpr_write_b32 a125, v21
    v_accvgpr_write_b32 a126, v22
    v_accvgpr_write_b32 a127, v23
    v_accvgpr_read_b32 v20, a144
    v_accvgpr_read_b32 v21, a145
    v_accvgpr_read_b32 v22, a146
    v_accvgpr_read_b32 v23, a147
    v_mul_f32 v20, v20, v19
    v_mul_f32 v21, v21, v19
    v_mul_f32 v22, v22, v19
    v_mul_f32 v23, v23, v19
    v_accvgpr_write_b32 a144, v20
    v_accvgpr_write_b32 a145, v21
    v_accvgpr_write_b32 a146, v22
    v_accvgpr_write_b32 a147, v23
L_slow2_b01:
    v_sub_f32 v112, v112, v18
    v_sub_f32 v113, v113, v18
    v_sub_f32 v114, v114, v18
    v_sub_f32 v115, v115, v18
    v_sub_f32 v116, v116, v18
    v_sub_f32 v117, v117, v18
    v_sub_f32 v118, v118, v18
    v_sub_f32 v119, v119, v18
    v_sub_f32 v120, v120, v18
    v_sub_f32 v121, v121, v18
    v_sub_f32 v122, v122, v18
    v_sub_f32 v123, v123, v18
    v_sub_f32 v124, v124, v18
    v_sub_f32 v125, v125, v18
    v_sub_f32 v126, v126, v18
    v_sub_f32 v127, v127, v18
    v_sub_f32 v208, v208, v18
    v_sub_f32 v209, v209, v18
    v_sub_f32 v210, v210, v18
    v_sub_f32 v211, v211, v18
    v_sub_f32 v212, v212, v18
    v_sub_f32 v213, v213, v18
    v_sub_f32 v214, v214, v18
    v_sub_f32 v215, v215, v18
    v_sub_f32 v216, v216, v18
    v_sub_f32 v217, v217, v18
    v_sub_f32 v218, v218, v18
    v_sub_f32 v219, v219, v18
    v_sub_f32 v220, v220, v18
    v_sub_f32 v221, v221, v18
    v_sub_f32 v222, v222, v18
    v_sub_f32 v223, v223, v18
    s_nop 1
    s_branch L_back_b01
L_slow_b10:
    v_mov_b32 v18, v17
    v_mov_b32 v19, v17
    s_nop 1
    v_permlane32_swap_b32 v18, v19
    s_nop 1
    v_max_f32 v18, v18, v19
    s_cmp_eq_u32 s27, 0
    s_cbranch_scc1 L_slow2_b10
    v_max_f32 v18, 0, v18
    v_sub_f32 v19, 0, v18
    v_exp_f32 v19, v19
    s_nop 7
    s_nop 7
    v_accvgpr_read_b32 v20, a0
    v_accvgpr_read_b32 v21, a1
    v_accvgpr_read_b32 v22, a2
    v_accvgpr_read_b32 v23, a3
    v_mul_f32 v20, v20, v19
    v_mul_f32 v21, v21, v19
    v_mul_f32 v22, v22, v19
    v_mul_f32 v23, v23, v19
    v_accvgpr_write_b32 a0, v20
    v_accvgpr_write_b32 a1, v21
    v_accvgpr_write_b32 a2, v22
    v_accvgpr_write_b32 a3, v23
    v_accvgpr_read_b32 v20, a4
    v_accvgpr_read_b32 v21, a5
    v_accvgpr_read_b32 v22, a6
    v_accvgpr_read_b32 v23, a7
    v_mul_f32 v20, v20, v19
    v_mul_f32 v21, v21, v19
    v_mul_f32 v22, v22, v19
    v_mul_f32 v23, v23, v19
    v_accvgpr_write_b32 a4, v20
    v_accvgpr_write_b32 a5, v21
    v_accvgpr_write_b32 a6, v22
    v_accvgpr_write_b32 a7, v23
    v_accvgpr_read_b32 v20, a8
    v_accvgpr_read_b32 v21, a9
    v_accvgpr_read_b32 v22, a10
    v_accvgpr_read_b32 v23, a11
    v_mul_f32 v20, v20, v19
    v_mul_f32 v21, v21, v19
    v_mul_f32 v22, v22, v19
    v_mul_f32 v23, v23, v19
    v_accvgpr_write_b32 a8, v20
    v_accvgpr_write_b32 a9, v21
    v_accvgpr_write_b32 a10, v22
    v_accvgpr_write_b32 a11, v23
    v_accvgpr_read_b32 v20, a12
    v_accvgpr_read_b32 v21, a13
    v_accvgpr_read_b32 v22, a14
    v_accvgpr_read_b32 v23, a15
    v_mul_f32 v20, v20, v19
    v_mul_f32 v21, v21, v19
    v_mul_f32 v22, v22, v19
    v_mul_f32 v23, v23, v19
    v_accvgpr_write_b32 a12, v20
    v_accvgpr_write_b32 a13, v21
    v_accvgpr_write_b32 a14, v22
    v_accvgpr_write_b32 a15, v23
    v_accvgpr_read_b32 v20, a16
    v_accvgpr_read_b32 v21, a17
    v_accvgpr_read_b32 v22, a18
    v_accvgpr_read_b32 v23, a19
    v_mul_f32 v20, v20, v19
    v_mul_f32 v21, v21, v19
    v_mul_f32 v22, v22, v19
    v_mul_f32 v23, v23, v19
    v_accvgpr_write_b32 a16, v20
    v_accvgpr_write_b32 a17, v21
    v_accvgpr_write_b32 a18, v22
    v_accvgpr_write_b32 a19, v23
    v_accvgpr_read_b32 v20, a20
    v_accvgpr_read_b32 v21, a21
    v_accvgpr_read_b32 v22, a22
    v_accvgpr_read_b32 v23, a23
    v_mul_f32 v20, v20, v19
    v_mul_f32 v21, v21, v19
    v_mul_f32 v22, v22, v19
    v_mul_f32 v23, v23, v19
    v_accvgpr_write_b32 a20, v20
    v_accvgpr_write_b32 a21, v21
    v_accvgpr_write_b32 a22, v22
    v_accvgpr_write_b32 a23, v23
    v_accvgpr_read_b32 v20, a24
    v_accvgpr_read_b32 v21, a25
    v_accvgpr_read_b32 v22, a26
    v_accvgpr_read_b32 v23, a27
    v_mul_f32 v20, v20, v19
    v_mul_f32 v21, v21, v19
    v_mul_f32 v22, v22, v19
    v_mul_f32 v23, v23, v19
    v_accvgpr_write_b32 a24, v20
    v_accvgpr_write_b32 a25, v21
    v_accvgpr_write_b32 a26, v22
    v_accvgpr_write_b32 a27, v23
    v_accvgpr_read_b32 v20, a28
    v_accvgpr_read_b32 v21, a29
    v_accvgpr_read_b32 v22, a30
    v_accvgpr_read_b32 v23, a31
    v_mul_f32 v20, v20, v19
    v_mul_f32 v21, v21, v19
    v_mul_f32 v22, v22, v19
    v_mul_f32 v23, v23, v19
    v_accvgpr_write_b32 a28, v20
    v_accvgpr_write_b32 a29, v21
    v_accvgpr_write_b32 a30, v22
    v_accvgpr_write_b32 a31, v23
    v_accvgpr_read_b32 v20, a32
    v_accvgpr_read_b32 v21, a33
    v_accvgpr_read_b32 v22, a34
    v_accvgpr_read_b32 v23, a35
    v_mul_f32 v20, v20, v19
    v_mul_f32 v21, v21, v19
    v_mul_f32 v22, v22, v19
    v_mul_f32 v23, v23, v19
    v_accvgpr_write_b32 a32, v20
    v_accvgpr_write_b32 a33, v21
    v_accvgpr_write_b32 a34, v22
    v_accvgpr_write_b32 a35, v23
    v_accvgpr_read_b32 v20, a36
    v_accvgpr_read_b32 v21, a37
    v_accvgpr_read_b32 v22, a38
    v_accvgpr_read_b32 v23, a39
    v_mul_f32 v20, v20, v19
    v_mul_f32 v21, v21, v19
    v_mul_f32 v22, v22, v19
    v_mul_f32 v23, v23, v19
    v_accvgpr_write_b32 a36, v20
    v_accvgpr_write_b32 a37, v21
    v_accvgpr_write_b32 a38, v22
    v_accvgpr_write_b32 a39, v23
    v_accvgpr_read_b32 v20, a40
    v_accvgpr_read_b32 v21, a41
    v_accvgpr_read_b32 v22, a42
    v_accvgpr_read_b32 v23, a43
    v_mul_f32 v20, v20, v19
    v_mul_f32 v21, v21, v19
    v_mul_f32 v22, v22, v19
    v_mul_f32 v23, v23, v19
    v_accvgpr_write_b32 a40, v20
    v_accvgpr_write_b32 a41, v21
    v_accvgpr_write_b32 a42, v22
    v_accvgpr_write_b32 a43, v23
    v_accvgpr_read_b32 v20, a44
    v_accvgpr_read_b32 v21, a45
    v_accvgpr_read_b32 v22, a46
    v_accvgpr_read_b32 v23, a47
    v_mul_f32 v20, v20, v19
    v_mul_f32 v21, v21, v19
    v_mul_f32 v22, v22, v19
    v_mul_f32 v23, v23, v19
    v_accvgpr_write_b32 a44, v20
    v_accvgpr_write_b32 a45, v21
    v_accvgpr_write_b32 a46, v22
    v_accvgpr_write_b32 a47, v23
    v_accvgpr_read_b32 v20, a48
    v_accvgpr_read_b32 v21, a49
    v_accvgpr_read_b32 v22, a50
    v_accvgpr_read_b32 v23, a51
    v_mul_f32 v20, v20, v19
    v_mul_f32 v21, v21, v19
    v_mul_f32 v22, v22, v19
    v_mul_f32 v23, v23, v19
    v_accvgpr_write_b32 a48, v20
    v_accvgpr_write_b32 a49, v21
    v_accvgpr_write_b32 a50, v22
    v_accvgpr_write_b32 a51, v23
    v_accvgpr_read_b32 v20, a52
    v_accvgpr_read_b32 v21, a53
    v_accvgpr_read_b32 v22, a54
    v_accvgpr_read_b32 v23, a55
    v_mul_f32 v20, v20, v19
    v_mul_f32 v21, v21, v19
    v_mul_f32 v22, v22, v19
    v_mul_f32 v23, v23, v19
    v_accvgpr_write_b32 a52, v20
    v_accvgpr_write_b32 a53, v21
    v_accvgpr_write_b32 a54, v22
    v_accvgpr_write_b32 a55, v23
    v_accvgpr_read_b32 v20, a56
    v_accvgpr_read_b32 v21, a57
    v_accvgpr_read_b32 v22, a58
    v_accvgpr_read_b32 v23, a59
    v_mul_f32 v20, v20, v19
    v_mul_f32 v21, v21, v19
    v_mul_f32 v22, v22, v19
    v_mul_f32 v23, v23, v19
    v_accvgpr_write_b32 a56, v20
    v_accvgpr_write_b32 a57, v21
    v_accvgpr_write_b32 a58, v22
    v_accvgpr_write_b32 a59, v23
    v_accvgpr_read_b32 v20, a60
    v_accvgpr_read_b32 v21, a61
    v_accvgpr_read_b32 v22, a62
    v_accvgpr_read_b32 v23, a63
    v_mul_f32 v20, v20, v19
    v_mul_f32 v21, v21, v19
    v_mul_f32 v22, v22, v19
    v_mul_f32 v23, v23, v19
    v_accvgpr_write_b32 a60, v20
    v_accvgpr_write_b32 a61, v21
    v_accvgpr_write_b32 a62, v22
    v_accvgpr_write_b32 a63, v23
    v_accvgpr_read_b32 v20, a128
    v_accvgpr_read_b32 v21, a129
    v_accvgpr_read_b32 v22, a130
    v_accvgpr_read_b32 v23, a131
    v_mul_f32 v20, v20, v19
    v_mul_f32 v21, v21, v19
    v_mul_f32 v22, v22, v19
    v_mul_f32 v23, v23, v19
    v_accvgpr_write_b32 a128, v20
    v_accvgpr_write_b32 a129, v21
    v_accvgpr_write_b32 a130, v22
    v_accvgpr_write_b32 a131, v23
L_slow2_b10:
    v_sub_f32 v96, v96, v18
    v_sub_f32 v97, v97, v18
    v_sub_f32 v98, v98, v18
    v_sub_f32 v99, v99, v18
    v_sub_f32 v100, v100, v18
    v_sub_f32 v101, v101, v18
    v_sub_f32 v102, v102, v18
    v_sub_f32 v103, v103, v18
    v_sub_f32 v104, v104, v18
    v_sub_f32 v105, v105, v18
    v_sub_f32 v106, v106, v18
    v_sub_f32 v107, v107, v18
    v_sub_f32 v108, v108, v18
    v_sub_f32 v109, v109, v18
    v_sub_f32 v110, v110, v18
    v_sub_f32 v111, v111, v18
    v_sub_f32 v192, v192, v18
    v_sub_f32 v193, v193, v18
    v_sub_f32 v194, v194, v18
    v_sub_f32 v195, v195, v18
    v_sub_f32 v196, v196, v18
    v_sub_f32 v197, v197, v18
    v_sub_f32 v198, v198, v18
    v_sub_f32 v199, v199, v18
    v_sub_f32 v200, v200, v18
    v_sub_f32 v201, v201, v18
    v_sub_f32 v202, v202, v18
    v_sub_f32 v203, v203, v18
    v_sub_f32 v204, v204, v18
    v_sub_f32 v205, v205, v18
    v_sub_f32 v206, v206, v18
    v_sub_f32 v207, v207, v18
    s_nop 1
    s_branch L_back_b10
L_slow_b11:
    v_mov_b32 v18, v17
    v_mov_b32 v19, v17
    s_nop 1
    v_permlane32_swap_b32 v18, v19
    s_nop 1
    v_max_f32 v18, v18, v19
    s_cmp_eq_u32 s27, 0
    s_cbranch_scc1 L_slow2_b11
    v_max_f32 v18, 0, v18
    v_sub_f32 v19, 0, v18
    v_exp_f32 v19, v19
    s_nop 7
    s_nop 7
    v_accvgpr_read_b32 v20, a64
    v_accvgpr_read_b32 v21, a65
    v_accvgpr_read_b32 v22, a66
    v_accvgpr_read_b32 v23, a67
    v_mul_f32 v20, v20, v19
    v_mul_f32 v21, v21, v19
    v_mul_f32 v22, v22, v19
    v_mul_f32 v23, v23, v19
    v_accvgpr_write_b32 a64, v20
    v_accvgpr_write_b32 a65, v21
    v_accvgpr_write_b32 a66, v22
    v_accvgpr_write_b32 a67, v23
    v_accvgpr_read_b32 v20, a68
    v_accvgpr_read_b32 v21, a69
    v_accvgpr_read_b32 v22, a70
    v_accvgpr_read_b32 v23, a71
    v_mul_f32 v20, v20, v19
    v_mul_f32 v21, v21, v19
    v_mul_f32 v22, v22, v19
    v_mul_f32 v23, v23, v19
    v_accvgpr_write_b32 a68, v20
    v_accvgpr_write_b32 a69, v21
    v_accvgpr_write_b32 a70, v22
    v_accvgpr_write_b32 a71, v23
    v_accvgpr_read_b32 v20, a72
    v_accvgpr_read_b32 v21, a73
    v_accvgpr_read_b32 v22, a74
    v_accvgpr_read_b32 v23, a75
    v_mul_f32 v20, v20, v19
    v_mul_f32 v21, v21, v19
    v_mul_f32 v22, v22, v19
    v_mul_f32 v23, v23, v19
    v_accvgpr_write_b32 a72, v20
    v_accvgpr_write_b32 a73, v21
    v_accvgpr_write_b32 a74, v22
    v_accvgpr_write_b32 a75, v23
    v_accvgpr_read_b32 v20, a76
    v_accvgpr_read_b32 v21, a77
    v_accvgpr_read_b32 v22, a78
    v_accvgpr_read_b32 v23, a79
    v_mul_f32 v20, v20, v19
    v_mul_f32 v21, v21, v19
    v_mul_f32 v22, v22, v19
    v_mul_f32 v23, v23, v19
    v_accvgpr_write_b32 a76, v20
    v_accvgpr_write_b32 a77, v21
    v_accvgpr_write_b32 a78, v22
    v_accvgpr_write_b32 a79, v23
    v_accvgpr_read_b32 v20, a80
    v_accvgpr_read_b32 v21, a81
    v_accvgpr_read_b32 v22, a82
    v_accvgpr_read_b32 v23, a83
    v_mul_f32 v20, v20, v19
    v_mul_f32 v21, v21, v19
    v_mul_f32 v22, v22, v19
    v_mul_f32 v23, v23, v19
    v_accvgpr_write_b32 a80, v20
    v_accvgpr_write_b32 a81, v21
    v_accvgpr_write_b32 a82, v22
    v_accvgpr_write_b32 a83, v23
    v_accvgpr_read_b32 v20, a84
    v_accvgpr_read_b32 v21, a85
    v_accvgpr_read_b32 v22, a86
    v_accvgpr_read_b32 v23, a87
    v_mul_f32 v20, v20, v19
    v_mul_f32 v21, v21, v19
    v_mul_f32 v22, v22, v19
    v_mul_f32 v23, v23, v19
    v_accvgpr_write_b32 a84, v20
    v_accvgpr_write_b32 a85, v21
    v_accvgpr_write_b32 a86, v22
    v_accvgpr_write_b32 a87, v23
    v_accvgpr_read_b32 v20, a88
    v_accvgpr_read_b32 v21, a89
    v_accvgpr_read_b32 v22, a90
    v_accvgpr_read_b32 v23, a91
    v_mul_f32 v20, v20, v19
    v_mul_f32 v21, v21, v19
    v_mul_f32 v22, v22, v19
    v_mul_f32 v23, v23, v19
    v_accvgpr_write_b32 a88, v20
    v_accvgpr_write_b32 a89, v21
    v_accvgpr_write_b32 a90, v22
    v_accvgpr_write_b32 a91, v23
    v_accvgpr_read_b32 v20, a92
    v_accvgpr_read_b32 v21, a93
    v_accvgpr_read_b32 v22, a94
    v_accvgpr_read_b32 v23, a95
    v_mul_f32 v20, v20, v19
    v_mul_f32 v21, v21, v19
    v_mul_f32 v22, v22, v19
    v_mul_f32 v23, v23, v19
    v_accvgpr_write_b32 a92, v20
    v_accvgpr_write_b32 a93, v21
    v_accvgpr_write_b32 a94, v22
    v_accvgpr_write_b32 a95, v23
    v_accvgpr_read_b32 v20, a96
    v_accvgpr_read_b32 v21, a97
    v_accvgpr_read_b32 v22, a98
    v_accvgpr_read_b32 v23, a99
    v_mul_f32 v20, v20, v19
    v_mul_f32 v21, v21, v19
    v_mul_f32 v22, v22, v19
    v_mul_f32 v23, v23, v19
    v_accvgpr_write_b32 a96, v20
    v_accvgpr_write_b32 a97, v21
    v_accvgpr_write_b32 a98, v22
    v_accvgpr_write_b32 a99, v23
    v_accvgpr_read_b32 v20, a100
    v_accvgpr_read_b32 v21, a101
    v_accvgpr_read_b32 v22, a102
    v_accvgpr_read_b32 v23, a103
    v_mul_f32 v20, v20, v19
    v_mul_f32 v21, v21, v19
    v_mul_f32 v22, v22, v19
    v_mul_f32 v23, v23, v19
    v_accvgpr_write_b32 a100, v20
    v_accvgpr_write_b32 a101, v21
    v_accvgpr_write_b32 a102, v22
    v_accvgpr_write_b32 a103, v23
    v_accvgpr_read_b32 v20, a104
    v_accvgpr_read_b32 v21, a105
    v_accvgpr_read_b32 v22, a106
    v_accvgpr_read_b32 v23, a107
    v_mul_f32 v20, v20, v19
    v_mul_f32 v21, v21, v19
    v_mul_f32 v22, v22, v19
    v_mul_f32 v23, v23, v19
    v_accvgpr_write_b32 a104, v20
    v_accvgpr_write_b32 a105, v21
    v_accvgpr_write_b32 a106, v22
    v_accvgpr_write_b32 a107, v23
    v_accvgpr_read_b32 v20, a108
    v_accvgpr_read_b32 v21, a109
    v_accvgpr_read_b32 v22, a110
    v_accvgpr_read_b32 v23, a111
    v_mul_f32 v20, v20, v19
    v_mul_f32 v21, v21, v19
    v_mul_f32 v22, v22, v19
    v_mul_f32 v23, v23, v19
    v_accvgpr_write_b32 a108, v20
    v_accvgpr_write_b32 a109, v21
    v_accvgpr_write_b32 a110, v22
    v_accvgpr_write_b32 a111, v23
    v_accvgpr_read_b32 v20, a112
    v_accvgpr_read_b32 v21, a113
    v_accvgpr_read_b32 v22, a114
    v_accvgpr_read_b32 v23, a115
    v_mul_f32 v20, v20, v19
    v_mul_f32 v21, v21, v19
    v_mul_f32 v22, v22, v19
    v_mul_f32 v23, v23, v19
    v_accvgpr_write_b32 a112, v20
    v_accvgpr_write_b32 a113, v21
    v_accvgpr_write_b32 a114, v22
    v_accvgpr_write_b32 a115, v23
    v_accvgpr_read_b32 v20, a116
    v_accvgpr_read_b32 v21, a117
    v_accvgpr_read_b32 v22, a118
    v_accvgpr_read_b32 v23, a119
    v_mul_f32 v20, v20, v19
    v_mul_f32 v21, v21, v19
    v_mul_f32 v22, v22, v19
    v_mul_f32 v23, v23, v19
    v_accvgpr_write_b32 a116, v20
    v_accvgpr_write_b32 a117, v21
    v_accvgpr_write_b32 a118, v22
    v_accvgpr_write_b32 a119, v23
    v_accvgpr_read_b32 v20, a120
    v_accvgpr_read_b32 v21, a121
    v_accvgpr_read_b32 v22, a122
    v_accvgpr_read_b32 v23, a123
    v_mul_f32 v20, v20, v19
    v_mul_f32 v21, v21, v19
    v_mul_f32 v22, v22, v19
    v_mul_f32 v23, v23, v19
    v_accvgpr_write_b32 a120, v20
    v_accvgpr_write_b32 a121, v21
    v_accvgpr_write_b32 a122, v22
    v_accvgpr_write_b32 a123, v23
    v_accvgpr_read_b32 v20, a124
    v_accvgpr_read_b32 v21, a125
    v_accvgpr_read_b32 v22, a126
    v_accvgpr_read_b32 v23, a127
    v_mul_f32 v20, v20, v19
    v_mul_f32 v21, v21, v19
    v_mul_f32 v22, v22, v19
    v_mul_f32 v23, v23, v19
    v_accvgpr_write_b32 a124, v20
    v_accvgpr_write_b32 a125, v21
    v_accvgpr_write_b32 a126, v22
    v_accvgpr_write_b32 a127, v23
    v_accvgpr_read_b32 v20, a144
    v_accvgpr_read_b32 v21, a145
    v_accvgpr_read_b32 v22, a146
    v_accvgpr_read_b32 v23, a147
    v_mul_f32 v20, v20, v19
    v_mul_f32 v21, v21, v19
    v_mul_f32 v22, v22, v19
    v_mul_f32 v23, v23, v19
    v_accvgpr_write_b32 a144, v20
    v_accvgpr_write_b32 a145, v21
    v_accvgpr_write_b32 a146, v22
    v_accvgpr_write_b32 a147, v23
L_slow2_b11:
    v_sub_f32 v112, v112, v18
    v_sub_f32 v113, v113, v18
    v_sub_f32 v114, v114, v18
    v_sub_f32 v115, v115, v18
    v_sub_f32 v116, v116, v18
    v_sub_f32 v117, v117, v18
    v_sub_f32 v118, v118, v18
    v_sub_f32 v119, v119, v18
    v_sub_f32 v120, v120, v18
    v_sub_f32 v121, v121, v18
    v_sub_f32 v122, v122, v18
    v_sub_f32 v123, v123, v18
    v_sub_f32 v124, v124, v18
    v_sub_f32 v125, v125, v18
    v_sub_f32 v126, v126, v18
    v_sub_f32 v127, v127, v18
    v_sub_f32 v208, v208, v18
    v_sub_f32 v209, v209, v18
    v_sub_f32 v210, v210, v18
    v_sub_f32 v211, v211, v18
    v_sub_f32 v212, v212, v18
    v_sub_f32 v213, v213, v18
    v_sub_f32 v214, v214, v18
    v_sub_f32 v215, v215, v18
    v_sub_f32 v216, v216, v18
    v_sub_f32 v217, v217, v18
    v_sub_f32 v218, v218, v18
    v_sub_f32 v219, v219, v18
    v_sub_f32 v220, v220, v18
    v_sub_f32 v221, v221, v18
    v_sub_f32 v222, v222, v18
    v_sub_f32 v223, v223, v18
    s_nop 1
    s_branch L_back_b11
L_typeA:
    s_lshl_b32 s39, s47, 16
    s_lshl_b32 s37, s46, 12
    s_add_u32 s39, s39, s37
    s_add_u32 s26, s26, s37
    s_lshl_b32 s37, s47, 16
    s_sub_u32 s37, s37, s28
    v_add_u32 v224, s37, v224
    v_add_u32 v232, s37, v232
    v_add_u32 v225, s37, v225
    v_add_u32 v233, s37, v233
    v_add_u32 v226, s37, v226
    v_add_u32 v234, s37, v234
    v_add_u32 v227, s37, v227
    v_add_u32 v235, s37, v235
    v_add_u32 v228, s37, v228
    v_add_u32 v236, s37, v236
    v_add_u32 v229, s37, v229
    v_add_u32 v237, s37, v237
    v_add_u32 v230, s37, v230
    v_add_u32 v238, s37, v238
    v_add_u32 v231, s37, v231
    v_add_u32 v239, s37, v239
    s_lshl_b32 s83, s82, 7
    s_add_u32 s83, s83, s29
    s_mul_i32 s84, s82, 524288
    s_add_u32 s84, s84, s30
    s_add_u32 s82, s82, 1
    s_and_b32 s82, s82, 7
    s_add_u32 m0, s80, 0
    s_add_u32 s37, s83, 0
    buffer_load_dwordx4 v32, s[12:15], s37 offen lds
    buffer_load_dwordx4 v33, s[12:15], s37 offen offset:1024 lds
    s_add_u32 m0, s80, 65536
    s_add_u32 s37, s84, 0
    buffer_load_dwordx4 v34, s[16:19], s37 offen lds
    buffer_load_dwordx4 v35, s[16:19], s37 offen offset:1024 lds
    s_add_u32 m0, s80, 8192
    s_add_u32 s37, s84, 262144
    buffer_load_dwordx4 v34, s[16:19], s37 offen lds
    buffer_load_dwordx4 v35, s[16:19], s37 offen offset:1024 lds
    s_add_u32 m0, s80, 73728
    s_add_u32 s37, s84, 256
    buffer_load_dwordx4 v34, s[16:19], s37 offen lds
    buffer_load_dwordx4 v35, s[16:19], s37 offen offset:1024 lds
    s_add_u32 m0, s80, 32768
    s_add_u32 s37, s84, 262400
    buffer_load_dwordx4 v34, s[16:19], s37 offen lds
    buffer_load_dwordx4 v35, s[16:19], s37 offen offset:1024 lds
    s_lshl_b32 s83, s82, 7
    s_add_u32 s83, s83, s29
    s_mul_i32 s84, s82, 524288
    s_add_u32 s84, s84, s30
    s_add_u32 s82, s82, 1
    s_and_b32 s82, s82, 7
    s_add_u32 m0, s80, 98304
    s_add_u32 s37, s83, 0
    buffer_load_dwordx4 v32, s[12:15], s37 offen lds
    buffer_load_dwordx4 v33, s[12:15], s37 offen offset:1024 lds
    s_add_u32 m0, s80, 40960
    s_add_u32 s37, s84, 0
    buffer_load_dwordx4 v34, s[16:19], s37 offen lds
    buffer_load_dwordx4 v35, s[16:19], s37 offen offset:1024 lds
    s_add_u32 m0, s80, 106496
    s_add_u32 s37, s84, 262144
    buffer_load_dwordx4 v34, s[16:19], s37 offen lds
    buffer_load_dwordx4 v35, s[16:19], s37 offen offset:1024 lds
    s_add_u32 m0, s80, 16384
    s_add_u32 s37, s84, 256
    buffer_load_dwordx4 v34, s[16:19], s37 offen lds
    buffer_load_dwordx4 v35, s[16:19], s37 offen offset:1024 lds
    s_add_u32 m0, s80, 81920
    s_add_u32 s37, s84, 262400
    buffer_load_dwordx4 v34, s[16:19], s37 offen lds
    buffer_load_dwordx4 v35, s[16:19], s37 offen offset:1024 lds
    s_lshl_b32 s83, s82, 7
    s_add_u32 s83, s83, s29
    s_mul_i32 s84, s82, 524288
    s_add_u32 s84, s84, s30
    s_add_u32 s82, s82, 1
    s_and_b32 s82, s82, 7
    s_add_u32 m0, s80, 24576
    s_add_u32 s37, s83, 0
    buffer_load_dwordx4 v32, s[12:15], s37 offen lds
    buffer_load_dwordx4 v33, s[12:15], s37 offen offset:1024 lds
    s_add_u32 m0, s80, 90112
    s_add_u32 s37, s84, 0
    buffer_load_dwordx4 v34, s[16:19], s37 offen lds
    buffer_load_dwordx4 v35, s[16:19], s37 offen offset:1024 lds
    s_add_u32 m0, s80, 49152
    s_add_u32 s37, s84, 262144
    buffer_load_dwordx4 v34, s[16:19], s37 offen lds
    buffer_load_dwordx4 v35, s[16:19], s37 offen offset:1024 lds
    s_add_u32 m0, s80, 114688
    s_add_u32 s37, s84, 256
    buffer_load_dwordx4 v34, s[16:19], s37 offen lds
    buffer_load_dwordx4 v35, s[16:19], s37 offen offset:1024 lds
    s_add_u32 m0, s80, 57344
    s_add_u32 s37, s84, 262400
    buffer_load_dwordx4 v34, s[16:19], s37 offen lds
    buffer_load_dwordx4 v35, s[16:19], s37 offen offset:1024 lds
    v_mov_b32 v192, 0
    v_mov_b32 v193, 0
    v_mov_b32 v194, 0
    v_mov_b32 v195, 0
    v_mov_b32 v196, 0
    v_mov_b32 v197, 0
    v_mov_b32 v198, 0
    v_mov_b32 v199, 0
    v_mov_b32 v200, 0
    v_mov_b32 v201, 0
    v_mov_b32 v202, 0
    v_mov_b32 v203, 0
    v_mov_b32 v204, 0
    v_mov_b32 v205, 0
    v_mov_b32 v206, 0
    v_mov_b32 v207, 0
    v_mov_b32 v208, 0
    v_mov_b32 v209, 0
    v_mov_b32 v210, 0
    v_mov_b32 v211, 0
    v_mov_b32 v212, 0
    v_mov_b32 v213, 0
    v_mov_b32 v214, 0
    v_mov_b32 v215, 0
    v_mov_b32 v216, 0
    v_mov_b32 v217, 0
    v_mov_b32 v218, 0
    v_mov_b32 v219, 0
    v_mov_b32 v220, 0
    v_mov_b32 v221, 0
    v_mov_b32 v222, 0
    v_mov_b32 v223, 0
    v_mov_b32 v240, 0x3f803f80
    v_mov_b32 v241, 0x3f803f80
    v_mov_b32 v242, 0x3f803f80
    v_mov_b32 v243, 0x3f803f80
    s_mov_b32 s41, 0xff800000
    s_nop 1
    v_mfma_f32_32x32x16_bf16 a[0:15], v[192:195], v[192:195], 0
    v_mfma_f32_32x32x16_bf16 a[16:31], v[192:195], v[192:195], 0
    v_mfma_f32_32x32x16_bf16 a[32:47], v[192:195], v[192:195], 0
    v_mfma_f32_32x32x16_bf16 a[48:63], v[192:195], v[192:195], 0
    v_mfma_f32_32x32x16_bf16 a[64:79], v[192:195], v[192:195], 0
    v_mfma_f32_32x32x16_bf16 a[80:95], v[192:195], v[192:195], 0
    v_mfma_f32_32x32x16_bf16 a[96:111], v[192:195], v[192:195], 0
    v_mfma_f32_32x32x16_bf16 a[112:127], v[192:195], v[192:195], 0
    v_mfma_f32_32x32x16_bf16 a[128:143], v[192:195], v[192:195], 0
    v_mfma_f32_32x32x16_bf16 a[144:159], v[192:195], v[192:195], 0
    s_waitcnt vmcnt(20)
    s_barrier
    s_mov_b32 s81, 65536
    s_cmp_eq_u32 s46, 0
    s_cselect_b32 s81, s81, 73728
    v_add_u32 v44, 0, v36
    ds_read_b128 v[64:67], v44 offset:0
    ds_read_b128 v[80:83], v44 offset:4096
    v_add_u32 v44, 0, v37
    ds_read_b128 v[68:71], v44 offset:0
    ds_read_b128 v[84:87], v44 offset:4096
    v_add_u32 v44, s81, v40
    ds_read_b64_tr_b16 v[96:97], v44 offset:0
    ds_read_b64_tr_b16 v[100:101], v44 offset:4096
    v_add_u32 v45, s81, v41
    ds_read_b64_tr_b16 v[98:99], v45 offset:1024
    ds_read_b64_tr_b16 v[102:103], v45 offset:5120
    v_add_u32 v44, s81, v42
    ds_read_b64_tr_b16 v[112:113], v44 offset:0
    ds_read_b64_tr_b16 v[116:117], v44 offset:4096
    v_add_u32 v45, s81, v43
    ds_read_b64_tr_b16 v[114:115], v45 offset:1024
    ds_read_b64_tr_b16 v[118:119], v45 offset:5120
    s_lshl_b32 s83, s82, 7
    s_add_u32 s83, s83, s29
    s_mul_i32 s84, s82, 524288
    s_add_u32 s84, s84, s30
    s_add_u32 s82, s82, 1
    s_and_b32 s82, s82, 7
    s_add_u32 m0, s80, 122880
    s_add_u32 s37, s83, 0
    buffer_load_dwordx4 v32, s[12:15], s37 offen lds
    buffer_load_dwordx4 v33, s[12:15], s37 offen offset:1024 lds
    s_waitcnt lgkmcnt(0)
    v_mfma_f32_32x32x16_bf16 v[128:143], v[96:99], v[64:67], 0
    s_mov_b32 s81, 8192
    s_cmp_eq_u32 s46, 0
    s_cselect_b32 s81, s81, 32768
    v_mfma_f32_32x32x16_bf16 v[144:159], v[96:99], v[80:83], 0
    v_add_u32 v44, 0, v38
    ds_read_b128 v[72:75], v44 offset:0
    ds_read_b128 v[88:91], v44 offset:4096
    v_mfma_f32_32x32x16_bf16 v[160:175], v[112:115], v[64:67], 0
    v_add_u32 v44, 0, v39
    ds_read_b128 v[76:79], v44 offset:0
    v_mfma_f32_32x32x16_bf16 v[176:191], v[112:115], v[80:83], 0
    ds_read_b128 v[92:95], v44 offset:4096
    v_add_u32 v44, s81, v40
    ds_read_b64_tr_b16 v[104:105], v44 offset:0
    v_mfma_f32_32x32x16_bf16 v[128:143], v[100:103], v[68:71], v[128:143]
    ds_read_b64_tr_b16 v[108:109], v44 offset:4096
    v_add_u32 v45, s81, v41
    ds_read_b64_tr_b16 v[106:107], v45 offset:1024
    v_mfma_f32_32x32x16_bf16 v[144:159], v[100:103], v[84:87], v[144:159]
    ds_read_b64_tr_b16 v[110:111], v45 offset:5120
    v_add_u32 v44, s81, v42
    v_mfma_f32_32x32x16_bf16 v[160:175], v[116:119], v[68:71], v[160:175]
    ds_read_b64_tr_b16 v[120:121], v44 offset:0
    ds_read_b64_tr_b16 v[124:125], v44 offset:4096
    v_add_u32 v45, s81, v43
    v_mfma_f32_32x32x16_bf16 v[176:191], v[116:119], v[84:87], v[176:191]
    ds_read_b64_tr_b16 v[122:123], v45 offset:1024
    ds_read_b64_tr_b16 v[126:127], v45 offset:5120
    s_waitcnt lgkmcnt(0)
    v_mfma_f32_32x32x16_bf16 v[128:143], v[104:107], v[72:75], v[128:143]
    s_add_u32 m0, s80, 131072
    s_add_u32 s37, s84, 0
    v_mfma_f32_32x32x16_bf16 v[144:159], v[104:107], v[88:91], v[144:159]
    buffer_load_dwordx4 v34, s[16:19], s37 offen lds
    buffer_load_dwordx4 v35, s[16:19], s37 offen offset:1024 lds
    v_mfma_f32_32x32x16_bf16 v[160:175], v[120:123], v[72:75], v[160:175]
    s_add_u32 m0, s80, 139264
    s_add_u32 s37, s84, 262144
    v_mfma_f32_32x32x16_bf16 v[176:191], v[120:123], v[88:91], v[176:191]
    buffer_load_dwordx4 v34, s[16:19], s37 offen lds
    buffer_load_dwordx4 v35, s[16:19], s37 offen offset:1024 lds
    v_mfma_f32_32x32x16_bf16 v[128:143], v[108:111], v[76:79], v[128:143]
    s_add_u32 m0, s80, 147456
    s_add_u32 s37, s84, 256
    buffer_load_dwordx4 v34, s[16:19], s37 offen lds
    v_mfma_f32_32x32x16_bf16 v[144:159], v[108:111], v[92:95], v[144:159]
    buffer_load_dwordx4 v35, s[16:19], s37 offen offset:1024 lds
    v_mfma_f32_32x32x16_bf16 v[160:175], v[124:127], v[76:79], v[160:175]
    s_add_u32 m0, s80, 155648
    s_add_u32 s37, s84, 262400
    buffer_load_dwordx4 v34, s[16:19], s37 offen lds
    v_mfma_f32_32x32x16_bf16 v[176:191], v[124:127], v[92:95], v[176:191]
    buffer_load_dwordx4 v35, s[16:19], s37 offen offset:1024 lds
    s_waitcnt vmcnt(20)
    s_barrier
    s_mov_b32 s81, 40960
    s_cmp_eq_u32 s46, 0
    s_cselect_b32 s81, s81, 16384
    v_add_u32 v44, 98304, v36
    ds_read_b128 v[64:67], v44 offset:0
    ds_read_b128 v[80:83], v44 offset:4096
    v_add_u32 v44, 98304, v37
    ds_read_b128 v[68:71], v44 offset:0
    ds_read_b128 v[84:87], v44 offset:4096
    v_add_u32 v44, s81, v40
    ds_read_b64_tr_b16 v[96:97], v44 offset:0
    ds_read_b64_tr_b16 v[100:101], v44 offset:4096
    v_add_u32 v45, s81, v41
    ds_read_b64_tr_b16 v[98:99], v45 offset:1024
    ds_read_b64_tr_b16 v[102:103], v45 offset:5120
    v_add_u32 v44, s81, v42
    ds_read_b64_tr_b16 v[112:113], v44 offset:0
    ds_read_b64_tr_b16 v[116:117], v44 offset:4096
    v_add_u32 v45, s81, v43
    ds_read_b64_tr_b16 v[114:115], v45 offset:1024
    ds_read_b64_tr_b16 v[118:119], v45 offset:5120
    s_add_u32 m0, s39, 0
    s_add_u32 s37, s26, 0
    buffer_load_dwordx4 v5, s[4:7], s37 offen offset:0 lds
    buffer_load_dwordx4 v6, s[4:7], s37 offen offset:1024 lds
    s_waitcnt lgkmcnt(0)
    v_mfma_f32_32x32x16_bf16 v[128:143], v[96:99], v[64:67], v[128:143]
    s_mov_b32 s81, 106496
    s_cmp_eq_u32 s46, 0
    s_cselect_b32 s81, s81, 81920
    v_mfma_f32_32x32x16_bf16 v[144:159], v[96:99], v[80:83], v[144:159]
    v_add_u32 v44, 98304, v38
    ds_read_b128 v[72:75], v44 offset:0
    ds_read_b128 v[88:91], v44 offset:4096
    v_mfma_f32_32x32x16_bf16 v[160:175], v[112:115], v[64:67], v[160:175]
    v_add_u32 v44, 98304, v39
    ds_read_b128 v[76:79], v44 offset:0
    v_mfma_f32_32x32x16_bf16 v[176:191], v[112:115], v[80:83], v[176:191]
    ds_read_b128 v[92:95], v44 offset:4096
    v_add_u32 v44, s81, v40
    ds_read_b64_tr_b16 v[104:105], v44 offset:0
    v_mfma_f32_32x32x16_bf16 v[128:143], v[100:103], v[68:71], v[128:143]
    ds_read_b64_tr_b16 v[108:109], v44 offset:4096
    v_add_u32 v45, s81, v41
    ds_read_b64_tr_b16 v[106:107], v45 offset:1024
    v_mfma_f32_32x32x16_bf16 v[144:159], v[100:103], v[84:87], v[144:159]
    ds_read_b64_tr_b16 v[110:111], v45 offset:5120
    v_add_u32 v44, s81, v42
    v_mfma_f32_32x32x16_bf16 v[160:175], v[116:119], v[68:71], v[160:175]
    ds_read_b64_tr_b16 v[120:121], v44 offset:0
    ds_read_b64_tr_b16 v[124:125], v44 offset:4096
    v_add_u32 v45, s81, v43
    v_mfma_f32_32x32x16_bf16 v[176:191], v[116:119], v[84:87], v[176:191]
    ds_read_b64_tr_b16 v[122:123], v45 offset:1024
    ds_read_b64_tr_b16 v[126:127], v45 offset:5120
    s_waitcnt lgkmcnt(0)
    v_mfma_f32_32x32x16_bf16 v[128:143], v[104:107], v[72:75], v[128:143]
    buffer_load_dwordx4 v7, s[4:7], s37 offen offset:2048 lds
    v_mfma_f32_32x32x16_bf16 v[144:159], v[104:107], v[88:91], v[144:159]
    buffer_load_dwordx4 v8, s[4:7], s37 offen offset:3072 lds
    v_mfma_f32_32x32x16_bf16 v[160:175], v[120:123], v[72:75], v[160:175]
    s_add_u32 m0, s39, 8192
    v_mfma_f32_32x32x16_bf16 v[176:191], v[120:123], v[88:91], v[176:191]
    s_add_u32 s37, s26, 0
    v_mfma_f32_32x32x16_bf16 v[128:143], v[108:111], v[76:79], v[128:143]
    buffer_load_dwordx4 v5, s[8:11], s37 offen offset:0 lds
    v_mfma_f32_32x32x16_bf16 v[144:159], v[108:111], v[92:95], v[144:159]
    buffer_load_dwordx4 v6, s[8:11], s37 offen offset:1024 lds
    v_mfma_f32_32x32x16_bf16 v[160:175], v[124:127], v[76:79], v[160:175]
    buffer_load_dwordx4 v7, s[8:11], s37 offen offset:2048 lds
    v_mfma_f32_32x32x16_bf16 v[176:191], v[124:127], v[92:95], v[176:191]
    buffer_load_dwordx4 v8, s[8:11], s37 offen offset:3072 lds
    s_waitcnt vmcnt(18)
    s_barrier
    s_mov_b32 s81, 90112
    s_cmp_eq_u32 s46, 0
    s_cselect_b32 s81, s81, 114688
    v_add_u32 v44, 24576, v36
    ds_read_b128 v[64:67], v44 offset:0
    ds_read_b128 v[80:83], v44 offset:4096
    v_add_u32 v44, 24576, v37
    ds_read_b128 v[68:71], v44 offset:0
    ds_read_b128 v[84:87], v44 offset:4096
    v_add_u32 v44, s81, v40
    ds_read_b64_tr_b16 v[96:97], v44 offset:0
    ds_read_b64_tr_b16 v[100:101], v44 offset:4096
    v_add_u32 v45, s81, v41
    ds_read_b64_tr_b16 v[98:99], v45 offset:1024
    ds_read_b64_tr_b16 v[102:103], v45 offset:5120
    v_add_u32 v44, s81, v42
    ds_read_b64_tr_b16 v[112:113], v44 offset:0
    ds_read_b64_tr_b16 v[116:117], v44 offset:4096
    v_add_u32 v45, s81, v43
    ds_read_b64_tr_b16 v[114:115], v45 offset:1024
    ds_read_b64_tr_b16 v[118:119], v45 offset:5120
    s_add_u32 m0, s39, 32768
    s_add_u32 s37, s26, 16384
    buffer_load_dwordx4 v5, s[4:7], s37 offen offset:0 lds
    buffer_load_dwordx4 v6, s[4:7], s37 offen offset:1024 lds
    buffer_load_dwordx4 v7, s[4:7], s37 offen offset:2048 lds
    buffer_load_dwordx4 v8, s[4:7], s37 offen offset:3072 lds
    s_add_u32 m0, s39, 40960
    s_add_u32 s37, s26, 16384
    buffer_load_dwordx4 v5, s[8:11], s37 offen offset:0 lds
    s_waitcnt lgkmcnt(0)
    v_mfma_f32_32x32x16_bf16 v[128:143], v[96:99], v[64:67], v[128:143]
    s_mov_b32 s81, 49152
    s_cmp_eq_u32 s46, 0
    s_cselect_b32 s81, s81, 57344
    v_mfma_f32_32x32x16_bf16 v[144:159], v[96:99], v[80:83], v[144:159]
    v_add_u32 v44, 24576, v38
    ds_read_b128 v[72:75], v44 offset:0
    ds_read_b128 v[88:91], v44 offset:4096
    v_mfma_f32_32x32x16_bf16 v[160:175], v[112:115], v[64:67], v[160:175]
    v_add_u32 v44, 24576, v39
    ds_read_b128 v[76:79], v44 offset:0
    v_mfma_f32_32x32x16_bf16 v[176:191], v[112:115], v[80:83], v[176:191]
    ds_read_b128 v[92:95], v44 offset:4096
    v_add_u32 v44, s81, v40
    ds_read_b64_tr_b16 v[104:105], v44 offset:0
    v_mfma_f32_32x32x16_bf16 v[128:143], v[100:103], v[68:71], v[128:143]
    ds_read_b64_tr_b16 v[108:109], v44 offset:4096
    v_add_u32 v45, s81, v41
    ds_read_b64_tr_b16 v[106:107], v45 offset:1024
    v_mfma_f32_32x32x16_bf16 v[144:159], v[100:103], v[84:87], v[144:159]
    ds_read_b64_tr_b16 v[110:111], v45 offset:5120
    v_add_u32 v44, s81, v42
    v_mfma_f32_32x32x16_bf16 v[160:175], v[116:119], v[68:71], v[160:175]
    ds_read_b64_tr_b16 v[120:121], v44 offset:0
    ds_read_b64_tr_b16 v[124:125], v44 offset:4096
    v_add_u32 v45, s81, v43
    v_mfma_f32_32x32x16_bf16 v[176:191], v[116:119], v[84:87], v[176:191]
    ds_read_b64_tr_b16 v[122:123], v45 offset:1024
    ds_read_b64_tr_b16 v[126:127], v45 offset:5120
    s_waitcnt lgkmcnt(0)
    v_mfma_f32_32x32x16_bf16 v[128:143], v[104:107], v[72:75], v[128:143]
    buffer_load_dwordx4 v6, s[8:11], s37 offen offset:1024 lds
    buffer_load_dwordx4 v7, s[8:11], s37 offen offset:2048 lds
    buffer_load_dwordx4 v8, s[8:11], s37 offen offset:3072 lds
    v_mfma_f32_32x32x16_bf16 v[144:159], v[104:107], v[88:91], v[144:159]
    s_lshl_b32 s83, s82, 7
    s_add_u32 s83, s83, s29
    v_mfma_f32_32x32x16_bf16 v[160:175], v[120:123], v[72:75], v[160:175]
    s_mul_i32 s84, s82, 524288
    s_add_u32 s84, s84, s30
    s_add_u32 s82, s82, 1
    v_mfma_f32_32x32x16_bf16 v[176:191], v[120:123], v[88:91], v[176:191]
    s_and_b32 s82, s82, 7
    s_add_u32 m0, s80, 81920
    v_mfma_f32_32x32x16_bf16 v[128:143], v[108:111], v[76:79], v[128:143]
    s_add_u32 s37, s83, 0
    buffer_load_dwordx4 v32, s[12:15], s37 offen lds
    v_mfma_f32_32x32x16_bf16 v[144:159], v[108:111], v[92:95], v[144:159]
    buffer_load_dwordx4 v33, s[12:15], s37 offen offset:1024 lds
    s_add_u32 m0, s80, 16384
    v_mfma_f32_32x32x16_bf16 v[160:175], v[124:127], v[76:79], v[160:175]
    s_add_u32 s37, s84, 0
    buffer_load_dwordx4 v34, s[16:19], s37 offen lds
    v_mfma_f32_32x32x16_bf16 v[176:191], v[124:127], v[92:95], v[176:191]
    buffer_load_dwordx4 v35, s[16:19], s37 offen offset:1024 lds
    s_waitcnt vmcnt(20)
    s_barrier
    s_mov_b32 s81, 131072
    s_cmp_eq_u32 s46, 0
    s_cselect_b32 s81, s81, 147456
    v_add_u32 v44, 122880, v36
    ds_read_b128 v[64:67], v44 offset:0
    ds_read_b128 v[80:83], v44 offset:4096
    v_add_u32 v44, 122880, v37
    ds_read_b128 v[68:71], v44 offset:0
    ds_read_b128 v[84:87], v44 offset:4096
    v_add_u32 v44, s81, v40
    ds_read_b64_tr_b16 v[96:97], v44 offset:0
    ds_read_b64_tr_b16 v[100:101], v44 offset:4096
    v_add_u32 v45, s81, v41
    ds_read_b64_tr_b16 v[98:99], v45 offset:1024
    ds_read_b64_tr_b16 v[102:103], v45 offset:5120
    v_add_u32 v44, s81, v42
    ds_read_b64_tr_b16 v[112:113], v44 offset:0
    ds_read_b64_tr_b16 v[116:117], v44 offset:4096
    v_add_u32 v45, s81, v43
    ds_read_b64_tr_b16 v[114:115], v45 offset:1024
    ds_read_b64_tr_b16 v[118:119], v45 offset:5120
    s_add_u32 m0, s80, 57344
    s_add_u32 s37, s84, 262144
    buffer_load_dwordx4 v34, s[16:19], s37 offen lds
    buffer_load_dwordx4 v35, s[16:19], s37 offen offset:1024 lds
    s_add_u32 m0, s80, 114688
    s_add_u32 s37, s84, 256
    buffer_load_dwordx4 v34, s[16:19], s37 offen lds
    buffer_load_dwordx4 v35, s[16:19], s37 offen offset:1024 lds
    s_waitcnt lgkmcnt(0)
    v_mfma_f32_32x32x16_bf16 v[128:143], v[96:99], v[64:67], v[128:143]
    s_mov_b32 s81, 139264
    s_cmp_eq_u32 s46, 0
    s_cselect_b32 s81, s81, 155648
    v_mfma_f32_32x32x16_bf16 v[144:159], v[96:99], v[80:83], v[144:159]
    v_add_u32 v44, 122880, v38
    ds_read_b128 v[72:75], v44 offset:0
    ds_read_b128 v[88:91], v44 offset:4096
    v_mfma_f32_32x32x16_bf16 v[160:175], v[112:115], v[64:67], v[160:175]
    v_add_u32 v44, 122880, v39
    ds_read_b128 v[76:79], v44 offset:0
    v_mfma_f32_32x32x16_bf16 v[176:191], v[112:115], v[80:83], v[176:191]
    ds_read_b128 v[92:95], v44 offset:4096
    v_add_u32 v44, s81, v40
    ds_read_b64_tr_b16 v[104:105], v44 offset:0
    v_mfma_f32_32x32x16_bf16 v[128:143], v[100:103], v[68:71], v[128:143]
    ds_read_b64_tr_b16 v[108:109], v44 offset:4096
    v_add_u32 v45, s81, v41
    ds_read_b64_tr_b16 v[106:107], v45 offset:1024
    v_mfma_f32_32x32x16_bf16 v[144:159], v[100:103], v[84:87], v[144:159]
    ds_read_b64_tr_b16 v[110:111], v45 offset:5120
    v_add_u32 v44, s81, v42
    v_mfma_f32_32x32x16_bf16 v[160:175], v[116:119], v[68:71], v[160:175]
    ds_read_b64_tr_b16 v[120:121], v44 offset:0
    ds_read_b64_tr_b16 v[124:125], v44 offset:4096
    v_add_u32 v45, s81, v43
    v_mfma_f32_32x32x16_bf16 v[176:191], v[116:119], v[84:87], v[176:191]
    ds_read_b64_tr_b16 v[122:123], v45 offset:1024
    ds_read_b64_tr_b16 v[126:127], v45 offset:5120
    s_waitcnt lgkmcnt(0)
    v_mfma_f32_32x32x16_bf16 v[128:143], v[104:107], v[72:75], v[128:143]
    s_add_u32 m0, s80, 49152
    s_add_u32 s37, s84, 262400
    buffer_load_dwordx4 v34, s[16:19], s37 offen lds
    v_mfma_f32_32x32x16_bf16 v[144:159], v[104:107], v[88:91], v[144:159]
    buffer_load_dwordx4 v35, s[16:19], s37 offen offset:1024 lds
    s_lshl_b32 s83, s82, 7
    v_mfma_f32_32x32x16_bf16 v[160:175], v[120:123], v[72:75], v[160:175]
    s_add_u32 s83, s83, s29
    s_mul_i32 s84, s82, 524288
    v_mfma_f32_32x32x16_bf16 v[176:191], v[120:123], v[88:91], v[176:191]
    s_add_u32 s84, s84, s30
    s_add_u32 s82, s82, 1
    s_and_b32 s82, s82, 7
    v_mfma_f32_32x32x16_bf16 v[128:143], v[108:111], v[76:79], v[128:143]
    s_add_u32 m0, s80, 90112
    s_add_u32 s37, s83, 0
    buffer_load_dwordx4 v32, s[12:15], s37 offen lds
    v_mfma_f32_32x32x16_bf16 v[144:159], v[108:111], v[92:95], v[144:159]
    buffer_load_dwordx4 v33, s[12:15], s37 offen offset:1024 lds
    v_mfma_f32_32x32x16_bf16 v[160:175], v[124:127], v[76:79], v[160:175]
    s_add_u32 m0, s80, 24576
    s_add_u32 s37, s84, 0
    buffer_load_dwordx4 v34, s[16:19], s37 offen lds
    v_mfma_f32_32x32x16_bf16 v[176:191], v[124:127], v[92:95], v[176:191]
    buffer_load_dwordx4 v35, s[16:19], s37 offen offset:1024 lds
    s_waitcnt vmcnt(4)
    s_barrier
    s_mov_b32 s81, 16384
    s_cmp_eq_u32 s46, 0
    s_cselect_b32 s81, s81, 114688
    v_add_u32 v44, 81920, v36
    ds_read_b128 v[64:67], v44 offset:0
    ds_read_b128 v[80:83], v44 offset:4096
    v_add_u32 v44, 81920, v37
    ds_read_b128 v[68:71], v44 offset:0
    ds_read_b128 v[84:87], v44 offset:4096
    v_add_u32 v44, s81, v40
    ds_read_b64_tr_b16 v[96:97], v44 offset:0
    ds_read_b64_tr_b16 v[100:101], v44 offset:4096
    v_add_u32 v45, s81, v41
    ds_read_b64_tr_b16 v[98:99], v45 offset:1024
    ds_read_b64_tr_b16 v[102:103], v45 offset:5120
    v_add_u32 v44, s81, v42
    ds_read_b64_tr_b16 v[112:113], v44 offset:0
    ds_read_b64_tr_b16 v[116:117], v44 offset:4096
    v_add_u32 v45, s81, v43
    ds_read_b64_tr_b16 v[114:115], v45 offset:1024
    ds_read_b64_tr_b16 v[118:119], v45 offset:5120
    s_add_u32 m0, s80, 155648
    s_add_u32 s37, s84, 262144
    buffer_load_dwordx4 v34, s[16:19], s37 offen lds
    buffer_load_dwordx4 v35, s[16:19], s37 offen offset:1024 lds
    s_add_u32 m0, s80, 147456
    s_add_u32 s37, s84, 256
    buffer_load_dwordx4 v34, s[16:19], s37 offen lds
    buffer_load_dwordx4 v35, s[16:19], s37 offen offset:1024 lds
    s_waitcnt lgkmcnt(0)
    v_mfma_f32_32x32x16_bf16 v[128:143], v[96:99], v[64:67], v[128:143]
    s_mov_b32 s81, 57344
    s_cmp_eq_u32 s46, 0
    s_cselect_b32 s81, s81, 49152
    v_mfma_f32_32x32x16_bf16 v[144:159], v[96:99], v[80:83], v[144:159]
    v_add_u32 v44, 81920, v38
    ds_read_b128 v[72:75], v44 offset:0
    ds_read_b128 v[88:91], v44 offset:4096
    v_mfma_f32_32x32x16_bf16 v[160:175], v[112:115], v[64:67], v[160:175]
    v_add_u32 v44, 81920, v39
    ds_read_b128 v[76:79], v44 offset:0
    v_mfma_f32_32x32x16_bf16 v[176:191], v[112:115], v[80:83], v[176:191]
    ds_read_b128 v[92:95], v44 offset:4096
    v_add_u32 v44, s81, v40
    ds_read_b64_tr_b16 v[104:105], v44 offset:0
    v_mfma_f32_32x32x16_bf16 v[128:143], v[100:103], v[68:71], v[128:143]
    ds_read_b64_tr_b16 v[108:109], v44 offset:4096
    v_add_u32 v45, s81, v41
    ds_read_b64_tr_b16 v[106:107], v45 offset:1024
    v_mfma_f32_32x32x16_bf16 v[144:159], v[100:103], v[84:87], v[144:159]
    ds_read_b64_tr_b16 v[110:111], v45 offset:5120
    v_add_u32 v44, s81, v42
    v_mfma_f32_32x32x16_bf16 v[160:175], v[116:119], v[68:71], v[160:175]
    ds_read_b64_tr_b16 v[120:121], v44 offset:0
    ds_read_b64_tr_b16 v[124:125], v44 offset:4096
    v_add_u32 v45, s81, v43
    v_mfma_f32_32x32x16_bf16 v[176:191], v[116:119], v[84:87], v[176:191]
    ds_read_b64_tr_b16 v[122:123], v45 offset:1024
    ds_read_b64_tr_b16 v[126:127], v45 offset:5120
    s_waitcnt lgkmcnt(0)
    v_mfma_f32_32x32x16_bf16 v[128:143], v[104:107], v[72:75], v[128:143]
    s_add_u32 m0, s80, 139264
    s_add_u32 s37, s84, 262400
    buffer_load_dwordx4 v34, s[16:19], s37 offen lds
    v_mfma_f32_32x32x16_bf16 v[144:159], v[104:107], v[88:91], v[144:159]
    buffer_load_dwordx4 v35, s[16:19], s37 offen offset:1024 lds
    s_lshl_b32 s83, s82, 7
    v_mfma_f32_32x32x16_bf16 v[160:175], v[120:123], v[72:75], v[160:175]
    s_add_u32 s83, s83, s29
    s_mul_i32 s84, s82, 524288
    v_mfma_f32_32x32x16_bf16 v[176:191], v[120:123], v[88:91], v[176:191]
    s_add_u32 s84, s84, s30
    s_add_u32 s82, s82, 1
    s_and_b32 s82, s82, 7
    v_mfma_f32_32x32x16_bf16 v[128:143], v[108:111], v[76:79], v[128:143]
    s_add_u32 m0, s80, 131072
    s_add_u32 s37, s83, 0
    buffer_load_dwordx4 v32, s[12:15], s37 offen lds
    v_mfma_f32_32x32x16_bf16 v[144:159], v[108:111], v[92:95], v[144:159]
    buffer_load_dwordx4 v33, s[12:15], s37 offen offset:1024 lds
    v_mfma_f32_32x32x16_bf16 v[160:175], v[124:127], v[76:79], v[160:175]
    s_add_u32 m0, s80, 122880
    s_add_u32 s37, s84, 0
    buffer_load_dwordx4 v34, s[16:19], s37 offen lds
    v_mfma_f32_32x32x16_bf16 v[176:191], v[124:127], v[92:95], v[176:191]
    buffer_load_dwordx4 v35, s[16:19], s37 offen offset:1024 lds
    s_waitcnt vmcnt(4)
    s_barrier
    s_mov_b32 s81, 24576
    s_cmp_eq_u32 s46, 0
    s_cselect_b32 s81, s81, 147456
    v_add_u32 v44, 90112, v36
    ds_read_b128 v[64:67], v44 offset:0
    ds_read_b128 v[80:83], v44 offset:4096
    v_add_u32 v44, 90112, v37
    ds_read_b128 v[68:71], v44 offset:0
    ds_read_b128 v[84:87], v44 offset:4096
    v_add_u32 v44, s81, v40
    ds_read_b64_tr_b16 v[96:97], v44 offset:0
    ds_read_b64_tr_b16 v[100:101], v44 offset:4096
    v_add_u32 v45, s81, v41
    ds_read_b64_tr_b16 v[98:99], v45 offset:1024
    ds_read_b64_tr_b16 v[102:103], v45 offset:5120
    v_add_u32 v44, s81, v42
    ds_read_b64_tr_b16 v[112:113], v44 offset:0
    ds_read_b64_tr_b16 v[116:117], v44 offset:4096
    v_add_u32 v45, s81, v43
    ds_read_b64_tr_b16 v[114:115], v45 offset:1024
    ds_read_b64_tr_b16 v[118:119], v45 offset:5120
    s_add_u32 m0, s80, 57344
    s_add_u32 s37, s84, 262144
    buffer_load_dwordx4 v34, s[16:19], s37 offen lds
    buffer_load_dwordx4 v35, s[16:19], s37 offen offset:1024 lds
    s_add_u32 m0, s80, 114688
    s_add_u32 s37, s84, 256
    buffer_load_dwordx4 v34, s[16:19], s37 offen lds
    buffer_load_dwordx4 v35, s[16:19], s37 offen offset:1024 lds
    s_waitcnt lgkmcnt(0)
    v_mfma_f32_32x32x16_bf16 v[128:143], v[96:99], v[64:67], v[128:143]
    s_mov_b32 s81, 155648
    s_cmp_eq_u32 s46, 0
    s_cselect_b32 s81, s81, 139264
    v_mfma_f32_32x32x16_bf16 v[144:159], v[96:99], v[80:83], v[144:159]
    v_add_u32 v44, 90112, v38
    ds_read_b128 v[72:75], v44 offset:0
    ds_read_b128 v[88:91], v44 offset:4096
    v_mfma_f32_32x32x16_bf16 v[160:175], v[112:115], v[64:67], v[160:175]
    v_add_u32 v44, 90112, v39
    ds_read_b128 v[76:79], v44 offset:0
    v_mfma_f32_32x32x16_bf16 v[176:191], v[112:115], v[80:83], v[176:191]
    ds_read_b128 v[92:95], v44 offset:4096
    v_add_u32 v44, s81, v40
    ds_read_b64_tr_b16 v[104:105], v44 offset:0
    v_mfma_f32_32x32x16_bf16 v[128:143], v[100:103], v[68:71], v[128:143]
    ds_read_b64_tr_b16 v[108:109], v44 offset:4096
    v_add_u32 v45, s81, v41
    ds_read_b64_tr_b16 v[106:107], v45 offset:1024
    v_mfma_f32_32x32x16_bf16 v[144:159], v[100:103], v[84:87], v[144:159]
    ds_read_b64_tr_b16 v[110:111], v45 offset:5120
    v_add_u32 v44, s81, v42
    v_mfma_f32_32x32x16_bf16 v[160:175], v[116:119], v[68:71], v[160:175]
    ds_read_b64_tr_b16 v[120:121], v44 offset:0
    ds_read_b64_tr_b16 v[124:125], v44 offset:4096
    v_add_u32 v45, s81, v43
    v_mfma_f32_32x32x16_bf16 v[176:191], v[116:119], v[84:87], v[176:191]
    ds_read_b64_tr_b16 v[122:123], v45 offset:1024
    ds_read_b64_tr_b16 v[126:127], v45 offset:5120
    s_waitcnt lgkmcnt(0)
    v_mfma_f32_32x32x16_bf16 v[128:143], v[104:107], v[72:75], v[128:143]
    s_add_u32 m0, s80, 49152
    s_add_u32 s37, s84, 262400
    buffer_load_dwordx4 v34, s[16:19], s37 offen lds
    v_mfma_f32_32x32x16_bf16 v[144:159], v[104:107], v[88:91], v[144:159]
    buffer_load_dwordx4 v35, s[16:19], s37 offen offset:1024 lds
    s_lshl_b32 s83, s82, 7
    v_mfma_f32_32x32x16_bf16 v[160:175], v[120:123], v[72:75], v[160:175]
    s_add_u32 s83, s83, s29
    s_mul_i32 s84, s82, 524288
    v_mfma_f32_32x32x16_bf16 v[176:191], v[120:123], v[88:91], v[176:191]
    s_add_u32 s84, s84, s30
    s_add_u32 s82, s82, 1
    s_and_b32 s82, s82, 7
    v_mfma_f32_32x32x16_bf16 v[128:143], v[108:111], v[76:79], v[128:143]
    s_add_u32 m0, s80, 81920
    s_add_u32 s37, s83, 0
    buffer_load_dwordx4 v32, s[12:15], s37 offen lds
    v_mfma_f32_32x32x16_bf16 v[144:159], v[108:111], v[92:95], v[144:159]
    buffer_load_dwordx4 v33, s[12:15], s37 offen offset:1024 lds
    v_mfma_f32_32x32x16_bf16 v[160:175], v[124:127], v[76:79], v[160:175]
    s_add_u32 m0, s80, 16384
    s_add_u32 s37, s84, 0
    buffer_load_dwordx4 v34, s[16:19], s37 offen lds
    v_mfma_f32_32x32x16_bf16 v[176:191], v[124:127], v[92:95], v[176:191]
    buffer_load_dwordx4 v35, s[16:19], s37 offen offset:1024 lds
    s_waitcnt vmcnt(4)
    s_barrier
    s_mov_b32 s81, 122880
    s_cmp_eq_u32 s46, 0
    s_cselect_b32 s81, s81, 114688
    v_add_u32 v44, 131072, v36
    ds_read_b128 v[64:67], v44 offset:0
    ds_read_b128 v[80:83], v44 offset:4096
    v_add_u32 v44, 131072, v37
    ds_read_b128 v[68:71], v44 offset:0
    ds_read_b128 v[84:87], v44 offset:4096
    v_add_u32 v44, s81, v40
    ds_read_b64_tr_b16 v[96:97], v44 offset:0
    ds_read_b64_tr_b16 v[100:101], v44 offset:4096
    v_add_u32 v45, s81, v41
    ds_read_b64_tr_b16 v[98:99], v45 offset:1024
    ds_read_b64_tr_b16 v[102:103], v45 offset:5120
    v_add_u32 v44, s81, v42
    ds_read_b64_tr_b16 v[112:113], v44 offset:0
    ds_read_b64_tr_b16 v[116:117], v44 offset:4096
    v_add_u32 v45, s81, v43
    ds_read_b64_tr_b16 v[114:115], v45 offset:1024
    ds_read_b64_tr_b16 v[118:119], v45 offset:5120
    s_add_u32 m0, s80, 155648
    s_add_u32 s37, s84, 262144
    buffer_load_dwordx4 v34, s[16:19], s37 offen lds
    buffer_load_dwordx4 v35, s[16:19], s37 offen offset:1024 lds
    s_waitcnt lgkmcnt(0)
    v_mfma_f32_32x32x16_bf16 v[128:143], v[96:99], v[64:67], v[128:143]
    s_mov_b32 s81, 57344
    s_cmp_eq_u32 s46, 0
    s_cselect_b32 s81, s81, 49152
    v_mfma_f32_32x32x16_bf16 v[144:159], v[96:99], v[80:83], v[144:159]
    v_add_u32 v44, 131072, v38
    ds_read_b128 v[72:75], v44 offset:0
    ds_read_b128 v[88:91], v44 offset:4096
    v_mfma_f32_32x32x16_bf16 v[160:175], v[112:115], v[64:67], v[160:175]
    v_add_u32 v44, 131072, v39
    ds_read_b128 v[76:79], v44 offset:0
    v_mfma_f32_32x32x16_bf16 v[176:191], v[112:115], v[80:83], v[176:191]
    ds_read_b128 v[92:95], v44 offset:4096
    v_add_u32 v44, s81, v40
    ds_read_b64_tr_b16 v[104:105], v44 offset:0
    v_mfma_f32_32x32x16_bf16 v[128:143], v[100:103], v[68:71], v[128:143]
    ds_read_b64_tr_b16 v[108:109], v44 offset:4096
    v_add_u32 v45, s81, v41
    ds_read_b64_tr_b16 v[106:107], v45 offset:1024
    v_mfma_f32_32x32x16_bf16 v[144:159], v[100:103], v[84:87], v[144:159]
    ds_read_b64_tr_b16 v[110:111], v45 offset:5120
    v_add_u32 v44, s81, v42
    v_mfma_f32_32x32x16_bf16 v[160:175], v[116:119], v[68:71], v[160:175]
    ds_read_b64_tr_b16 v[120:121], v44 offset:0
    ds_read_b64_tr_b16 v[124:125], v44 offset:4096
    v_add_u32 v45, s81, v43
    v_mfma_f32_32x32x16_bf16 v[176:191], v[116:119], v[84:87], v[176:191]
    ds_read_b64_tr_b16 v[122:123], v45 offset:1024
    ds_read_b64_tr_b16 v[126:127], v45 offset:5120
    s_waitcnt lgkmcnt(0)
    v_mfma_f32_32x32x16_bf16 v[128:143], v[104:107], v[72:75], v[128:143]
    s_add_u32 m0, s80, 147456
    s_add_u32 s37, s84, 256
    v_mfma_f32_32x32x16_bf16 v[144:159], v[104:107], v[88:91], v[144:159]
    buffer_load_dwordx4 v34, s[16:19], s37 offen lds
    v_mfma_f32_32x32x16_bf16 v[160:175], v[120:123], v[72:75], v[160:175]
    buffer_load_dwordx4 v35, s[16:19], s37 offen offset:1024 lds
    v_mfma_f32_32x32x16_bf16 v[176:191], v[120:123], v[88:91], v[176:191]
    v_mfma_f32_32x32x16_bf16 v[128:143], v[108:111], v[76:79], v[128:143]
    s_add_u32 m0, s80, 139264
    s_add_u32 s37, s84, 262400
    v_mfma_f32_32x32x16_bf16 v[144:159], v[108:111], v[92:95], v[144:159]
    buffer_load_dwordx4 v34, s[16:19], s37 offen lds
    v_mfma_f32_32x32x16_bf16 v[160:175], v[124:127], v[76:79], v[160:175]
    buffer_load_dwordx4 v35, s[16:19], s37 offen offset:1024 lds
    v_mfma_f32_32x32x16_bf16 v[176:191], v[124:127], v[92:95], v[176:191]
    s_waitcnt vmcnt(0)
    s_barrier
    s_mov_b32 s81, 16384
    s_cmp_eq_u32 s46, 0
    s_cselect_b32 s81, s81, 147456
    v_add_u32 v44, 81920, v36
    ds_read_b128 v[64:67], v44 offset:0
    ds_read_b128 v[80:83], v44 offset:4096
    v_add_u32 v44, 81920, v37
    ds_read_b128 v[68:71], v44 offset:0
    ds_read_b128 v[84:87], v44 offset:4096
    v_add_u32 v44, s81, v40
    ds_read_b64_tr_b16 v[96:97], v44 offset:0
    ds_read_b64_tr_b16 v[100:101], v44 offset:4096
    v_add_u32 v45, s81, v41
    ds_read_b64_tr_b16 v[98:99], v45 offset:1024
    ds_read_b64_tr_b16 v[102:103], v45 offset:5120
    v_add_u32 v44, s81, v42
    ds_read_b64_tr_b16 v[112:113], v44 offset:0
    ds_read_b64_tr_b16 v[116:117], v44 offset:4096
    v_add_u32 v45, s81, v43
    ds_read_b64_tr_b16 v[114:115], v45 offset:1024
    ds_read_b64_tr_b16 v[118:119], v45 offset:5120
    s_waitcnt lgkmcnt(0)
    v_mfma_f32_32x32x16_bf16 v[128:143], v[96:99], v[64:67], v[128:143]
    s_mov_b32 s81, 155648
    s_cmp_eq_u32 s46, 0
    s_cselect_b32 s81, s81, 139264
    v_mfma_f32_32x32x16_bf16 v[144:159], v[96:99], v[80:83], v[144:159]
    v_add_u32 v44, 81920, v38
    ds_read_b128 v[72:75], v44 offset:0
    ds_read_b128 v[88:91], v44 offset:4096
    v_mfma_f32_32x32x16_bf16 v[160:175], v[112:115], v[64:67], v[160:175]
    v_add_u32 v44, 81920, v39
    ds_read_b128 v[76:79], v44 offset:0
    v_mfma_f32_32x32x16_bf16 v[176:191], v[112:115], v[80:83], v[176:191]
    ds_read_b128 v[92:95], v44 offset:4096
    v_add_u32 v44, s81, v40
    ds_read_b64_tr_b16 v[104:105], v44 offset:0
    v_mfma_f32_32x32x16_bf16 v[128:143], v[100:103], v[68:71], v[128:143]
    ds_read_b64_tr_b16 v[108:109], v44 offset:4096
    v_add_u32 v45, s81, v41
    ds_read_b64_tr_b16 v[106:107], v45 offset:1024
    v_mfma_f32_32x32x16_bf16 v[144:159], v[100:103], v[84:87], v[144:159]
    ds_read_b64_tr_b16 v[110:111], v45 offset:5120
    v_add_u32 v44, s81, v42
    v_mfma_f32_32x32x16_bf16 v[160:175], v[116:119], v[68:71], v[160:175]
    ds_read_b64_tr_b16 v[120:121], v44 offset:0
    ds_read_b64_tr_b16 v[124:125], v44 offset:4096
    v_add_u32 v45, s81, v43
    v_mfma_f32_32x32x16_bf16 v[176:191], v[116:119], v[84:87], v[176:191]
    ds_read_b64_tr_b16 v[122:123], v45 offset:1024
    ds_read_b64_tr_b16 v[126:127], v45 offset:5120
    s_waitcnt lgkmcnt(0)
    v_mfma_f32_32x32x16_bf16 v[128:143], v[104:107], v[72:75], v[128:143]
    v_mfma_f32_32x32x16_bf16 v[144:159], v[104:107], v[88:91], v[144:159]
    v_mfma_f32_32x32x16_bf16 v[160:175], v[120:123], v[72:75], v[160:175]
    v_mfma_f32_32x32x16_bf16 v[176:191], v[120:123], v[88:91], v[176:191]
    v_mfma_f32_32x32x16_bf16 v[128:143], v[108:111], v[76:79], v[128:143]
    v_mfma_f32_32x32x16_bf16 v[144:159], v[108:111], v[92:95], v[144:159]
    v_mfma_f32_32x32x16_bf16 v[160:175], v[124:127], v[76:79], v[160:175]
    v_mfma_f32_32x32x16_bf16 v[176:191], v[124:127], v[92:95], v[176:191]
    s_barrier
    s_add_u32 m0, s39, 16384
    s_add_u32 s37, s26, 32768
    buffer_load_dwordx4 v5, s[4:7], s37 offen offset:0 lds
    buffer_load_dwordx4 v6, s[4:7], s37 offen offset:1024 lds
    buffer_load_dwordx4 v7, s[4:7], s37 offen offset:2048 lds
    buffer_load_dwordx4 v8, s[4:7], s37 offen offset:3072 lds
    s_add_u32 m0, s39, 24576
    s_add_u32 s37, s26, 32768
    buffer_load_dwordx4 v5, s[8:11], s37 offen offset:0 lds
    buffer_load_dwordx4 v6, s[8:11], s37 offen offset:1024 lds
    buffer_load_dwordx4 v7, s[8:11], s37 offen offset:2048 lds
    buffer_load_dwordx4 v8, s[8:11], s37 offen offset:3072 lds
    s_add_u32 s26, s26, 49152
    s_lshl_b32 s37, s47, 7
    v_xor_b32 v29, s37, v28
    s_lshl_b32 s37, s46, 14
    s_add_u32 s37, s37, 131072
    v_add_u32 v29, s37, v29
    s_nop 7
    v_mul_f32 v128, s31, v128
    v_mul_f32 v129, s31, v129
    v_mul_f32 v130, s31, v130
    v_mul_f32 v131, s31, v131
    v_mul_f32 v132, s31, v132
    v_mul_f32 v133, s31, v133
    v_mul_f32 v134, s31, v134
    v_mul_f32 v135, s31, v135
    v_cvt_pk_bf16_f32 v64, v128, v129
    v_cvt_pk_bf16_f32 v65, v130, v131
    v_cvt_pk_bf16_f32 v66, v132, v133
    v_cvt_pk_bf16_f32 v67, v134, v135
    ds_write_b128 v29, v[64:67] offset:0
    v_mul_f32 v144, s31, v144
    v_mul_f32 v145, s31, v145
    v_mul_f32 v146, s31, v146
    v_mul_f32 v147, s31, v147
    v_mul_f32 v148, s31, v148
    v_mul_f32 v149, s31, v149
    v_mul_f32 v150, s31, v150
    v_mul_f32 v151, s31, v151
    v_cvt_pk_bf16_f32 v68, v144, v145
    v_cvt_pk_bf16_f32 v69, v146, v147
    v_cvt_pk_bf16_f32 v70, v148, v149
    v_cvt_pk_bf16_f32 v71, v150, v151
    ds_write_b128 v29, v[68:71] offset:8192
    v_xor_b32 v30, 32, v29
    v_mul_f32 v136, s31, v136
    v_mul_f32 v137, s31, v137
    v_mul_f32 v138, s31, v138
    v_mul_f32 v139, s31, v139
    v_mul_f32 v140, s31, v140
    v_mul_f32 v141, s31, v141
    v_mul_f32 v142, s31, v142
    v_mul_f32 v143, s31, v143
    v_cvt_pk_bf16_f32 v72, v136, v137
    v_cvt_pk_bf16_f32 v73, v138, v139
    v_cvt_pk_bf16_f32 v74, v140, v141
    v_cvt_pk_bf16_f32 v75, v142, v143
    ds_write_b128 v30, v[72:75] offset:0
    v_mul_f32 v152, s31, v152
    v_mul_f32 v153, s31, v153
    v_mul_f32 v154, s31, v154
    v_mul_f32 v155, s31, v155
    v_mul_f32 v156, s31, v156
    v_mul_f32 v157, s31, v157
    v_mul_f32 v158, s31, v158
    v_mul_f32 v159, s31, v159
    v_cvt_pk_bf16_f32 v76, v152, v153
    v_cvt_pk_bf16_f32 v77, v154, v155
    v_cvt_pk_bf16_f32 v78, v156, v157
    v_cvt_pk_bf16_f32 v79, v158, v159
    ds_write_b128 v30, v[76:79] offset:8192
    v_xor_b32 v30, 64, v29
    v_mul_f32 v160, s31, v160
    v_mul_f32 v161, s31, v161
    v_mul_f32 v162, s31, v162
    v_mul_f32 v163, s31, v163
    v_mul_f32 v164, s31, v164
    v_mul_f32 v165, s31, v165
    v_mul_f32 v166, s31, v166
    v_mul_f32 v167, s31, v167
    v_cvt_pk_bf16_f32 v80, v160, v161
    v_cvt_pk_bf16_f32 v81, v162, v163
    v_cvt_pk_bf16_f32 v82, v164, v165
    v_cvt_pk_bf16_f32 v83, v166, v167
    ds_write_b128 v30, v[80:83] offset:0
    v_mul_f32 v176, s31, v176
    v_mul_f32 v177, s31, v177
    v_mul_f32 v178, s31, v178
    v_mul_f32 v179, s31, v179
    v_mul_f32 v180, s31, v180
    v_mul_f32 v181, s31, v181
    v_mul_f32 v182, s31, v182
    v_mul_f32 v183, s31, v183
    v_cvt_pk_bf16_f32 v84, v176, v177
    v_cvt_pk_bf16_f32 v85, v178, v179
    v_cvt_pk_bf16_f32 v86, v180, v181
    v_cvt_pk_bf16_f32 v87, v182, v183
    ds_write_b128 v30, v[84:87] offset:8192
    v_xor_b32 v30, 96, v29
    v_mul_f32 v168, s31, v168
    v_mul_f32 v169, s31, v169
    v_mul_f32 v170, s31, v170
    v_mul_f32 v171, s31, v171
    v_mul_f32 v172, s31, v172
    v_mul_f32 v173, s31, v173
    v_mul_f32 v174, s31, v174
    v_mul_f32 v175, s31, v175
    v_cvt_pk_bf16_f32 v88, v168, v169
    v_cvt_pk_bf16_f32 v89, v170, v171
    v_cvt_pk_bf16_f32 v90, v172, v173
    v_cvt_pk_bf16_f32 v91, v174, v175
    ds_write_b128 v30, v[88:91] offset:0
    v_mul_f32 v184, s31, v184
    v_mul_f32 v185, s31, v185
    v_mul_f32 v186, s31, v186
    v_mul_f32 v187, s31, v187
    v_mul_f32 v188, s31, v188
    v_mul_f32 v189, s31, v189
    v_mul_f32 v190, s31, v190
    v_mul_f32 v191, s31, v191
    v_cvt_pk_bf16_f32 v92, v184, v185
    v_cvt_pk_bf16_f32 v93, v186, v187
    v_cvt_pk_bf16_f32 v94, v188, v189
    v_cvt_pk_bf16_f32 v95, v190, v191
    ds_write_b128 v30, v[92:95] offset:8192
    s_waitcnt lgkmcnt(0)
    s_barrier
    v_add_u32 v29, s37, v28
    ds_read_b128 v[128:131], v29 offset:0
    ds_read_b128 v[160:163], v29 offset:8192
    v_xor_b32 v30, 32, v29
    ds_read_b128 v[132:135], v30 offset:0
    ds_read_b128 v[164:167], v30 offset:8192
    v_xor_b32 v30, 64, v29
    ds_read_b128 v[136:139], v30 offset:0
    ds_read_b128 v[168:171], v30 offset:8192
    v_xor_b32 v30, 96, v29
    ds_read_b128 v[140:143], v30 offset:0
    ds_read_b128 v[172:175], v30 offset:8192
    v_xor_b32 v30, 128, v29
    ds_read_b128 v[144:147], v30 offset:0
    ds_read_b128 v[176:179], v30 offset:8192
    v_xor_b32 v30, 160, v29
    ds_read_b128 v[148:151], v30 offset:0
    ds_read_b128 v[180:183], v30 offset:8192
    s_waitcnt lgkmcnt(4)
    v_xor_b32 v30, 192, v29
    ds_read_b128 v[152:155], v30 offset:0
    ds_read_b128 v[184:187], v30 offset:8192
    v_xor_b32 v30, 224, v29
    ds_read_b128 v[156:159], v30 offset:0
    ds_read_b128 v[188:191], v30 offset:8192
    s_waitcnt lgkmcnt(0)
    s_barrier
    s_lshr_b32 s45, s2, 3
    s_bfe_u32 s77, s45, 0x20002
    s_and_b32 s78, s45, 3
    s_mov_b32 s16, s56
    s_mov_b32 s17, s57
    s_lshl_b32 s30, s3, 19
    s_lshl_b32 s59, s78, 8
    s_add_u32 s30, s30, s59
    v_lshrrev_b32 v246, 4, v0
    v_and_b32 v247, 15, v0
    v_lshlrev_b32 v252, 2, v246
    v_xor_b32 v247, v247, v252
    s_lshl_b32 s37, s24, 1
    s_and_b32 s37, s37, 3
    v_xor_b32 v247, s37, v247
    v_lshlrev_b32 v247, 4, v247
    s_lshl_b32 s37, s24, 3
    v_add_u32 v246, s37, v246
    v_lshlrev_b32 v246, 10, v246
    v_add_u32 v252, v246, v247
    v_xor_b32 v247, 16, v247
    v_add_u32 v253, v246, v247
    v_add_u32 v253, 3072, v253
    v_min_u32 v246, 12, v0
    v_lshlrev_b32 v246, 21, v246
    buffer_load_dword v247, v246, s[20:23], 0 offen sc1
    v_and_b32 v246, 15, v0
    v_lshlrev_b32 v246, 16, v246
    buffer_load_dword v248, v246, s[72:75], 0 offen sc1
    v_mov_b32 v246, 0
    buffer_load_dwordx2 v[244:245], v246, s[68:71], 0 offen sc1
    s_waitcnt vmcnt(23)
    s_barrier
    ds_read_b128 v[64:67], v224 offset:0
    ds_read_b128 v[68:71], v225 offset:0
    ds_read_b128 v[72:75], v226 offset:0
    ds_read_b128 v[76:79], v227 offset:0
    ds_read_b128 v[80:83], v228 offset:0
    ds_read_b128 v[84:87], v229 offset:0
    ds_read_b128 v[88:91], v230 offset:0
    ds_read_b128 v[92:95], v231 offset:0
    s_mov_b32 s27, 0
L_tile_a:
    s_cmp_eq_u32 s27, 4
    s_cbranch_scc1 L_wo0_a
    s_cmp_eq_u32 s27, 8
    s_cbranch_scc1 L_wo2_a
L_woback0_a:
    s_waitcnt vmcnt(12) lgkmcnt(0)
    s_barrier
    v_mfma_f32_32x32x16_bf16 v[96:111], v[64:67], v[128:131], v[192:207]
    ds_read_b64_tr_b16 v[32:33], v232 offset:8192
    ds_read_b64_tr_b16 v[36:37], v232 offset:12288
    ds_read_b64_tr_b16 v[34:35], v233 offset:10240
    v_mfma_f32_32x32x16_bf16 v[96:111], v[68:71], v[132:135], v[96:111]
    ds_read_b64_tr_b16 v[38:39], v233 offset:14336
    ds_read_b64_tr_b16 v[40:41], v234 offset:8192
    v_mfma_f32_32x32x16_bf16 v[96:111], v[72:75], v[136:139], v[96:111]
    ds_read_b64_tr_b16 v[44:45], v234 offset:12288
    ds_read_b64_tr_b16 v[42:43], v235 offset:10240
    ds_read_b64_tr_b16 v[46:47], v235 offset:14336
    v_mfma_f32_32x32x16_bf16 v[96:111], v[76:79], v[140:143], v[96:111]
    s_waitcnt lgkmcnt(4)
    ds_read_b64_tr_b16 v[48:49], v236 offset:8192
    v_mfma_f32_32x32x16_bf16 v[96:111], v[80:83], v[144:147], v[96:111]
    ds_read_b64_tr_b16 v[52:53], v236 offset:12288
    ds_read_b64_tr_b16 v[50:51], v237 offset:10240
    ds_read_b64_tr_b16 v[54:55], v237 offset:14336
    v_mfma_f32_32x32x16_bf16 v[96:111], v[84:87], v[148:151], v[96:111]
    ds_read_b64_tr_b16 v[56:57], v238 offset:8192
    ds_read_b64_tr_b16 v[60:61], v238 offset:12288
    v_mfma_f32_32x32x16_bf16 v[96:111], v[88:91], v[152:155], v[96:111]
    ds_read_b64_tr_b16 v[58:59], v239 offset:10240
    ds_read_b64_tr_b16 v[62:63], v239 offset:14336
    s_add_u32 m0, s39, 49152
    v_mfma_f32_32x32x16_bf16 v[96:111], v[92:95], v[156:159], v[96:111]
    s_nop 0
    buffer_load_dwordx4 v5, s[4:7], s26 offen offset:0 lds
    v_mfma_f32_32x32x16_bf16 v[112:127], v[64:67], v[160:163], v[208:223]
    buffer_load_dwordx4 v6, s[4:7], s26 offen offset:1024 lds
    buffer_load_dwordx4 v7, s[4:7], s26 offen offset:2048 lds
    buffer_load_dwordx4 v8, s[4:7], s26 offen offset:3072 lds
    s_nop 7
    v_max3_f32 v18, v96, v97, v98
    v_mfma_f32_32x32x16_bf16 v[112:127], v[68:71], v[164:167], v[112:127]
    v_max3_f32 v19, v99, v100, v101
    v_max3_f32 v20, v102, v103, v104
    v_max3_f32 v21, v105, v106, v107
    v_max3_f32 v22, v108, v109, v110
    v_max3_f32 v18, v18, v19, v111
    v_mfma_f32_32x32x16_bf16 v[112:127], v[72:75], v[168:171], v[112:127]
    v_max3_f32 v20, v20, v21, v22
    v_max_f32 v17, v18, v20
    v_cmp_lt_f32 vcc, s41, v17
    s_cbranch_vccnz L_slow_a00
L_back_a00:
    v_exp_f32 v96, v96
    v_mfma_f32_32x32x16_bf16 v[112:127], v[76:79], v[172:175], v[112:127]
    v_exp_f32 v97, v97
    v_exp_f32 v98, v98
    v_exp_f32 v99, v99
    v_cvt_pk_bf16_f32 v96, v96, v97
    v_exp_f32 v100, v100
    v_mfma_f32_32x32x16_bf16 v[112:127], v[80:83], v[176:179], v[112:127]
    v_exp_f32 v101, v101
    v_cvt_pk_bf16_f32 v97, v98, v99
    v_exp_f32 v102, v102
    v_exp_f32 v103, v103
    v_cvt_pk_bf16_f32 v98, v100, v101
    v_mfma_f32_32x32x16_bf16 v[112:127], v[84:87], v[180:183], v[112:127]
    v_exp_f32 v104, v104
    v_exp_f32 v105, v105
    v_cvt_pk_bf16_f32 v99, v102, v103
    v_exp_f32 v106, v106
    v_exp_f32 v107, v107
    v_mfma_f32_32x32x16_bf16 v[112:127], v[88:91], v[184:187], v[112:127]
    v_cvt_pk_bf16_f32 v100, v104, v105
    v_exp_f32 v108, v108
    v_exp_f32 v109, v109
    v_cvt_pk_bf16_f32 v101, v106, v107
    v_exp_f32 v110, v110
    v_mfma_f32_32x32x16_bf16 v[112:127], v[92:95], v[188:191], v[112:127]
    v_exp_f32 v111, v111
    v_cvt_pk_bf16_f32 v102, v108, v109
    s_nop 0
    v_cvt_pk_bf16_f32 v103, v110, v111
    s_waitcnt lgkmcnt(0)
    s_nop 0
    v_mfma_f32_32x32x16_bf16 a[0:15], v[32:35], v[96:99], a[0:15]
    s_add_u32 m0, s39, 57344
    s_nop 0
    buffer_load_dwordx4 v5, s[8:11], s26 offen offset:0 lds
    buffer_load_dwordx4 v6, s[8:11], s26 offen offset:1024 lds
    buffer_load_dwordx4 v7, s[8:11], s26 offen offset:2048 lds
    v_mfma_f32_32x32x16_bf16 a[16:31], v[40:43], v[96:99], a[16:31]
    buffer_load_dwordx4 v8, s[8:11], s26 offen offset:3072 lds
    s_nop 3
    v_max3_f32 v18, v112, v113, v114
    v_max3_f32 v19, v115, v116, v117
    v_mfma_f32_32x32x16_bf16 a[32:47], v[48:51], v[96:99], a[32:47]
    v_max3_f32 v20, v118, v119, v120
    v_max3_f32 v21, v121, v122, v123
    v_max3_f32 v22, v124, v125, v126
    v_max3_f32 v18, v18, v19, v127
    v_mfma_f32_32x32x16_bf16 a[48:63], v[56:59], v[96:99], a[48:63]
    v_max3_f32 v20, v20, v21, v22
    v_max_f32 v17, v18, v20
    v_cmp_lt_f32 vcc, s41, v17
    s_cbranch_vccnz L_slow_a01
L_back_a01:
    v_mfma_f32_32x32x16_bf16 a[128:143], v[240:243], v[96:99], a[128:143]
    v_exp_f32 v112, v112
    v_exp_f32 v113, v113
    v_exp_f32 v114, v114
    v_exp_f32 v115, v115
    v_mfma_f32_32x32x16_bf16 a[0:15], v[36:39], v[100:103], a[0:15]
    v_cvt_pk_bf16_f32 v112, v112, v113
    v_exp_f32 v116, v116
    v_exp_f32 v117, v117
    v_cvt_pk_bf16_f32 v113, v114, v115
    v_exp_f32 v118, v118
    v_mfma_f32_32x32x16_bf16 a[16:31], v[44:47], v[100:103], a[16:31]
    v_exp_f32 v119, v119
    v_cvt_pk_bf16_f32 v114, v116, v117
    v_exp_f32 v120, v120
    v_exp_f32 v121, v121
    v_mfma_f32_32x32x16_bf16 a[32:47], v[52:55], v[100:103], a[32:47]
    v_cvt_pk_bf16_f32 v115, v118, v119
    v_exp_f32 v122, v122
    v_exp_f32 v123, v123
    v_cvt_pk_bf16_f32 v116, v120, v121
    v_mfma_f32_32x32x16_bf16 a[48:63], v[60:63], v[100:103], a[48:63]
    v_exp_f32 v124, v124
    v_exp_f32 v125, v125
    v_cvt_pk_bf16_f32 v117, v122, v123
    v_exp_f32 v126, v126
    v_mfma_f32_32x32x16_bf16 a[128:143], v[240:243], v[100:103], a[128:143]
    v_exp_f32 v127, v127
    v_cvt_pk_bf16_f32 v118, v124, v125
    s_nop 0
    v_cvt_pk_bf16_f32 v119, v126, v127
    s_nop 1
    v_mfma_f32_32x32x16_bf16 a[64:79], v[32:35], v[112:115], a[64:79]
    s_add_u32 s26, s26, 16384
    s_add_u32 s27, s27, 1
    v_mfma_f32_32x32x16_bf16 a[80:95], v[40:43], v[112:115], a[80:95]
    s_mov_b32 s41, s42
    v_mfma_f32_32x32x16_bf16 a[96:111], v[48:51], v[112:115], a[96:111]
    ds_read_b128 v[64:67], v224 offset:32768
    v_mfma_f32_32x32x16_bf16 a[112:127], v[56:59], v[112:115], a[112:127]
    ds_read_b128 v[68:71], v225 offset:32768
    v_mfma_f32_32x32x16_bf16 a[144:159], v[240:243], v[112:115], a[144:159]
    ds_read_b128 v[72:75], v226 offset:32768
    v_mfma_f32_32x32x16_bf16 a[64:79], v[36:39], v[116:119], a[64:79]
    ds_read_b128 v[76:79], v227 offset:32768
    v_mfma_f32_32x32x16_bf16 a[80:95], v[44:47], v[116:119], a[80:95]
    ds_read_b128 v[80:83], v228 offset:32768
    v_mfma_f32_32x32x16_bf16 a[96:111], v[52:55], v[116:119], a[96:111]
    ds_read_b128 v[84:87], v229 offset:32768
    v_mfma_f32_32x32x16_bf16 a[112:127], v[60:63], v[116:119], a[112:127]
    ds_read_b128 v[88:91], v230 offset:32768
    v_mfma_f32_32x32x16_bf16 a[144:159], v[240:243], v[116:119], a[144:159]
    ds_read_b128 v[92:95], v231 offset:32768
    s_waitcnt vmcnt(12) lgkmcnt(0)
    s_barrier
    v_mfma_f32_32x32x16_bf16 v[96:111], v[64:67], v[128:131], v[192:207]
    ds_read_b64_tr_b16 v[32:33], v232 offset:40960
    ds_read_b64_tr_b16 v[36:37], v232 offset:45056
    ds_read_b64_tr_b16 v[34:35], v233 offset:43008
    v_mfma_f32_32x32x16_bf16 v[96:111], v[68:71], v[132:135], v[96:111]
    ds_read_b64_tr_b16 v[38:39], v233 offset:47104
    ds_read_b64_tr_b16 v[40:41], v234 offset:40960
    v_mfma_f32_32x32x16_bf16 v[96:111], v[72:75], v[136:139], v[96:111]
    ds_read_b64_tr_b16 v[44:45], v234 offset:45056
    ds_read_b64_tr_b16 v[42:43], v235 offset:43008
    ds_read_b64_tr_b16 v[46:47], v235 offset:47104
    v_mfma_f32_32x32x16_bf16 v[96:111], v[76:79], v[140:143], v[96:111]
    s_waitcnt lgkmcnt(4)
    ds_read_b64_tr_b16 v[48:49], v236 offset:40960
    v_mfma_f32_32x32x16_bf16 v[96:111], v[80:83], v[144:147], v[96:111]
    ds_read_b64_tr_b16 v[52:53], v236 offset:45056
    ds_read_b64_tr_b16 v[50:51], v237 offset:43008
    ds_read_b64_tr_b16 v[54:55], v237 offset:47104
    v_mfma_f32_32x32x16_bf16 v[96:111], v[84:87], v[148:151], v[96:111]
    ds_read_b64_tr_b16 v[56:57], v238 offset:40960
    ds_read_b64_tr_b16 v[60:61], v238 offset:45056
    v_mfma_f32_32x32x16_bf16 v[96:111], v[88:91], v[152:155], v[96:111]
    ds_read_b64_tr_b16 v[58:59], v239 offset:43008
    ds_read_b64_tr_b16 v[62:63], v239 offset:47104
    s_add_u32 m0, s39, 0
    v_mfma_f32_32x32x16_bf16 v[96:111], v[92:95], v[156:159], v[96:111]
    s_nop 0
    buffer_load_dwordx4 v5, s[4:7], s26 offen offset:0 lds
    v_mfma_f32_32x32x16_bf16 v[112:127], v[64:67], v[160:163], v[208:223]
    buffer_load_dwordx4 v6, s[4:7], s26 offen offset:1024 lds
    buffer_load_dwordx4 v7, s[4:7], s26 offen offset:2048 lds
    buffer_load_dwordx4 v8, s[4:7], s26 offen offset:3072 lds
    s_nop 7
    v_max3_f32 v18, v96, v97, v98
    v_mfma_f32_32x32x16_bf16 v[112:127], v[68:71], v[164:167], v[112:127]
    v_max3_f32 v19, v99, v100, v101
    v_max3_f32 v20, v102, v103, v104
    v_max3_f32 v21, v105, v106, v107
    v_max3_f32 v22, v108, v109, v110
    v_max3_f32 v18, v18, v19, v111
    v_mfma_f32_32x32x16_bf16 v[112:127], v[72:75], v[168:171], v[112:127]
    v_max3_f32 v20, v20, v21, v22
    v_max_f32 v17, v18, v20
    v_cmp_lt_f32 vcc, s41, v17
    s_cbranch_vccnz L_slow_a10
L_back_a10:
    v_exp_f32 v96, v96
    v_mfma_f32_32x32x16_bf16 v[112:127], v[76:79], v[172:175], v[112:127]
    v_exp_f32 v97, v97
    v_exp_f32 v98, v98
    v_exp_f32 v99, v99
    v_cvt_pk_bf16_f32 v96, v96, v97
    v_exp_f32 v100, v100
    v_mfma_f32_32x32x16_bf16 v[112:127], v[80:83], v[176:179], v[112:127]
    v_exp_f32 v101, v101
    v_cvt_pk_bf16_f32 v97, v98, v99
    v_exp_f32 v102, v102
    v_exp_f32 v103, v103
    v_cvt_pk_bf16_f32 v98, v100, v101
    v_mfma_f32_32x32x16_bf16 v[112:127], v[84:87], v[180:183], v[112:127]
    v_exp_f32 v104, v104
    v_exp_f32 v105, v105
    v_cvt_pk_bf16_f32 v99, v102, v103
    v_exp_f32 v106, v106
    v_exp_f32 v107, v107
    v_mfma_f32_32x32x16_bf16 v[112:127], v[88:91], v[184:187], v[112:127]
    v_cvt_pk_bf16_f32 v100, v104, v105
    v_exp_f32 v108, v108
    v_exp_f32 v109, v109
    v_cvt_pk_bf16_f32 v101, v106, v107
    v_exp_f32 v110, v110
    v_mfma_f32_32x32x16_bf16 v[112:127], v[92:95], v[188:191], v[112:127]
    v_exp_f32 v111, v111
    v_cvt_pk_bf16_f32 v102, v108, v109
    s_nop 0
    v_cvt_pk_bf16_f32 v103, v110, v111
    s_waitcnt lgkmcnt(0)
    s_nop 0
    v_mfma_f32_32x32x16_bf16 a[0:15], v[32:35], v[96:99], a[0:15]
    s_add_u32 m0, s39, 8192
    s_nop 0
    buffer_load_dwordx4 v5, s[8:11], s26 offen offset:0 lds
    buffer_load_dwordx4 v6, s[8:11], s26 offen offset:1024 lds
    buffer_load_dwordx4 v7, s[8:11], s26 offen offset:2048 lds
    v_mfma_f32_32x32x16_bf16 a[16:31], v[40:43], v[96:99], a[16:31]
    buffer_load_dwordx4 v8, s[8:11], s26 offen offset:3072 lds
    s_nop 3
    v_max3_f32 v18, v112, v113, v114
    v_max3_f32 v19, v115, v116, v117
    v_mfma_f32_32x32x16_bf16 a[32:47], v[48:51], v[96:99], a[32:47]
    v_max3_f32 v20, v118, v119, v120
    v_max3_f32 v21, v121, v122, v123
    v_max3_f32 v22, v124, v125, v126
    v_max3_f32 v18, v18, v19, v127
    v_mfma_f32_32x32x16_bf16 a[48:63], v[56:59], v[96:99], a[48:63]
    v_max3_f32 v20, v20, v21, v22
    v_max_f32 v17, v18, v20
    v_cmp_lt_f32 vcc, s41, v17
    s_cbranch_vccnz L_slow_a11
L_back_a11:
    v_mfma_f32_32x32x16_bf16 a[128:143], v[240:243], v[96:99], a[128:143]
    v_exp_f32 v112, v112
    v_exp_f32 v113, v113
    v_exp_f32 v114, v114
    v_exp_f32 v115, v115
    v_mfma_f32_32x32x16_bf16 a[0:15], v[36:39], v[100:103], a[0:15]
    v_cvt_pk_bf16_f32 v112, v112, v113
    v_exp_f32 v116, v116
    v_exp_f32 v117, v117
    v_cvt_pk_bf16_f32 v113, v114, v115
    v_exp_f32 v118, v118
    v_mfma_f32_32x32x16_bf16 a[16:31], v[44:47], v[100:103], a[16:31]
    v_exp_f32 v119, v119
    v_cvt_pk_bf16_f32 v114, v116, v117
    v_exp_f32 v120, v120
    v_exp_f32 v121, v121
    v_mfma_f32_32x32x16_bf16 a[32:47], v[52:55], v[100:103], a[32:47]
    v_cvt_pk_bf16_f32 v115, v118, v119
    v_exp_f32 v122, v122
    v_exp_f32 v123, v123
    v_cvt_pk_bf16_f32 v116, v120, v121
    v_mfma_f32_32x32x16_bf16 a[48:63], v[60:63], v[100:103], a[48:63]
    v_exp_f32 v124, v124
    v_exp_f32 v125, v125
    v_cvt_pk_bf16_f32 v117, v122, v123
    v_exp_f32 v126, v126
    v_mfma_f32_32x32x16_bf16 a[128:143], v[240:243], v[100:103], a[128:143]
    v_exp_f32 v127, v127
    v_cvt_pk_bf16_f32 v118, v124, v125
    s_nop 0
    v_cvt_pk_bf16_f32 v119, v126, v127
    s_nop 1
    v_mfma_f32_32x32x16_bf16 a[64:79], v[32:35], v[112:115], a[64:79]
    s_add_u32 s26, s26, 16384
    s_add_u32 s27, s27, 1
    v_mfma_f32_32x32x16_bf16 a[80:95], v[40:43], v[112:115], a[80:95]
    s_mov_b32 s41, s42
    v_mfma_f32_32x32x16_bf16 a[96:111], v[48:51], v[112:115], a[96:111]
    ds_read_b128 v[64:67], v224 offset:16384
    v_mfma_f32_32x32x16_bf16 a[112:127], v[56:59], v[112:115], a[112:127]
    ds_read_b128 v[68:71], v225 offset:16384
    v_mfma_f32_32x32x16_bf16 a[144:159], v[240:243], v[112:115], a[144:159]
    ds_read_b128 v[72:75], v226 offset:16384
    v_mfma_f32_32x32x16_bf16 a[64:79], v[36:39], v[116:119], a[64:79]
    ds_read_b128 v[76:79], v227 offset:16384
    v_mfma_f32_32x32x16_bf16 a[80:95], v[44:47], v[116:119], a[80:95]
    ds_read_b128 v[80:83], v228 offset:16384
    v_mfma_f32_32x32x16_bf16 a[96:111], v[52:55], v[116:119], a[96:111]
    ds_read_b128 v[84:87], v229 offset:16384
    v_mfma_f32_32x32x16_bf16 a[112:127], v[60:63], v[116:119], a[112:127]
    ds_read_b128 v[88:91], v230 offset:16384
    v_mfma_f32_32x32x16_bf16 a[144:159], v[240:243], v[116:119], a[144:159]
    ds_read_b128 v[92:95], v231 offset:16384
    s_cmp_eq_u32 s27, 6
    s_cbranch_scc1 L_wo1_a
    s_cmp_eq_u32 s27, 10
    s_cbranch_scc1 L_wo3_a
L_woback1_a:
    s_waitcnt vmcnt(12) lgkmcnt(0)
    s_barrier
    v_mfma_f32_32x32x16_bf16 v[96:111], v[64:67], v[128:131], v[192:207]
    ds_read_b64_tr_b16 v[32:33], v232 offset:24576
    ds_read_b64_tr_b16 v[36:37], v232 offset:28672
    ds_read_b64_tr_b16 v[34:35], v233 offset:26624
    v_mfma_f32_32x32x16_bf16 v[96:111], v[68:71], v[132:135], v[96:111]
    ds_read_b64_tr_b16 v[38:39], v233 offset:30720
    ds_read_b64_tr_b16 v[40:41], v234 offset:24576
    v_mfma_f32_32x32x16_bf16 v[96:111], v[72:75], v[136:139], v[96:111]
    ds_read_b64_tr_b16 v[44:45], v234 offset:28672
    ds_read_b64_tr_b16 v[42:43], v235 offset:26624
    ds_read_b64_tr_b16 v[46:47], v235 offset:30720
    v_mfma_f32_32x32x16_bf16 v[96:111], v[76:79], v[140:143], v[96:111]
    s_waitcnt lgkmcnt(4)
    ds_read_b64_tr_b16 v[48:49], v236 offset:24576
    v_mfma_f32_32x32x16_bf16 v[96:111], v[80:83], v[144:147], v[96:111]
    ds_read_b64_tr_b16 v[52:53], v236 offset:28672
    ds_read_b64_tr_b16 v[50:51], v237 offset:26624
    ds_read_b64_tr_b16 v[54:55], v237 offset:30720
    v_mfma_f32_32x32x16_bf16 v[96:111], v[84:87], v[148:151], v[96:111]
    ds_read_b64_tr_b16 v[56:57], v238 offset:24576
    ds_read_b64_tr_b16 v[60:61], v238 offset:28672
    v_mfma_f32_32x32x16_bf16 v[96:111], v[88:91], v[152:155], v[96:111]
    ds_read_b64_tr_b16 v[58:59], v239 offset:26624
    ds_read_b64_tr_b16 v[62:63], v239 offset:30720
    s_add_u32 m0, s39, 32768
    v_mfma_f32_32x32x16_bf16 v[96:111], v[92:95], v[156:159], v[96:111]
    s_nop 0
    buffer_load_dwordx4 v5, s[4:7], s26 offen offset:0 lds
    v_mfma_f32_32x32x16_bf16 v[112:127], v[64:67], v[160:163], v[208:223]
    buffer_load_dwordx4 v6, s[4:7], s26 offen offset:1024 lds
    buffer_load_dwordx4 v7, s[4:7], s26 offen offset:2048 lds
    buffer_load_dwordx4 v8, s[4:7], s26 offen offset:3072 lds
    s_nop 7
    v_max3_f32 v18, v96, v97, v98
    v_mfma_f32_32x32x16_bf16 v[112:127], v[68:71], v[164:167], v[112:127]
    v_max3_f32 v19, v99, v100, v101
    v_max3_f32 v20, v102, v103, v104
    v_max3_f32 v21, v105, v106, v107
    v_max3_f32 v22, v108, v109, v110
    v_max3_f32 v18, v18, v19, v111
    v_mfma_f32_32x32x16_bf16 v[112:127], v[72:75], v[168:171], v[112:127]
    v_max3_f32 v20, v20, v21, v22
    v_max_f32 v17, v18, v20
    v_cmp_lt_f32 vcc, s41, v17
    s_cbranch_vccnz L_slow_a20
L_back_a20:
    v_exp_f32 v96, v96
    v_mfma_f32_32x32x16_bf16 v[112:127], v[76:79], v[172:175], v[112:127]
    v_exp_f32 v97, v97
    v_exp_f32 v98, v98
    v_exp_f32 v99, v99
    v_cvt_pk_bf16_f32 v96, v96, v97
    v_exp_f32 v100, v100
    v_mfma_f32_32x32x16_bf16 v[112:127], v[80:83], v[176:179], v[112:127]
    v_exp_f32 v101, v101
    v_cvt_pk_bf16_f32 v97, v98, v99
    v_exp_f32 v102, v102
    v_exp_f32 v103, v103
    v_cvt_pk_bf16_f32 v98, v100, v101
    v_mfma_f32_32x32x16_bf16 v[112:127], v[84:87], v[180:183], v[112:127]
    v_exp_f32 v104, v104
    v_exp_f32 v105, v105
    v_cvt_pk_bf16_f32 v99, v102, v103
    v_exp_f32 v106, v106
    v_exp_f32 v107, v107
    v_mfma_f32_32x32x16_bf16 v[112:127], v[88:91], v[184:187], v[112:127]
    v_cvt_pk_bf16_f32 v100, v104, v105
    v_exp_f32 v108, v108
    v_exp_f32 v109, v109
    v_cvt_pk_bf16_f32 v101, v106, v107
    v_exp_f32 v110, v110
    v_mfma_f32_32x32x16_bf16 v[112:127], v[92:95], v[188:191], v[112:127]
    v_exp_f32 v111, v111
    v_cvt_pk_bf16_f32 v102, v108, v109
    s_nop 0
    v_cvt_pk_bf16_f32 v103, v110, v111
    s_waitcnt lgkmcnt(0)
    s_nop 0
    v_mfma_f32_32x32x16_bf16 a[0:15], v[32:35], v[96:99], a[0:15]
    s_add_u32 m0, s39, 40960
    s_nop 0
    buffer_load_dwordx4 v5, s[8:11], s26 offen offset:0 lds
    buffer_load_dwordx4 v6, s[8:11], s26 offen offset:1024 lds
    buffer_load_dwordx4 v7, s[8:11], s26 offen offset:2048 lds
    v_mfma_f32_32x32x16_bf16 a[16:31], v[40:43], v[96:99], a[16:31]
    buffer_load_dwordx4 v8, s[8:11], s26 offen offset:3072 lds
    s_nop 3
    v_max3_f32 v18, v112, v113, v114
    v_max3_f32 v19, v115, v116, v117
    v_mfma_f32_32x32x16_bf16 a[32:47], v[48:51], v[96:99], a[32:47]
    v_max3_f32 v20, v118, v119, v120
    v_max3_f32 v21, v121, v122, v123
    v_max3_f32 v22, v124, v125, v126
    v_max3_f32 v18, v18, v19, v127
    v_mfma_f32_32x32x16_bf16 a[48:63], v[56:59], v[96:99], a[48:63]
    v_max3_f32 v20, v20, v21, v22
    v_max_f32 v17, v18, v20
    v_cmp_lt_f32 vcc, s41, v17
    s_cbranch_vccnz L_slow_a21
L_back_a21:
    v_mfma_f32_32x32x16_bf16 a[128:143], v[240:243], v[96:99], a[128:143]
    v_exp_f32 v112, v112
    v_exp_f32 v113, v113
    v_exp_f32 v114, v114
    v_exp_f32 v115, v115
    v_mfma_f32_32x32x16_bf16 a[0:15], v[36:39], v[100:103], a[0:15]
    v_cvt_pk_bf16_f32 v112, v112, v113
    v_exp_f32 v116, v116
    v_exp_f32 v117, v117
    v_cvt_pk_bf16_f32 v113, v114, v115
    v_exp_f32 v118, v118
    v_mfma_f32_32x32x16_bf16 a[16:31], v[44:47], v[100:103], a[16:31]
    v_exp_f32 v119, v119
    v_cvt_pk_bf16_f32 v114, v116, v117
    v_exp_f32 v120, v120
    v_exp_f32 v121, v121
    v_mfma_f32_32x32x16_bf16 a[32:47], v[52:55], v[100:103], a[32:47]
    v_cvt_pk_bf16_f32 v115, v118, v119
    v_exp_f32 v122, v122
    v_exp_f32 v123, v123
    v_cvt_pk_bf16_f32 v116, v120, v121
    v_mfma_f32_32x32x16_bf16 a[48:63], v[60:63], v[100:103], a[48:63]
    v_exp_f32 v124, v124
    v_exp_f32 v125, v125
    v_cvt_pk_bf16_f32 v117, v122, v123
    v_exp_f32 v126, v126
    v_mfma_f32_32x32x16_bf16 a[128:143], v[240:243], v[100:103], a[128:143]
    v_exp_f32 v127, v127
    v_cvt_pk_bf16_f32 v118, v124, v125
    s_nop 0
    v_cvt_pk_bf16_f32 v119, v126, v127
    s_nop 1
    v_mfma_f32_32x32x16_bf16 a[64:79], v[32:35], v[112:115], a[64:79]
    s_add_u32 s26, s26, 16384
    s_add_u32 s27, s27, 1
    v_mfma_f32_32x32x16_bf16 a[80:95], v[40:43], v[112:115], a[80:95]
    s_mov_b32 s41, s42
    v_mfma_f32_32x32x16_bf16 a[96:111], v[48:51], v[112:115], a[96:111]
    ds_read_b128 v[64:67], v224 offset:49152
    v_mfma_f32_32x32x16_bf16 a[112:127], v[56:59], v[112:115], a[112:127]
    ds_read_b128 v[68:71], v225 offset:49152
    v_mfma_f32_32x32x16_bf16 a[144:159], v[240:243], v[112:115], a[144:159]
    ds_read_b128 v[72:75], v226 offset:49152
    v_mfma_f32_32x32x16_bf16 a[64:79], v[36:39], v[116:119], a[64:79]
    ds_read_b128 v[76:79], v227 offset:49152
    v_mfma_f32_32x32x16_bf16 a[80:95], v[44:47], v[116:119], a[80:95]
    ds_read_b128 v[80:83], v228 offset:49152
    v_mfma_f32_32x32x16_bf16 a[96:111], v[52:55], v[116:119], a[96:111]
    ds_read_b128 v[84:87], v229 offset:49152
    v_mfma_f32_32x32x16_bf16 a[112:127], v[60:63], v[116:119], a[112:127]
    ds_read_b128 v[88:91], v230 offset:49152
    v_mfma_f32_32x32x16_bf16 a[144:159], v[240:243], v[116:119], a[144:159]
    ds_read_b128 v[92:95], v231 offset:49152
    s_waitcnt vmcnt(12) lgkmcnt(0)
    s_barrier
    v_mfma_f32_32x32x16_bf16 v[96:111], v[64:67], v[128:131], v[192:207]
    ds_read_b64_tr_b16 v[32:33], v232 offset:57344
    ds_read_b64_tr_b16 v[36:37], v232 offset:61440
    ds_read_b64_tr_b16 v[34:35], v233 offset:59392
    v_mfma_f32_32x32x16_bf16 v[96:111], v[68:71], v[132:135], v[96:111]
    ds_read_b64_tr_b16 v[38:39], v233 offset:63488
    ds_read_b64_tr_b16 v[40:41], v234 offset:57344
    v_mfma_f32_32x32x16_bf16 v[96:111], v[72:75], v[136:139], v[96:111]
    ds_read_b64_tr_b16 v[44:45], v234 offset:61440
    ds_read_b64_tr_b16 v[42:43], v235 offset:59392
    ds_read_b64_tr_b16 v[46:47], v235 offset:63488
    v_mfma_f32_32x32x16_bf16 v[96:111], v[76:79], v[140:143], v[96:111]
    s_waitcnt lgkmcnt(4)
    ds_read_b64_tr_b16 v[48:49], v236 offset:57344
    v_mfma_f32_32x32x16_bf16 v[96:111], v[80:83], v[144:147], v[96:111]
    ds_read_b64_tr_b16 v[52:53], v236 offset:61440
    ds_read_b64_tr_b16 v[50:51], v237 offset:59392
    ds_read_b64_tr_b16 v[54:55], v237 offset:63488
    v_mfma_f32_32x32x16_bf16 v[96:111], v[84:87], v[148:151], v[96:111]
    ds_read_b64_tr_b16 v[56:57], v238 offset:57344
    ds_read_b64_tr_b16 v[60:61], v238 offset:61440
    v_mfma_f32_32x32x16_bf16 v[96:111], v[88:91], v[152:155], v[96:111]
    ds_read_b64_tr_b16 v[58:59], v239 offset:59392
    ds_read_b64_tr_b16 v[62:63], v239 offset:63488
    s_add_u32 m0, s39, 16384
    v_mfma_f32_32x32x16_bf16 v[96:111], v[92:95], v[156:159], v[96:111]
    s_nop 0
    buffer_load_dwordx4 v5, s[4:7], s26 offen offset:0 lds
    v_mfma_f32_32x32x16_bf16 v[112:127], v[64:67], v[160:163], v[208:223]
    buffer_load_dwordx4 v6, s[4:7], s26 offen offset:1024 lds
    buffer_load_dwordx4 v7, s[4:7], s26 offen offset:2048 lds
    buffer_load_dwordx4 v8, s[4:7], s26 offen offset:3072 lds
    s_nop 7
    v_max3_f32 v18, v96, v97, v98
    v_mfma_f32_32x32x16_bf16 v[112:127], v[68:71], v[164:167], v[112:127]
    v_max3_f32 v19, v99, v100, v101
    v_max3_f32 v20, v102, v103, v104
    v_max3_f32 v21, v105, v106, v107
    v_max3_f32 v22, v108, v109, v110
    v_max3_f32 v18, v18, v19, v111
    v_mfma_f32_32x32x16_bf16 v[112:127], v[72:75], v[168:171], v[112:127]
    v_max3_f32 v20, v20, v21, v22
    v_max_f32 v17, v18, v20
    v_cmp_lt_f32 vcc, s41, v17
    s_cbranch_vccnz L_slow_a30
L_back_a30:
    v_exp_f32 v96, v96
    v_mfma_f32_32x32x16_bf16 v[112:127], v[76:79], v[172:175], v[112:127]
    v_exp_f32 v97, v97
    v_exp_f32 v98, v98
    v_exp_f32 v99, v99
    v_cvt_pk_bf16_f32 v96, v96, v97
    v_exp_f32 v100, v100
    v_mfma_f32_32x32x16_bf16 v[112:127], v[80:83], v[176:179], v[112:127]
    v_exp_f32 v101, v101
    v_cvt_pk_bf16_f32 v97, v98, v99
    v_exp_f32 v102, v102
    v_exp_f32 v103, v103
    v_cvt_pk_bf16_f32 v98, v100, v101
    v_mfma_f32_32x32x16_bf16 v[112:127], v[84:87], v[180:183], v[112:127]
    v_exp_f32 v104, v104
    v_exp_f32 v105, v105
    v_cvt_pk_bf16_f32 v99, v102, v103
    v_exp_f32 v106, v106
    v_exp_f32 v107, v107
    v_mfma_f32_32x32x16_bf16 v[112:127], v[88:91], v[184:187], v[112:127]
    v_cvt_pk_bf16_f32 v100, v104, v105
    v_exp_f32 v108, v108
    v_exp_f32 v109, v109
    v_cvt_pk_bf16_f32 v101, v106, v107
    v_exp_f32 v110, v110
    v_mfma_f32_32x32x16_bf16 v[112:127], v[92:95], v[188:191], v[112:127]
    v_exp_f32 v111, v111
    v_cvt_pk_bf16_f32 v102, v108, v109
    s_nop 0
    v_cvt_pk_bf16_f32 v103, v110, v111
    s_waitcnt lgkmcnt(0)
    s_nop 0
    v_mfma_f32_32x32x16_bf16 a[0:15], v[32:35], v[96:99], a[0:15]
    s_add_u32 m0, s39, 24576
    s_nop 0
    buffer_load_dwordx4 v5, s[8:11], s26 offen offset:0 lds
    buffer_load_dwordx4 v6, s[8:11], s26 offen offset:1024 lds
    buffer_load_dwordx4 v7, s[8:11], s26 offen offset:2048 lds
    v_mfma_f32_32x32x16_bf16 a[16:31], v[40:43], v[96:99], a[16:31]
    buffer_load_dwordx4 v8, s[8:11], s26 offen offset:3072 lds
    s_nop 3
    v_max3_f32 v18, v112, v113, v114
    v_max3_f32 v19, v115, v116, v117
    v_mfma_f32_32x32x16_bf16 a[32:47], v[48:51], v[96:99], a[32:47]
    v_max3_f32 v20, v118, v119, v120
    v_max3_f32 v21, v121, v122, v123
    v_max3_f32 v22, v124, v125, v126
    v_max3_f32 v18, v18, v19, v127
    v_mfma_f32_32x32x16_bf16 a[48:63], v[56:59], v[96:99], a[48:63]
    v_max3_f32 v20, v20, v21, v22
    v_max_f32 v17, v18, v20
    v_cmp_lt_f32 vcc, s41, v17
    s_cbranch_vccnz L_slow_a31
L_back_a31:
    v_mfma_f32_32x32x16_bf16 a[128:143], v[240:243], v[96:99], a[128:143]
    v_exp_f32 v112, v112
    v_exp_f32 v113, v113
    v_exp_f32 v114, v114
    v_exp_f32 v115, v115
    v_mfma_f32_32x32x16_bf16 a[0:15], v[36:39], v[100:103], a[0:15]
    v_cvt_pk_bf16_f32 v112, v112, v113
    v_exp_f32 v116, v116
    v_exp_f32 v117, v117
    v_cvt_pk_bf16_f32 v113, v114, v115
    v_exp_f32 v118, v118
    v_mfma_f32_32x32x16_bf16 a[16:31], v[44:47], v[100:103], a[16:31]
    v_exp_f32 v119, v119
    v_cvt_pk_bf16_f32 v114, v116, v117
    v_exp_f32 v120, v120
    v_exp_f32 v121, v121
    v_mfma_f32_32x32x16_bf16 a[32:47], v[52:55], v[100:103], a[32:47]
    v_cvt_pk_bf16_f32 v115, v118, v119
    v_exp_f32 v122, v122
    v_exp_f32 v123, v123
    v_cvt_pk_bf16_f32 v116, v120, v121
    v_mfma_f32_32x32x16_bf16 a[48:63], v[60:63], v[100:103], a[48:63]
    v_exp_f32 v124, v124
    v_exp_f32 v125, v125
    v_cvt_pk_bf16_f32 v117, v122, v123
    v_exp_f32 v126, v126
    v_mfma_f32_32x32x16_bf16 a[128:143], v[240:243], v[100:103], a[128:143]
    v_exp_f32 v127, v127
    v_cvt_pk_bf16_f32 v118, v124, v125
    s_nop 0
    v_cvt_pk_bf16_f32 v119, v126, v127
    s_nop 1
    v_mfma_f32_32x32x16_bf16 a[64:79], v[32:35], v[112:115], a[64:79]
    s_add_u32 s26, s26, 16384
    s_add_u32 s27, s27, 1
    v_mfma_f32_32x32x16_bf16 a[80:95], v[40:43], v[112:115], a[80:95]
    s_mov_b32 s41, s42
    v_mfma_f32_32x32x16_bf16 a[96:111], v[48:51], v[112:115], a[96:111]
    ds_read_b128 v[64:67], v224 offset:0
    v_mfma_f32_32x32x16_bf16 a[112:127], v[56:59], v[112:115], a[112:127]
    ds_read_b128 v[68:71], v225 offset:0
    v_mfma_f32_32x32x16_bf16 a[144:159], v[240:243], v[112:115], a[144:159]
    ds_read_b128 v[72:75], v226 offset:0
    v_mfma_f32_32x32x16_bf16 a[64:79], v[36:39], v[116:119], a[64:79]
    ds_read_b128 v[76:79], v227 offset:0
    v_mfma_f32_32x32x16_bf16 a[80:95], v[44:47], v[116:119], a[80:95]
    ds_read_b128 v[80:83], v228 offset:0
    v_mfma_f32_32x32x16_bf16 a[96:111], v[52:55], v[116:119], a[96:111]
    ds_read_b128 v[84:87], v229 offset:0
    v_mfma_f32_32x32x16_bf16 a[112:127], v[60:63], v[116:119], a[112:127]
    ds_read_b128 v[88:91], v230 offset:0
    v_mfma_f32_32x32x16_bf16 a[144:159], v[240:243], v[116:119], a[144:159]
    ds_read_b128 v[92:95], v231 offset:0
    s_cmp_lt_u32 s27, 16
    s_cbranch_scc1 L_tile_a
    s_waitcnt vmcnt(0) lgkmcnt(0)
    s_barrier
    s_nop 7
    s_nop 7
    v_accvgpr_read_b32 v21, a128
    v_sub_f32 v20, 0, v192
    v_accvgpr_read_b32 v23, a144
    v_sub_f32 v22, 0, v208
    s_add_u32 s37, s28, 16384
    v_lshlrev_b32 v40, 3, v0
    v_add_u32 v41, s37, v40
    v_add_u32 v42, s28, v27
    v_xor_b32 v43, 32768, v42
    s_waitcnt vmcnt(0)
    ds_write_b64 v41, v[20:21]
    ds_write_b64 v41, v[22:23] offset:512
    v_xor_b32 v41, 32768, v41
    s_cmp_eq_u32 s47, 1
    s_cbranch_scc1 L_cmb1_a
    ds_write_b128 v42, a[32:35] offset:0
    ds_write_b128 v42, a[36:39] offset:1024
    ds_write_b128 v42, a[40:43] offset:2048
    ds_write_b128 v42, a[44:47] offset:3072
    ds_write_b128 v42, a[48:51] offset:4096
    ds_write_b128 v42, a[52:55] offset:5120
    ds_write_b128 v42, a[56:59] offset:6144
    ds_write_b128 v42, a[60:63] offset:7168
    ds_write_b128 v42, a[96:99] offset:8192
    ds_write_b128 v42, a[100:103] offset:9216
    ds_write_b128 v42, a[104:107] offset:10240
    ds_write_b128 v42, a[108:111] offset:11264
    ds_write_b128 v42, a[112:115] offset:12288
    ds_write_b128 v42, a[116:119] offset:13312
    ds_write_b128 v42, a[120:123] offset:14336
    ds_write_b128 v42, a[124:127] offset:15360
    v_accvgpr_read_b32 v128, a0
    v_accvgpr_read_b32 v129, a1
    v_accvgpr_read_b32 v130, a2
    v_accvgpr_read_b32 v131, a3
    v_accvgpr_read_b32 v132, a4
    v_accvgpr_read_b32 v133, a5
    v_accvgpr_read_b32 v134, a6
    v_accvgpr_read_b32 v135, a7
    v_accvgpr_read_b32 v136, a8
    v_accvgpr_read_b32 v137, a9
    v_accvgpr_read_b32 v138, a10
    v_accvgpr_read_b32 v139, a11
    v_accvgpr_read_b32 v140, a12
    v_accvgpr_read_b32 v141, a13
    v_accvgpr_read_b32 v142, a14
    v_accvgpr_read_b32 v143, a15
    v_accvgpr_read_b32 v144, a16
    v_accvgpr_read_b32 v145, a17
    v_accvgpr_read_b32 v146, a18
    v_accvgpr_read_b32 v147, a19
    v_accvgpr_read_b32 v148, a20
    v_accvgpr_read_b32 v149, a21
    v_accvgpr_read_b32 v150, a22
    v_accvgpr_read_b32 v151, a23
    v_accvgpr_read_b32 v152, a24
    v_accvgpr_read_b32 v153, a25
    v_accvgpr_read_b32 v154, a26
    v_accvgpr_read_b32 v155, a27
    v_accvgpr_read_b32 v156, a28
    v_accvgpr_read_b32 v157, a29
    v_accvgpr_read_b32 v158, a30
    v_accvgpr_read_b32 v159, a31
    v_accvgpr_read_b32 v160, a64
    v_accvgpr_read_b32 v161, a65
    v_accvgpr_read_b32 v162, a66
    v_accvgpr_read_b32 v163, a67
    v_accvgpr_read_b32 v164, a68
    v_accvgpr_read_b32 v165, a69
    v_accvgpr_read_b32 v166, a70
    v_accvgpr_read_b32 v167, a71
    v_accvgpr_read_b32 v168, a72
    v_accvgpr_read_b32 v169, a73
    v_accvgpr_read_b32 v170, a74
    v_accvgpr_read_b32 v171, a75
    v_accvgpr_read_b32 v172, a76
    v_accvgpr_read_b32 v173, a77
    v_accvgpr_read_b32 v174, a78
    v_accvgpr_read_b32 v175, a79
    v_accvgpr_read_b32 v176, a80
    v_accvgpr_read_b32 v177, a81
    v_accvgpr_read_b32 v178, a82
    v_accvgpr_read_b32 v179, a83
    v_accvgpr_read_b32 v180, a84
    v_accvgpr_read_b32 v181, a85
    v_accvgpr_read_b32 v182, a86
    v_accvgpr_read_b32 v183, a87
    v_accvgpr_read_b32 v184, a88
    v_accvgpr_read_b32 v185, a89
    v_accvgpr_read_b32 v186, a90
    v_accvgpr_read_b32 v187, a91
    v_accvgpr_read_b32 v188, a92
    v_accvgpr_read_b32 v189, a93
    v_accvgpr_read_b32 v190, a94
    v_accvgpr_read_b32 v191, a95
    s_branch L_cmb2_a
L_cmb1_a:
    ds_write_b128 v42, a[0:3] offset:0
    ds_write_b128 v42, a[4:7] offset:1024
    ds_write_b128 v42, a[8:11] offset:2048
    ds_write_b128 v42, a[12:15] offset:3072
    ds_write_b128 v42, a[16:19] offset:4096
    ds_write_b128 v42, a[20:23] offset:5120
    ds_write_b128 v42, a[24:27] offset:6144
    ds_write_b128 v42, a[28:31] offset:7168
    ds_write_b128 v42, a[64:67] offset:8192
    ds_write_b128 v42, a[68:71] offset:9216
    ds_write_b128 v42, a[72:75] offset:10240
    ds_write_b128 v42, a[76:79] offset:11264
    ds_write_b128 v42, a[80:83] offset:12288
    ds_write_b128 v42, a[84:87] offset:13312
    ds_write_b128 v42, a[88:91] offset:14336
    ds_write_b128 v42, a[92:95] offset:15360
    v_accvgpr_read_b32 v128, a32
    v_accvgpr_read_b32 v129, a33
    v_accvgpr_read_b32 v130, a34
    v_accvgpr_read_b32 v131, a35
    v_accvgpr_read_b32 v132, a36
    v_accvgpr_read_b32 v133, a37
    v_accvgpr_read_b32 v134, a38
    v_accvgpr_read_b32 v135, a39
    v_accvgpr_read_b32 v136, a40
    v_accvgpr_read_b32 v137, a41
    v_accvgpr_read_b32 v138, a42
    v_accvgpr_read_b32 v139, a43
    v_accvgpr_read_b32 v140, a44
    v_accvgpr_read_b32 v141, a45
    v_accvgpr_read_b32 v142, a46
    v_accvgpr_read_b32 v143, a47
    v_accvgpr_read_b32 v144, a48
    v_accvgpr_read_b32 v145, a49
    v_accvgpr_read_b32 v146, a50
    v_accvgpr_read_b32 v147, a51
    v_accvgpr_read_b32 v148, a52
    v_accvgpr_read_b32 v149, a53
    v_accvgpr_read_b32 v150, a54
    v_accvgpr_read_b32 v151, a55
    v_accvgpr_read_b32 v152, a56
    v_accvgpr_read_b32 v153, a57
    v_accvgpr_read_b32 v154, a58
    v_accvgpr_read_b32 v155, a59
    v_accvgpr_read_b32 v156, a60
    v_accvgpr_read_b32 v157, a61
    v_accvgpr_read_b32 v158, a62
    v_accvgpr_read_b32 v159, a63
    v_accvgpr_read_b32 v160, a96
    v_accvgpr_read_b32 v161, a97
    v_accvgpr_read_b32 v162, a98
    v_accvgpr_read_b32 v163, a99
    v_accvgpr_read_b32 v164, a100
    v_accvgpr_read_b32 v165, a101
    v_accvgpr_read_b32 v166, a102
    v_accvgpr_read_b32 v167, a103
    v_accvgpr_read_b32 v168, a104
    v_accvgpr_read_b32 v169, a105
    v_accvgpr_read_b32 v170, a106
    v_accvgpr_read_b32 v171, a107
    v_accvgpr_read_b32 v172, a108
    v_accvgpr_read_b32 v173, a109
    v_accvgpr_read_b32 v174, a110
    v_accvgpr_read_b32 v175, a111
    v_accvgpr_read_b32 v176, a112
    v_accvgpr_read_b32 v177, a113
    v_accvgpr_read_b32 v178, a114
    v_accvgpr_read_b32 v179, a115
    v_accvgpr_read_b32 v180, a116
    v_accvgpr_read_b32 v181, a117
    v_accvgpr_read_b32 v182, a118
    v_accvgpr_read_b32 v183, a119
    v_accvgpr_read_b32 v184, a120
    v_accvgpr_read_b32 v185, a121
    v_accvgpr_read_b32 v186, a122
    v_accvgpr_read_b32 v187, a123
    v_accvgpr_read_b32 v188, a124
    v_accvgpr_read_b32 v189, a125
    v_accvgpr_read_b32 v190, a126
    v_accvgpr_read_b32 v191, a127
L_cmb2_a:
    s_waitcnt lgkmcnt(0)
    s_barrier
    ds_read_b64 v[36:37], v41
    ds_read_b64 v[38:39], v41 offset:512
    ds_read_b128 v[64:67], v43 offset:0
    ds_read_b128 v[68:71], v43 offset:1024
    ds_read_b128 v[72:75], v43 offset:2048
    ds_read_b128 v[76:79], v43 offset:3072
    ds_read_b128 v[80:83], v43 offset:4096
    ds_read_b128 v[84:87], v43 offset:5120
    ds_read_b128 v[88:91], v43 offset:6144
    ds_read_b128 v[92:95], v43 offset:7168
    ds_read_b128 v[96:99], v43 offset:8192
    ds_read_b128 v[100:103], v43 offset:9216
    ds_read_b128 v[104:107], v43 offset:10240
    ds_read_b128 v[108:111], v43 offset:11264
    s_waitcnt lgkmcnt(12)
    v_max_f32 v18, v20, v36
    v_sub_f32 v32, v20, v18
    v_sub_f32 v33, v36, v18
    v_exp_f32 v32, v32
    v_exp_f32 v33, v33
    s_nop 0
    v_mul_f32 v19, v32, v21
    v_fmac_f32 v19, v33, v37
    v_rcp_f32 v19, v19
    s_nop 0
    v_mul_f32 v48, v32, v19
    v_mul_f32 v49, v32, v19
    v_mul_f32 v50, v33, v19
    v_mul_f32 v51, v33, v19
    v_mul_f32 v32, v32, v19
    v_mul_f32 v33, v33, v19
    v_max_f32 v18, v22, v38
    v_sub_f32 v34, v22, v18
    v_sub_f32 v35, v38, v18
    v_exp_f32 v34, v34
    v_exp_f32 v35, v35
    s_nop 0
    v_mul_f32 v19, v34, v23
    v_fmac_f32 v19, v35, v39
    v_rcp_f32 v19, v19
    s_nop 0
    v_mul_f32 v52, v34, v19
    v_mul_f32 v53, v34, v19
    v_mul_f32 v54, v35, v19
    v_mul_f32 v55, v35, v19
    v_mul_f32 v34, v34, v19
    v_mul_f32 v35, v35, v19
    ds_read_b128 v[112:115], v43 offset:12288
    ds_read_b128 v[116:119], v43 offset:13312
    ds_read_b128 v[120:123], v43 offset:14336
    ds_read_b128 v[124:127], v43 offset:15360
    s_add_u32 s37, s44, 4096
    v_pk_mul_f32 v[128:129], v[48:49], v[128:129]
    v_pk_mul_f32 v[130:131], v[48:49], v[130:131]
    v_pk_mul_f32 v[132:133], v[48:49], v[132:133]
    v_pk_mul_f32 v[134:135], v[48:49], v[134:135]
    v_pk_mul_f32 v[136:137], v[48:49], v[136:137]
    v_pk_mul_f32 v[138:139], v[48:49], v[138:139]
    v_pk_mul_f32 v[140:141], v[48:49], v[140:141]
    v_pk_mul_f32 v[142:143], v[48:49], v[142:143]
    s_waitcnt lgkmcnt(12)
    v_pk_fma_f32 v[128:129], v[50:51], v[64:65], v[128:129]
    v_pk_fma_f32 v[130:131], v[50:51], v[66:67], v[130:131]
    v_pk_fma_f32 v[132:133], v[50:51], v[68:69], v[132:133]
    v_pk_fma_f32 v[134:135], v[50:51], v[70:71], v[134:135]
    v_pk_fma_f32 v[136:137], v[50:51], v[72:73], v[136:137]
    v_pk_fma_f32 v[138:139], v[50:51], v[74:75], v[138:139]
    v_pk_fma_f32 v[140:141], v[50:51], v[76:77], v[140:141]
    v_pk_fma_f32 v[142:143], v[50:51], v[78:79], v[142:143]
    v_cvt_pk_bf16_f32 v192, v128, v129
    v_cvt_pk_bf16_f32 v193, v130, v131
    v_cvt_pk_bf16_f32 v194, v132, v133
    v_cvt_pk_bf16_f32 v195, v134, v135
    buffer_store_dwordx4 v[192:195], v27, s[20:23], s44 offen offset:0 sc1
    v_cvt_pk_bf16_f32 v196, v136, v137
    v_cvt_pk_bf16_f32 v197, v138, v139
    v_cvt_pk_bf16_f32 v198, v140, v141
    v_cvt_pk_bf16_f32 v199, v142, v143
    buffer_store_dwordx4 v[196:199], v27, s[20:23], s44 offen offset:1024 sc1
    v_pk_mul_f32 v[144:145], v[48:49], v[144:145]
    v_pk_mul_f32 v[146:147], v[48:49], v[146:147]
    v_pk_mul_f32 v[148:149], v[48:49], v[148:149]
    v_pk_mul_f32 v[150:151], v[48:49], v[150:151]
    v_pk_mul_f32 v[152:153], v[48:49], v[152:153]
    v_pk_mul_f32 v[154:155], v[48:49], v[154:155]
    v_pk_mul_f32 v[156:157], v[48:49], v[156:157]
    v_pk_mul_f32 v[158:159], v[48:49], v[158:159]
    s_waitcnt lgkmcnt(8)
    v_pk_fma_f32 v[144:145], v[50:51], v[80:81], v[144:145]
    v_pk_fma_f32 v[146:147], v[50:51], v[82:83], v[146:147]
    v_pk_fma_f32 v[148:149], v[50:51], v[84:85], v[148:149]
    v_pk_fma_f32 v[150:151], v[50:51], v[86:87], v[150:151]
    v_pk_fma_f32 v[152:153], v[50:51], v[88:89], v[152:153]
    v_pk_fma_f32 v[154:155], v[50:51], v[90:91], v[154:155]
    v_pk_fma_f32 v[156:157], v[50:51], v[92:93], v[156:157]
    v_pk_fma_f32 v[158:159], v[50:51], v[94:95], v[158:159]
    v_cvt_pk_bf16_f32 v200, v144, v145
    v_cvt_pk_bf16_f32 v201, v146, v147
    v_cvt_pk_bf16_f32 v202, v148, v149
    v_cvt_pk_bf16_f32 v203, v150, v151
    buffer_store_dwordx4 v[200:203], v27, s[20:23], s44 offen offset:2048 sc1
    v_cvt_pk_bf16_f32 v204, v152, v153
    v_cvt_pk_bf16_f32 v205, v154, v155
    v_cvt_pk_bf16_f32 v206, v156, v157
    v_cvt_pk_bf16_f32 v207, v158, v159
    buffer_store_dwordx4 v[204:207], v27, s[20:23], s44 offen offset:3072 sc1
    v_pk_mul_f32 v[160:161], v[52:53], v[160:161]
    v_pk_mul_f32 v[162:163], v[52:53], v[162:163]
    v_pk_mul_f32 v[164:165], v[52:53], v[164:165]
    v_pk_mul_f32 v[166:167], v[52:53], v[166:167]
    v_pk_mul_f32 v[168:169], v[52:53], v[168:169]
    v_pk_mul_f32 v[170:171], v[52:53], v[170:171]
    v_pk_mul_f32 v[172:173], v[52:53], v[172:173]
    v_pk_mul_f32 v[174:175], v[52:53], v[174:175]
    s_waitcnt lgkmcnt(4)
    v_pk_fma_f32 v[160:161], v[54:55], v[96:97], v[160:161]
    v_pk_fma_f32 v[162:163], v[54:55], v[98:99], v[162:163]
    v_pk_fma_f32 v[164:165], v[54:55], v[100:101], v[164:165]
    v_pk_fma_f32 v[166:167], v[54:55], v[102:103], v[166:167]
    v_pk_fma_f32 v[168:169], v[54:55], v[104:105], v[168:169]
    v_pk_fma_f32 v[170:171], v[54:55], v[106:107], v[170:171]
    v_pk_fma_f32 v[172:173], v[54:55], v[108:109], v[172:173]
    v_pk_fma_f32 v[174:175], v[54:55], v[110:111], v[174:175]
    v_cvt_pk_bf16_f32 v208, v160, v161
    v_cvt_pk_bf16_f32 v209, v162, v163
    v_cvt_pk_bf16_f32 v210, v164, v165
    v_cvt_pk_bf16_f32 v211, v166, v167
    buffer_store_dwordx4 v[208:211], v27, s[20:23], s37 offen offset:0 sc1
    v_cvt_pk_bf16_f32 v212, v168, v169
    v_cvt_pk_bf16_f32 v213, v170, v171
    v_cvt_pk_bf16_f32 v214, v172, v173
    v_cvt_pk_bf16_f32 v215, v174, v175
    buffer_store_dwordx4 v[212:215], v27, s[20:23], s37 offen offset:1024 sc1
    v_pk_mul_f32 v[176:177], v[52:53], v[176:177]
    v_pk_mul_f32 v[178:179], v[52:53], v[178:179]
    v_pk_mul_f32 v[180:181], v[52:53], v[180:181]
    v_pk_mul_f32 v[182:183], v[52:53], v[182:183]
    v_pk_mul_f32 v[184:185], v[52:53], v[184:185]
    v_pk_mul_f32 v[186:187], v[52:53], v[186:187]
    v_pk_mul_f32 v[188:189], v[52:53], v[188:189]
    v_pk_mul_f32 v[190:191], v[52:53], v[190:191]
    s_waitcnt lgkmcnt(0)
    v_pk_fma_f32 v[176:177], v[54:55], v[112:113], v[176:177]
    v_pk_fma_f32 v[178:179], v[54:55], v[114:115], v[178:179]
    v_pk_fma_f32 v[180:181], v[54:55], v[116:117], v[180:181]
    v_pk_fma_f32 v[182:183], v[54:55], v[118:119], v[182:183]
    v_pk_fma_f32 v[184:185], v[54:55], v[120:121], v[184:185]
    v_pk_fma_f32 v[186:187], v[54:55], v[122:123], v[186:187]
    v_pk_fma_f32 v[188:189], v[54:55], v[124:125], v[188:189]
    v_pk_fma_f32 v[190:191], v[54:55], v[126:127], v[190:191]
    v_cvt_pk_bf16_f32 v216, v176, v177
    v_cvt_pk_bf16_f32 v217, v178, v179
    v_cvt_pk_bf16_f32 v218, v180, v181
    v_cvt_pk_bf16_f32 v219, v182, v183
    buffer_store_dwordx4 v[216:219], v27, s[20:23], s37 offen offset:2048 sc1
    v_cvt_pk_bf16_f32 v220, v184, v185
    v_cvt_pk_bf16_f32 v221, v186, v187
    v_cvt_pk_bf16_f32 v222, v188, v189
    v_cvt_pk_bf16_f32 v223, v190, v191
    buffer_store_dwordx4 v[220:223], v27, s[20:23], s37 offen offset:3072 sc1
    v_lshlrev_b32 v1, 4, v0
    v_add_u32 v2, s80, v1
    v_add_u32 v3, 65536, v2
    v_bfe_u32 v8, v0, 4, 1
    v_and_b32 v9, 1, v0
    v_lshl_add_u32 v8, v8, 1, v9
    v_lshrrev_b32 v9, 5, v0
    v_lshlrev_b32 v10, 1, v9
    v_xor_b32 v8, v8, v10
    v_bfe_u32 v10, v0, 2, 2
    v_lshl_add_u32 v8, v10, 2, v8
    v_lshlrev_b32 v8, 4, v8
    v_lshl_add_u32 v9, v9, 3, v10
    v_lshl_add_u32 v8, v9, 8, v8
    v_bfe_u32 v9, v0, 1, 1
    v_lshl_add_u32 v160, v9, 3, v8
    v_xor_b32 v161, 16, v160
    v_xor_b32 v162, 64, v160
    v_xor_b32 v163, 80, v160
    v_xor_b32 v164, 128, v160
    v_xor_b32 v165, 144, v160
    v_xor_b32 v166, 192, v160
    v_xor_b32 v167, 208, v160
    v_add_u32 v168, 65536, v160
    v_add_u32 v176, 131072, v160
    v_add_u32 v169, 65536, v161
    v_add_u32 v177, 131072, v161
    v_add_u32 v170, 65536, v162
    v_add_u32 v178, 131072, v162
    v_add_u32 v171, 65536, v163
    v_add_u32 v179, 131072, v163
    v_add_u32 v172, 65536, v164
    v_add_u32 v180, 131072, v164
    v_add_u32 v173, 65536, v165
    v_add_u32 v181, 131072, v165
    v_add_u32 v174, 65536, v166
    v_add_u32 v182, 131072, v166
    v_add_u32 v175, 65536, v167
    v_add_u32 v183, 131072, v167
    v_lshlrev_b32 v11, 3, v0
    v_min_u32 v11, 56, v11
    s_barrier
    ds_write_b128 v2, a[160:163] offset:0
    ds_write_b128 v2, a[164:167] offset:1024
    ds_write_b128 v2, a[168:171] offset:8192
    ds_write_b128 v2, a[172:175] offset:9216
    ds_write_b128 v2, a[176:179] offset:16384
    ds_write_b128 v2, a[180:183] offset:17408
    ds_write_b128 v2, a[184:187] offset:24576
    ds_write_b128 v2, a[188:191] offset:25600
    s_waitcnt lgkmcnt(4)
    ds_write_b128 v2, a[192:195] offset:32768
    ds_write_b128 v2, a[196:199] offset:33792
    ds_write_b128 v2, a[200:203] offset:40960
    ds_write_b128 v2, a[204:207] offset:41984
    ds_write_b128 v2, a[208:211] offset:49152
    ds_write_b128 v2, a[212:215] offset:50176
    ds_write_b128 v2, a[216:219] offset:57344
    ds_write_b128 v2, a[220:223] offset:58368
    s_waitcnt lgkmcnt(4)
    ds_write_b128 v3, a[224:227] offset:0
    ds_write_b128 v3, a[228:231] offset:1024
    ds_write_b128 v3, a[232:235] offset:8192
    ds_write_b128 v3, a[236:239] offset:9216
    ds_write_b128 v3, a[240:243] offset:16384
    ds_write_b128 v3, a[244:247] offset:17408
    ds_write_b128 v3, a[248:251] offset:24576
    ds_write_b128 v3, a[252:255] offset:25600
    s_waitcnt lgkmcnt(4)
    s_mov_b32 s85, 0
L_nn_a:
    s_waitcnt vmcnt(0)
    v_cmp_eq_u32 vcc, 0, v244
    s_cbranch_vccz L_nd_a
    v_mov_b32 v246, 0
    buffer_load_dwordx2 v[244:245], v246, s[68:71], 0 offen sc1
    s_add_u32 s85, s85, 1
    s_cmp_lt_u32 s85, 4000000
    s_cbranch_scc1 L_nn_a
L_nd_a:
    s_and_b32 s60, s45, 15
    s_add_u32 s60, s60, 0
    s_lshl_b32 s61, s77, 1
    s_add_u32 s61, s61, s46
    s_add_u32 s61, s61, 0
    s_lshl_b32 s61, s61, 3
    s_add_u32 s61, s61, s3
    s_lshl_b32 s61, s61, 3
    s_lshl_b32 s29, s61, 13
    s_lshl_b32 s59, s47, 12
    s_add_u32 s29, s29, s59
    s_lshl_b32 s61, s61, 3
    s_add_u32 s61, s61, 25165824
    s_mov_b32 s85, 0
    s_mov_b32 s83, 0xff
    v_mov_b32 v32, 0
    v_mov_b32 v33, 0
    v_mov_b32 v34, 0
    v_mov_b32 v35, 0
    s_nop 1
    v_mfma_f32_32x32x16_bf16 v[96:111], v[32:35], v[32:35], 0
    v_mfma_f32_32x32x16_bf16 v[112:127], v[32:35], v[32:35], 0
    v_mfma_f32_32x32x16_bf16 v[128:143], v[32:35], v[32:35], 0
    v_mfma_f32_32x32x16_bf16 v[144:159], v[32:35], v[32:35], 0
    s_waitcnt vmcnt(0)
    v_mov_b32 v246, 0
    s_mov_b64 exec, 1
    buffer_store_dwordx2 v[244:245], v246, s[20:23], s89 offen sc1
    s_mov_b64 exec, -1
    s_waitcnt lgkmcnt(0)
    s_barrier
    s_mov_b32 s16, s64
    s_mov_b32 s17, s65
L_ground_a:
    buffer_load_dwordx2 v[248:249], v11, s[20:23], s61 offen sc1
L_gchk_a:
    s_add_u32 s85, s85, 1
    s_waitcnt vmcnt(0)
    v_cmp_eq_u64 vcc, v[248:249], v[244:245]
    s_cmp_ge_u32 s85, 4000000
    s_cselect_b32 s82, 0xff, vcc_lo
    s_and_b32 s82, s82, s83
    s_cbranch_scc1 L_gwork_a
    s_sleep 8
    s_branch L_ground_a
L_gwork_a:
    s_cmp_eq_u32 s82, 0xff
    s_cbranch_scc1 L_gfast_a
    s_bitcmp1_b32 s82, 0
    s_cbranch_scc0 L_gl0_a
    s_add_u32 s37, s29, 0
    buffer_load_dwordx4 a[0:3], v1, s[20:23], s37 offen offset:0 sc1
    buffer_load_dwordx4 a[4:7], v1, s[20:23], s37 offen offset:1024 sc1
    buffer_load_dwordx4 a[8:11], v1, s[20:23], s37 offen offset:2048 sc1
    buffer_load_dwordx4 a[12:15], v1, s[20:23], s37 offen offset:3072 sc1
L_gl0_a:
    s_bitcmp1_b32 s82, 1
    s_cbranch_scc0 L_gl1_a
    s_add_u32 s37, s29, 8192
    buffer_load_dwordx4 a[16:19], v1, s[20:23], s37 offen offset:0 sc1
    buffer_load_dwordx4 a[20:23], v1, s[20:23], s37 offen offset:1024 sc1
    buffer_load_dwordx4 a[24:27], v1, s[20:23], s37 offen offset:2048 sc1
    buffer_load_dwordx4 a[28:31], v1, s[20:23], s37 offen offset:3072 sc1
L_gl1_a:
    s_bitcmp1_b32 s82, 2
    s_cbranch_scc0 L_gl2_a
    s_add_u32 s37, s29, 16384
    buffer_load_dwordx4 a[32:35], v1, s[20:23], s37 offen offset:0 sc1
    buffer_load_dwordx4 a[36:39], v1, s[20:23], s37 offen offset:1024 sc1
    buffer_load_dwordx4 a[40:43], v1, s[20:23], s37 offen offset:2048 sc1
    buffer_load_dwordx4 a[44:47], v1, s[20:23], s37 offen offset:3072 sc1
L_gl2_a:
    s_bitcmp1_b32 s82, 3
    s_cbranch_scc0 L_gl3_a
    s_add_u32 s37, s29, 24576
    buffer_load_dwordx4 a[48:51], v1, s[20:23], s37 offen offset:0 sc1
    buffer_load_dwordx4 a[52:55], v1, s[20:23], s37 offen offset:1024 sc1
    buffer_load_dwordx4 a[56:59], v1, s[20:23], s37 offen offset:2048 sc1
    buffer_load_dwordx4 a[60:63], v1, s[20:23], s37 offen offset:3072 sc1
L_gl3_a:
    s_bitcmp1_b32 s82, 4
    s_cbranch_scc0 L_gl4_a
    s_add_u32 s37, s29, 32768
    buffer_load_dwordx4 a[64:67], v1, s[20:23], s37 offen offset:0 sc1
    buffer_load_dwordx4 a[68:71], v1, s[20:23], s37 offen offset:1024 sc1
    buffer_load_dwordx4 a[72:75], v1, s[20:23], s37 offen offset:2048 sc1
    buffer_load_dwordx4 a[76:79], v1, s[20:23], s37 offen offset:3072 sc1
L_gl4_a:
    s_bitcmp1_b32 s82, 5
    s_cbranch_scc0 L_gl5_a
    s_add_u32 s37, s29, 40960
    buffer_load_dwordx4 a[80:83], v1, s[20:23], s37 offen offset:0 sc1
    buffer_load_dwordx4 a[84:87], v1, s[20:23], s37 offen offset:1024 sc1
    buffer_load_dwordx4 a[88:91], v1, s[20:23], s37 offen offset:2048 sc1
    buffer_load_dwordx4 a[92:95], v1, s[20:23], s37 offen offset:3072 sc1
L_gl5_a:
    s_bitcmp1_b32 s82, 6
    s_cbranch_scc0 L_gl6_a
    s_add_u32 s37, s29, 49152
    buffer_load_dwordx4 a[96:99], v1, s[20:23], s37 offen offset:0 sc1
    buffer_load_dwordx4 a[100:103], v1, s[20:23], s37 offen offset:1024 sc1
    buffer_load_dwordx4 a[104:107], v1, s[20:23], s37 offen offset:2048 sc1
    buffer_load_dwordx4 a[108:111], v1, s[20:23], s37 offen offset:3072 sc1
L_gl6_a:
    s_bitcmp1_b32 s82, 7
    s_cbranch_scc0 L_gl7_a
    s_add_u32 s37, s29, 57344
    buffer_load_dwordx4 a[112:115], v1, s[20:23], s37 offen offset:0 sc1
    buffer_load_dwordx4 a[116:119], v1, s[20:23], s37 offen offset:1024 sc1
    buffer_load_dwordx4 a[120:123], v1, s[20:23], s37 offen offset:2048 sc1
    buffer_load_dwordx4 a[124:127], v1, s[20:23], s37 offen offset:3072 sc1
L_gl7_a:
    s_waitcnt vmcnt(0)
    buffer_load_dwordx2 v[248:249], v11, s[20:23], s61 offen sc1
    s_bitcmp1_b32 s82, 0
    s_cbranch_scc0 L_gm0_a
    ds_read_b64_tr_b16 v[32:33], v160 offset:0
    ds_read_b64_tr_b16 v[34:35], v161 offset:1024
    ds_read_b64_tr_b16 v[36:37], v162 offset:0
    ds_read_b64_tr_b16 v[38:39], v163 offset:1024
    ds_read_b64_tr_b16 v[40:41], v164 offset:0
    ds_read_b64_tr_b16 v[42:43], v165 offset:1024
    ds_read_b64_tr_b16 v[44:45], v166 offset:0
    ds_read_b64_tr_b16 v[46:47], v167 offset:1024
    ds_read_b64_tr_b16 v[48:49], v160 offset:4096
    ds_read_b64_tr_b16 v[50:51], v161 offset:5120
    ds_read_b64_tr_b16 v[52:53], v162 offset:4096
    ds_read_b64_tr_b16 v[54:55], v163 offset:5120
    ds_read_b64_tr_b16 v[56:57], v164 offset:4096
    ds_read_b64_tr_b16 v[58:59], v165 offset:5120
    s_waitcnt lgkmcnt(6)
    v_mfma_f32_32x32x16_bf16 v[96:111], v[32:35], a[0:3], v[96:111]
    ds_read_b64_tr_b16 v[60:61], v166 offset:4096
    ds_read_b64_tr_b16 v[62:63], v167 offset:5120
    v_mfma_f32_32x32x16_bf16 v[112:127], v[36:39], a[0:3], v[112:127]
    ds_read_b64_tr_b16 v[64:65], v160 offset:8192
    ds_read_b64_tr_b16 v[66:67], v161 offset:9216
    v_mfma_f32_32x32x16_bf16 v[128:143], v[40:43], a[0:3], v[128:143]
    ds_read_b64_tr_b16 v[68:69], v162 offset:8192
    ds_read_b64_tr_b16 v[70:71], v163 offset:9216
    v_mfma_f32_32x32x16_bf16 v[144:159], v[44:47], a[0:3], v[144:159]
    ds_read_b64_tr_b16 v[72:73], v164 offset:8192
    ds_read_b64_tr_b16 v[74:75], v165 offset:9216
    s_waitcnt lgkmcnt(6)
    v_mfma_f32_32x32x16_bf16 v[96:111], v[48:51], a[4:7], v[96:111]
    ds_read_b64_tr_b16 v[76:77], v166 offset:8192
    ds_read_b64_tr_b16 v[78:79], v167 offset:9216
    v_mfma_f32_32x32x16_bf16 v[112:127], v[52:55], a[4:7], v[112:127]
    ds_read_b64_tr_b16 v[80:81], v160 offset:12288
    ds_read_b64_tr_b16 v[82:83], v161 offset:13312
    v_mfma_f32_32x32x16_bf16 v[128:143], v[56:59], a[4:7], v[128:143]
    ds_read_b64_tr_b16 v[84:85], v162 offset:12288
    ds_read_b64_tr_b16 v[86:87], v163 offset:13312
    v_mfma_f32_32x32x16_bf16 v[144:159], v[60:63], a[4:7], v[144:159]
    ds_read_b64_tr_b16 v[88:89], v164 offset:12288
    ds_read_b64_tr_b16 v[90:91], v165 offset:13312
    s_waitcnt lgkmcnt(6)
    v_mfma_f32_32x32x16_bf16 v[96:111], v[64:67], a[8:11], v[96:111]
    ds_read_b64_tr_b16 v[92:93], v166 offset:12288
    v_mfma_f32_32x32x16_bf16 v[112:127], v[68:71], a[8:11], v[112:127]
    v_mfma_f32_32x32x16_bf16 v[128:143], v[72:75], a[8:11], v[128:143]
    ds_read_b64_tr_b16 v[94:95], v167 offset:13312
    v_mfma_f32_32x32x16_bf16 v[144:159], v[76:79], a[8:11], v[144:159]
    s_waitcnt lgkmcnt(0)
    v_mfma_f32_32x32x16_bf16 v[96:111], v[80:83], a[12:15], v[96:111]
    v_mfma_f32_32x32x16_bf16 v[112:127], v[84:87], a[12:15], v[112:127]
    v_mfma_f32_32x32x16_bf16 v[128:143], v[88:91], a[12:15], v[128:143]
    v_mfma_f32_32x32x16_bf16 v[144:159], v[92:95], a[12:15], v[144:159]
L_gm0_a:
    s_bitcmp1_b32 s82, 1
    s_cbranch_scc0 L_gm1_a
    ds_read_b64_tr_b16 v[32:33], v160 offset:16384
    ds_read_b64_tr_b16 v[34:35], v161 offset:17408
    ds_read_b64_tr_b16 v[36:37], v162 offset:16384
    ds_read_b64_tr_b16 v[38:39], v163 offset:17408
    ds_read_b64_tr_b16 v[40:41], v164 offset:16384
    ds_read_b64_tr_b16 v[42:43], v165 offset:17408
    ds_read_b64_tr_b16 v[44:45], v166 offset:16384
    ds_read_b64_tr_b16 v[46:47], v167 offset:17408
    ds_read_b64_tr_b16 v[48:49], v160 offset:20480
    ds_read_b64_tr_b16 v[50:51], v161 offset:21504
    ds_read_b64_tr_b16 v[52:53], v162 offset:20480
    ds_read_b64_tr_b16 v[54:55], v163 offset:21504
    ds_read_b64_tr_b16 v[56:57], v164 offset:20480
    ds_read_b64_tr_b16 v[58:59], v165 offset:21504
    s_waitcnt lgkmcnt(6)
    v_mfma_f32_32x32x16_bf16 v[96:111], v[32:35], a[16:19], v[96:111]
    ds_read_b64_tr_b16 v[60:61], v166 offset:20480
    ds_read_b64_tr_b16 v[62:63], v167 offset:21504
    v_mfma_f32_32x32x16_bf16 v[112:127], v[36:39], a[16:19], v[112:127]
    ds_read_b64_tr_b16 v[64:65], v160 offset:24576
    ds_read_b64_tr_b16 v[66:67], v161 offset:25600
    v_mfma_f32_32x32x16_bf16 v[128:143], v[40:43], a[16:19], v[128:143]
    ds_read_b64_tr_b16 v[68:69], v162 offset:24576
    ds_read_b64_tr_b16 v[70:71], v163 offset:25600
    v_mfma_f32_32x32x16_bf16 v[144:159], v[44:47], a[16:19], v[144:159]
    ds_read_b64_tr_b16 v[72:73], v164 offset:24576
    ds_read_b64_tr_b16 v[74:75], v165 offset:25600
    s_waitcnt lgkmcnt(6)
    v_mfma_f32_32x32x16_bf16 v[96:111], v[48:51], a[20:23], v[96:111]
    ds_read_b64_tr_b16 v[76:77], v166 offset:24576
    ds_read_b64_tr_b16 v[78:79], v167 offset:25600
    v_mfma_f32_32x32x16_bf16 v[112:127], v[52:55], a[20:23], v[112:127]
    ds_read_b64_tr_b16 v[80:81], v160 offset:28672
    ds_read_b64_tr_b16 v[82:83], v161 offset:29696
    v_mfma_f32_32x32x16_bf16 v[128:143], v[56:59], a[20:23], v[128:143]
    ds_read_b64_tr_b16 v[84:85], v162 offset:28672
    ds_read_b64_tr_b16 v[86:87], v163 offset:29696
    v_mfma_f32_32x32x16_bf16 v[144:159], v[60:63], a[20:23], v[144:159]
    ds_read_b64_tr_b16 v[88:89], v164 offset:28672
    ds_read_b64_tr_b16 v[90:91], v165 offset:29696
    s_waitcnt lgkmcnt(6)
    v_mfma_f32_32x32x16_bf16 v[96:111], v[64:67], a[24:27], v[96:111]
    ds_read_b64_tr_b16 v[92:93], v166 offset:28672
    v_mfma_f32_32x32x16_bf16 v[112:127], v[68:71], a[24:27], v[112:127]
    v_mfma_f32_32x32x16_bf16 v[128:143], v[72:75], a[24:27], v[128:143]
    ds_read_b64_tr_b16 v[94:95], v167 offset:29696
    v_mfma_f32_32x32x16_bf16 v[144:159], v[76:79], a[24:27], v[144:159]
    s_waitcnt lgkmcnt(0)
    v_mfma_f32_32x32x16_bf16 v[96:111], v[80:83], a[28:31], v[96:111]
    v_mfma_f32_32x32x16_bf16 v[112:127], v[84:87], a[28:31], v[112:127]
    v_mfma_f32_32x32x16_bf16 v[128:143], v[88:91], a[28:31], v[128:143]
    v_mfma_f32_32x32x16_bf16 v[144:159], v[92:95], a[28:31], v[144:159]
L_gm1_a:
    s_bitcmp1_b32 s82, 2
    s_cbranch_scc0 L_gm2_a
    ds_read_b64_tr_b16 v[32:33], v160 offset:32768
    ds_read_b64_tr_b16 v[34:35], v161 offset:33792
    ds_read_b64_tr_b16 v[36:37], v162 offset:32768
    ds_read_b64_tr_b16 v[38:39], v163 offset:33792
    ds_read_b64_tr_b16 v[40:41], v164 offset:32768
    ds_read_b64_tr_b16 v[42:43], v165 offset:33792
    ds_read_b64_tr_b16 v[44:45], v166 offset:32768
    ds_read_b64_tr_b16 v[46:47], v167 offset:33792
    ds_read_b64_tr_b16 v[48:49], v160 offset:36864
    ds_read_b64_tr_b16 v[50:51], v161 offset:37888
    ds_read_b64_tr_b16 v[52:53], v162 offset:36864
    ds_read_b64_tr_b16 v[54:55], v163 offset:37888
    ds_read_b64_tr_b16 v[56:57], v164 offset:36864
    ds_read_b64_tr_b16 v[58:59], v165 offset:37888
    s_waitcnt lgkmcnt(6)
    v_mfma_f32_32x32x16_bf16 v[96:111], v[32:35], a[32:35], v[96:111]
    ds_read_b64_tr_b16 v[60:61], v166 offset:36864
    ds_read_b64_tr_b16 v[62:63], v167 offset:37888
    v_mfma_f32_32x32x16_bf16 v[112:127], v[36:39], a[32:35], v[112:127]
    ds_read_b64_tr_b16 v[64:65], v160 offset:40960
    ds_read_b64_tr_b16 v[66:67], v161 offset:41984
    v_mfma_f32_32x32x16_bf16 v[128:143], v[40:43], a[32:35], v[128:143]
    ds_read_b64_tr_b16 v[68:69], v162 offset:40960
    ds_read_b64_tr_b16 v[70:71], v163 offset:41984
    v_mfma_f32_32x32x16_bf16 v[144:159], v[44:47], a[32:35], v[144:159]
    ds_read_b64_tr_b16 v[72:73], v164 offset:40960
    ds_read_b64_tr_b16 v[74:75], v165 offset:41984
    s_waitcnt lgkmcnt(6)
    v_mfma_f32_32x32x16_bf16 v[96:111], v[48:51], a[36:39], v[96:111]
    ds_read_b64_tr_b16 v[76:77], v166 offset:40960
    ds_read_b64_tr_b16 v[78:79], v167 offset:41984
    v_mfma_f32_32x32x16_bf16 v[112:127], v[52:55], a[36:39], v[112:127]
    ds_read_b64_tr_b16 v[80:81], v160 offset:45056
    ds_read_b64_tr_b16 v[82:83], v161 offset:46080
    v_mfma_f32_32x32x16_bf16 v[128:143], v[56:59], a[36:39], v[128:143]
    ds_read_b64_tr_b16 v[84:85], v162 offset:45056
    ds_read_b64_tr_b16 v[86:87], v163 offset:46080
    v_mfma_f32_32x32x16_bf16 v[144:159], v[60:63], a[36:39], v[144:159]
    ds_read_b64_tr_b16 v[88:89], v164 offset:45056
    ds_read_b64_tr_b16 v[90:91], v165 offset:46080
    s_waitcnt lgkmcnt(6)
    v_mfma_f32_32x32x16_bf16 v[96:111], v[64:67], a[40:43], v[96:111]
    ds_read_b64_tr_b16 v[92:93], v166 offset:45056
    v_mfma_f32_32x32x16_bf16 v[112:127], v[68:71], a[40:43], v[112:127]
    v_mfma_f32_32x32x16_bf16 v[128:143], v[72:75], a[40:43], v[128:143]
    ds_read_b64_tr_b16 v[94:95], v167 offset:46080
    v_mfma_f32_32x32x16_bf16 v[144:159], v[76:79], a[40:43], v[144:159]
    s_waitcnt lgkmcnt(0)
    v_mfma_f32_32x32x16_bf16 v[96:111], v[80:83], a[44:47], v[96:111]
    v_mfma_f32_32x32x16_bf16 v[112:127], v[84:87], a[44:47], v[112:127]
    v_mfma_f32_32x32x16_bf16 v[128:143], v[88:91], a[44:47], v[128:143]
    v_mfma_f32_32x32x16_bf16 v[144:159], v[92:95], a[44:47], v[144:159]
L_gm2_a:
    s_bitcmp1_b32 s82, 3
    s_cbranch_scc0 L_gm3_a
    ds_read_b64_tr_b16 v[32:33], v160 offset:49152
    ds_read_b64_tr_b16 v[34:35], v161 offset:50176
    ds_read_b64_tr_b16 v[36:37], v162 offset:49152
    ds_read_b64_tr_b16 v[38:39], v163 offset:50176
    ds_read_b64_tr_b16 v[40:41], v164 offset:49152
    ds_read_b64_tr_b16 v[42:43], v165 offset:50176
    ds_read_b64_tr_b16 v[44:45], v166 offset:49152
    ds_read_b64_tr_b16 v[46:47], v167 offset:50176
    ds_read_b64_tr_b16 v[48:49], v160 offset:53248
    ds_read_b64_tr_b16 v[50:51], v161 offset:54272
    ds_read_b64_tr_b16 v[52:53], v162 offset:53248
    ds_read_b64_tr_b16 v[54:55], v163 offset:54272
    ds_read_b64_tr_b16 v[56:57], v164 offset:53248
    ds_read_b64_tr_b16 v[58:59], v165 offset:54272
    s_waitcnt lgkmcnt(6)
    v_mfma_f32_32x32x16_bf16 v[96:111], v[32:35], a[48:51], v[96:111]
    ds_read_b64_tr_b16 v[60:61], v166 offset:53248
    ds_read_b64_tr_b16 v[62:63], v167 offset:54272
    v_mfma_f32_32x32x16_bf16 v[112:127], v[36:39], a[48:51], v[112:127]
    ds_read_b64_tr_b16 v[64:65], v160 offset:57344
    ds_read_b64_tr_b16 v[66:67], v161 offset:58368
    v_mfma_f32_32x32x16_bf16 v[128:143], v[40:43], a[48:51], v[128:143]
    ds_read_b64_tr_b16 v[68:69], v162 offset:57344
    ds_read_b64_tr_b16 v[70:71], v163 offset:58368
    v_mfma_f32_32x32x16_bf16 v[144:159], v[44:47], a[48:51], v[144:159]
    ds_read_b64_tr_b16 v[72:73], v164 offset:57344
    ds_read_b64_tr_b16 v[74:75], v165 offset:58368
    s_waitcnt lgkmcnt(6)
    v_mfma_f32_32x32x16_bf16 v[96:111], v[48:51], a[52:55], v[96:111]
    ds_read_b64_tr_b16 v[76:77], v166 offset:57344
    ds_read_b64_tr_b16 v[78:79], v167 offset:58368
    v_mfma_f32_32x32x16_bf16 v[112:127], v[52:55], a[52:55], v[112:127]
    ds_read_b64_tr_b16 v[80:81], v160 offset:61440
    ds_read_b64_tr_b16 v[82:83], v161 offset:62464
    v_mfma_f32_32x32x16_bf16 v[128:143], v[56:59], a[52:55], v[128:143]
    ds_read_b64_tr_b16 v[84:85], v162 offset:61440
    ds_read_b64_tr_b16 v[86:87], v163 offset:62464
    v_mfma_f32_32x32x16_bf16 v[144:159], v[60:63], a[52:55], v[144:159]
    ds_read_b64_tr_b16 v[88:89], v164 offset:61440
    ds_read_b64_tr_b16 v[90:91], v165 offset:62464
    s_waitcnt lgkmcnt(6)
    v_mfma_f32_32x32x16_bf16 v[96:111], v[64:67], a[56:59], v[96:111]
    ds_read_b64_tr_b16 v[92:93], v166 offset:61440
    v_mfma_f32_32x32x16_bf16 v[112:127], v[68:71], a[56:59], v[112:127]
    v_mfma_f32_32x32x16_bf16 v[128:143], v[72:75], a[56:59], v[128:143]
    ds_read_b64_tr_b16 v[94:95], v167 offset:62464
    v_mfma_f32_32x32x16_bf16 v[144:159], v[76:79], a[56:59], v[144:159]
    s_waitcnt lgkmcnt(0)
    v_mfma_f32_32x32x16_bf16 v[96:111], v[80:83], a[60:63], v[96:111]
    v_mfma_f32_32x32x16_bf16 v[112:127], v[84:87], a[60:63], v[112:127]
    v_mfma_f32_32x32x16_bf16 v[128:143], v[88:91], a[60:63], v[128:143]
    v_mfma_f32_32x32x16_bf16 v[144:159], v[92:95], a[60:63], v[144:159]
L_gm3_a:
    s_bitcmp1_b32 s82, 4
    s_cbranch_scc0 L_gm4_a
    ds_read_b64_tr_b16 v[32:33], v168 offset:0
    ds_read_b64_tr_b16 v[34:35], v169 offset:1024
    ds_read_b64_tr_b16 v[36:37], v170 offset:0
    ds_read_b64_tr_b16 v[38:39], v171 offset:1024
    ds_read_b64_tr_b16 v[40:41], v172 offset:0
    ds_read_b64_tr_b16 v[42:43], v173 offset:1024
    ds_read_b64_tr_b16 v[44:45], v174 offset:0
    ds_read_b64_tr_b16 v[46:47], v175 offset:1024
    ds_read_b64_tr_b16 v[48:49], v168 offset:4096
    ds_read_b64_tr_b16 v[50:51], v169 offset:5120
    ds_read_b64_tr_b16 v[52:53], v170 offset:4096
    ds_read_b64_tr_b16 v[54:55], v171 offset:5120
    ds_read_b64_tr_b16 v[56:57], v172 offset:4096
    ds_read_b64_tr_b16 v[58:59], v173 offset:5120
    s_waitcnt lgkmcnt(6)
    v_mfma_f32_32x32x16_bf16 v[96:111], v[32:35], a[64:67], v[96:111]
    ds_read_b64_tr_b16 v[60:61], v174 offset:4096
    ds_read_b64_tr_b16 v[62:63], v175 offset:5120
    v_mfma_f32_32x32x16_bf16 v[112:127], v[36:39], a[64:67], v[112:127]
    ds_read_b64_tr_b16 v[64:65], v168 offset:8192
    ds_read_b64_tr_b16 v[66:67], v169 offset:9216
    v_mfma_f32_32x32x16_bf16 v[128:143], v[40:43], a[64:67], v[128:143]
    ds_read_b64_tr_b16 v[68:69], v170 offset:8192
    ds_read_b64_tr_b16 v[70:71], v171 offset:9216
    v_mfma_f32_32x32x16_bf16 v[144:159], v[44:47], a[64:67], v[144:159]
    ds_read_b64_tr_b16 v[72:73], v172 offset:8192
    ds_read_b64_tr_b16 v[74:75], v173 offset:9216
    s_waitcnt lgkmcnt(6)
    v_mfma_f32_32x32x16_bf16 v[96:111], v[48:51], a[68:71], v[96:111]
    ds_read_b64_tr_b16 v[76:77], v174 offset:8192
    ds_read_b64_tr_b16 v[78:79], v175 offset:9216
    v_mfma_f32_32x32x16_bf16 v[112:127], v[52:55], a[68:71], v[112:127]
    ds_read_b64_tr_b16 v[80:81], v168 offset:12288
    ds_read_b64_tr_b16 v[82:83], v169 offset:13312
    v_mfma_f32_32x32x16_bf16 v[128:143], v[56:59], a[68:71], v[128:143]
    ds_read_b64_tr_b16 v[84:85], v170 offset:12288
    ds_read_b64_tr_b16 v[86:87], v171 offset:13312
    v_mfma_f32_32x32x16_bf16 v[144:159], v[60:63], a[68:71], v[144:159]
    ds_read_b64_tr_b16 v[88:89], v172 offset:12288
    ds_read_b64_tr_b16 v[90:91], v173 offset:13312
    s_waitcnt lgkmcnt(6)
    v_mfma_f32_32x32x16_bf16 v[96:111], v[64:67], a[72:75], v[96:111]
    ds_read_b64_tr_b16 v[92:93], v174 offset:12288
    v_mfma_f32_32x32x16_bf16 v[112:127], v[68:71], a[72:75], v[112:127]
    v_mfma_f32_32x32x16_bf16 v[128:143], v[72:75], a[72:75], v[128:143]
    ds_read_b64_tr_b16 v[94:95], v175 offset:13312
    v_mfma_f32_32x32x16_bf16 v[144:159], v[76:79], a[72:75], v[144:159]
    s_waitcnt lgkmcnt(0)
    v_mfma_f32_32x32x16_bf16 v[96:111], v[80:83], a[76:79], v[96:111]
    v_mfma_f32_32x32x16_bf16 v[112:127], v[84:87], a[76:79], v[112:127]
    v_mfma_f32_32x32x16_bf16 v[128:143], v[88:91], a[76:79], v[128:143]
    v_mfma_f32_32x32x16_bf16 v[144:159], v[92:95], a[76:79], v[144:159]
L_gm4_a:
    s_bitcmp1_b32 s82, 5
    s_cbranch_scc0 L_gm5_a
    ds_read_b64_tr_b16 v[32:33], v168 offset:16384
    ds_read_b64_tr_b16 v[34:35], v169 offset:17408
    ds_read_b64_tr_b16 v[36:37], v170 offset:16384
    ds_read_b64_tr_b16 v[38:39], v171 offset:17408
    ds_read_b64_tr_b16 v[40:41], v172 offset:16384
    ds_read_b64_tr_b16 v[42:43], v173 offset:17408
    ds_read_b64_tr_b16 v[44:45], v174 offset:16384
    ds_read_b64_tr_b16 v[46:47], v175 offset:17408
    ds_read_b64_tr_b16 v[48:49], v168 offset:20480
    ds_read_b64_tr_b16 v[50:51], v169 offset:21504
    ds_read_b64_tr_b16 v[52:53], v170 offset:20480
    ds_read_b64_tr_b16 v[54:55], v171 offset:21504
    ds_read_b64_tr_b16 v[56:57], v172 offset:20480
    ds_read_b64_tr_b16 v[58:59], v173 offset:21504
    s_waitcnt lgkmcnt(6)
    v_mfma_f32_32x32x16_bf16 v[96:111], v[32:35], a[80:83], v[96:111]
    ds_read_b64_tr_b16 v[60:61], v174 offset:20480
    ds_read_b64_tr_b16 v[62:63], v175 offset:21504
    v_mfma_f32_32x32x16_bf16 v[112:127], v[36:39], a[80:83], v[112:127]
    ds_read_b64_tr_b16 v[64:65], v168 offset:24576
    ds_read_b64_tr_b16 v[66:67], v169 offset:25600
    v_mfma_f32_32x32x16_bf16 v[128:143], v[40:43], a[80:83], v[128:143]
    ds_read_b64_tr_b16 v[68:69], v170 offset:24576
    ds_read_b64_tr_b16 v[70:71], v171 offset:25600
    v_mfma_f32_32x32x16_bf16 v[144:159], v[44:47], a[80:83], v[144:159]
    ds_read_b64_tr_b16 v[72:73], v172 offset:24576
    ds_read_b64_tr_b16 v[74:75], v173 offset:25600
    s_waitcnt lgkmcnt(6)
    v_mfma_f32_32x32x16_bf16 v[96:111], v[48:51], a[84:87], v[96:111]
    ds_read_b64_tr_b16 v[76:77], v174 offset:24576
    ds_read_b64_tr_b16 v[78:79], v175 offset:25600
    v_mfma_f32_32x32x16_bf16 v[112:127], v[52:55], a[84:87], v[112:127]
    ds_read_b64_tr_b16 v[80:81], v168 offset:28672
    ds_read_b64_tr_b16 v[82:83], v169 offset:29696
    v_mfma_f32_32x32x16_bf16 v[128:143], v[56:59], a[84:87], v[128:143]
    ds_read_b64_tr_b16 v[84:85], v170 offset:28672
    ds_read_b64_tr_b16 v[86:87], v171 offset:29696
    v_mfma_f32_32x32x16_bf16 v[144:159], v[60:63], a[84:87], v[144:159]
    ds_read_b64_tr_b16 v[88:89], v172 offset:28672
    ds_read_b64_tr_b16 v[90:91], v173 offset:29696
    s_waitcnt lgkmcnt(6)
    v_mfma_f32_32x32x16_bf16 v[96:111], v[64:67], a[88:91], v[96:111]
    ds_read_b64_tr_b16 v[92:93], v174 offset:28672
    v_mfma_f32_32x32x16_bf16 v[112:127], v[68:71], a[88:91], v[112:127]
    v_mfma_f32_32x32x16_bf16 v[128:143], v[72:75], a[88:91], v[128:143]
    ds_read_b64_tr_b16 v[94:95], v175 offset:29696
    v_mfma_f32_32x32x16_bf16 v[144:159], v[76:79], a[88:91], v[144:159]
    s_waitcnt lgkmcnt(0)
    v_mfma_f32_32x32x16_bf16 v[96:111], v[80:83], a[92:95], v[96:111]
    v_mfma_f32_32x32x16_bf16 v[112:127], v[84:87], a[92:95], v[112:127]
    v_mfma_f32_32x32x16_bf16 v[128:143], v[88:91], a[92:95], v[128:143]
    v_mfma_f32_32x32x16_bf16 v[144:159], v[92:95], a[92:95], v[144:159]
L_gm5_a:
    s_bitcmp1_b32 s82, 6
    s_cbranch_scc0 L_gm6_a
    ds_read_b64_tr_b16 v[32:33], v176 offset:0
    ds_read_b64_tr_b16 v[34:35], v177 offset:1024
    ds_read_b64_tr_b16 v[36:37], v178 offset:0
    ds_read_b64_tr_b16 v[38:39], v179 offset:1024
    ds_read_b64_tr_b16 v[40:41], v180 offset:0
    ds_read_b64_tr_b16 v[42:43], v181 offset:1024
    ds_read_b64_tr_b16 v[44:45], v182 offset:0
    ds_read_b64_tr_b16 v[46:47], v183 offset:1024
    ds_read_b64_tr_b16 v[48:49], v176 offset:4096
    ds_read_b64_tr_b16 v[50:51], v177 offset:5120
    ds_read_b64_tr_b16 v[52:53], v178 offset:4096
    ds_read_b64_tr_b16 v[54:55], v179 offset:5120
    ds_read_b64_tr_b16 v[56:57], v180 offset:4096
    ds_read_b64_tr_b16 v[58:59], v181 offset:5120
    s_waitcnt lgkmcnt(6)
    v_mfma_f32_32x32x16_bf16 v[96:111], v[32:35], a[96:99], v[96:111]
    ds_read_b64_tr_b16 v[60:61], v182 offset:4096
    ds_read_b64_tr_b16 v[62:63], v183 offset:5120
    v_mfma_f32_32x32x16_bf16 v[112:127], v[36:39], a[96:99], v[112:127]
    ds_read_b64_tr_b16 v[64:65], v176 offset:8192
    ds_read_b64_tr_b16 v[66:67], v177 offset:9216
    v_mfma_f32_32x32x16_bf16 v[128:143], v[40:43], a[96:99], v[128:143]
    ds_read_b64_tr_b16 v[68:69], v178 offset:8192
    ds_read_b64_tr_b16 v[70:71], v179 offset:9216
    v_mfma_f32_32x32x16_bf16 v[144:159], v[44:47], a[96:99], v[144:159]
    ds_read_b64_tr_b16 v[72:73], v180 offset:8192
    ds_read_b64_tr_b16 v[74:75], v181 offset:9216
    s_waitcnt lgkmcnt(6)
    v_mfma_f32_32x32x16_bf16 v[96:111], v[48:51], a[100:103], v[96:111]
    ds_read_b64_tr_b16 v[76:77], v182 offset:8192
    ds_read_b64_tr_b16 v[78:79], v183 offset:9216
    v_mfma_f32_32x32x16_bf16 v[112:127], v[52:55], a[100:103], v[112:127]
    ds_read_b64_tr_b16 v[80:81], v176 offset:12288
    ds_read_b64_tr_b16 v[82:83], v177 offset:13312
    v_mfma_f32_32x32x16_bf16 v[128:143], v[56:59], a[100:103], v[128:143]
    ds_read_b64_tr_b16 v[84:85], v178 offset:12288
    ds_read_b64_tr_b16 v[86:87], v179 offset:13312
    v_mfma_f32_32x32x16_bf16 v[144:159], v[60:63], a[100:103], v[144:159]
    ds_read_b64_tr_b16 v[88:89], v180 offset:12288
    ds_read_b64_tr_b16 v[90:91], v181 offset:13312
    s_waitcnt lgkmcnt(6)
    v_mfma_f32_32x32x16_bf16 v[96:111], v[64:67], a[104:107], v[96:111]
    ds_read_b64_tr_b16 v[92:93], v182 offset:12288
    v_mfma_f32_32x32x16_bf16 v[112:127], v[68:71], a[104:107], v[112:127]
    v_mfma_f32_32x32x16_bf16 v[128:143], v[72:75], a[104:107], v[128:143]
    ds_read_b64_tr_b16 v[94:95], v183 offset:13312
    v_mfma_f32_32x32x16_bf16 v[144:159], v[76:79], a[104:107], v[144:159]
    s_waitcnt lgkmcnt(0)
    v_mfma_f32_32x32x16_bf16 v[96:111], v[80:83], a[108:111], v[96:111]
    v_mfma_f32_32x32x16_bf16 v[112:127], v[84:87], a[108:111], v[112:127]
    v_mfma_f32_32x32x16_bf16 v[128:143], v[88:91], a[108:111], v[128:143]
    v_mfma_f32_32x32x16_bf16 v[144:159], v[92:95], a[108:111], v[144:159]
L_gm6_a:
    s_bitcmp1_b32 s82, 7
    s_cbranch_scc0 L_gm7_a
    ds_read_b64_tr_b16 v[32:33], v176 offset:16384
    ds_read_b64_tr_b16 v[34:35], v177 offset:17408
    ds_read_b64_tr_b16 v[36:37], v178 offset:16384
    ds_read_b64_tr_b16 v[38:39], v179 offset:17408
    ds_read_b64_tr_b16 v[40:41], v180 offset:16384
    ds_read_b64_tr_b16 v[42:43], v181 offset:17408
    ds_read_b64_tr_b16 v[44:45], v182 offset:16384
    ds_read_b64_tr_b16 v[46:47], v183 offset:17408
    ds_read_b64_tr_b16 v[48:49], v176 offset:20480
    ds_read_b64_tr_b16 v[50:51], v177 offset:21504
    ds_read_b64_tr_b16 v[52:53], v178 offset:20480
    ds_read_b64_tr_b16 v[54:55], v179 offset:21504
    ds_read_b64_tr_b16 v[56:57], v180 offset:20480
    ds_read_b64_tr_b16 v[58:59], v181 offset:21504
    s_waitcnt lgkmcnt(6)
    v_mfma_f32_32x32x16_bf16 v[96:111], v[32:35], a[112:115], v[96:111]
    ds_read_b64_tr_b16 v[60:61], v182 offset:20480
    ds_read_b64_tr_b16 v[62:63], v183 offset:21504
    v_mfma_f32_32x32x16_bf16 v[112:127], v[36:39], a[112:115], v[112:127]
    ds_read_b64_tr_b16 v[64:65], v176 offset:24576
    ds_read_b64_tr_b16 v[66:67], v177 offset:25600
    v_mfma_f32_32x32x16_bf16 v[128:143], v[40:43], a[112:115], v[128:143]
    ds_read_b64_tr_b16 v[68:69], v178 offset:24576
    ds_read_b64_tr_b16 v[70:71], v179 offset:25600
    v_mfma_f32_32x32x16_bf16 v[144:159], v[44:47], a[112:115], v[144:159]
    ds_read_b64_tr_b16 v[72:73], v180 offset:24576
    ds_read_b64_tr_b16 v[74:75], v181 offset:25600
    s_waitcnt lgkmcnt(6)
    v_mfma_f32_32x32x16_bf16 v[96:111], v[48:51], a[116:119], v[96:111]
    ds_read_b64_tr_b16 v[76:77], v182 offset:24576
    ds_read_b64_tr_b16 v[78:79], v183 offset:25600
    v_mfma_f32_32x32x16_bf16 v[112:127], v[52:55], a[116:119], v[112:127]
    ds_read_b64_tr_b16 v[80:81], v176 offset:28672
    ds_read_b64_tr_b16 v[82:83], v177 offset:29696
    v_mfma_f32_32x32x16_bf16 v[128:143], v[56:59], a[116:119], v[128:143]
    ds_read_b64_tr_b16 v[84:85], v178 offset:28672
    ds_read_b64_tr_b16 v[86:87], v179 offset:29696
    v_mfma_f32_32x32x16_bf16 v[144:159], v[60:63], a[116:119], v[144:159]
    ds_read_b64_tr_b16 v[88:89], v180 offset:28672
    ds_read_b64_tr_b16 v[90:91], v181 offset:29696
    s_waitcnt lgkmcnt(6)
    v_mfma_f32_32x32x16_bf16 v[96:111], v[64:67], a[120:123], v[96:111]
    ds_read_b64_tr_b16 v[92:93], v182 offset:28672
    v_mfma_f32_32x32x16_bf16 v[112:127], v[68:71], a[120:123], v[112:127]
    v_mfma_f32_32x32x16_bf16 v[128:143], v[72:75], a[120:123], v[128:143]
    ds_read_b64_tr_b16 v[94:95], v183 offset:29696
    v_mfma_f32_32x32x16_bf16 v[144:159], v[76:79], a[120:123], v[144:159]
    s_waitcnt lgkmcnt(0)
    v_mfma_f32_32x32x16_bf16 v[96:111], v[80:83], a[124:127], v[96:111]
    v_mfma_f32_32x32x16_bf16 v[112:127], v[84:87], a[124:127], v[112:127]
    v_mfma_f32_32x32x16_bf16 v[128:143], v[88:91], a[124:127], v[128:143]
    v_mfma_f32_32x32x16_bf16 v[144:159], v[92:95], a[124:127], v[144:159]
L_gm7_a:
    s_andn2_b32 s83, s83, s82
    s_cbranch_scc1 L_gchk_a
    s_add_u32 s81, s30, 0
    buffer_load_dwordx4 a[128:131], v252, s[16:19], s81 offen
    buffer_load_dwordx4 a[132:135], v253, s[16:19], s81 offen offset:1024
    s_add_u32 s81, s30, 32768
    buffer_load_dwordx4 a[136:139], v252, s[16:19], s81 offen
    buffer_load_dwordx4 a[140:143], v253, s[16:19], s81 offen offset:1024
    s_add_u32 s81, s30, 65536
    buffer_load_dwordx4 a[144:147], v252, s[16:19], s81 offen
    buffer_load_dwordx4 a[148:151], v253, s[16:19], s81 offen offset:1024
    s_add_u32 s81, s30, 98304
    buffer_load_dwordx4 a[152:155], v252, s[16:19], s81 offen
    buffer_load_dwordx4 a[156:159], v253, s[16:19], s81 offen offset:1024
    s_add_u32 s81, s30, 131072
    buffer_load_dwordx4 a[160:163], v252, s[16:19], s81 offen
    buffer_load_dwordx4 a[164:167], v253, s[16:19], s81 offen offset:1024
    s_add_u32 s81, s30, 163840
    buffer_load_dwordx4 a[168:171], v252, s[16:19], s81 offen
    buffer_load_dwordx4 a[172:175], v253, s[16:19], s81 offen offset:1024
    s_add_u32 s81, s30, 196608
    buffer_load_dwordx4 a[176:179], v252, s[16:19], s81 offen
    buffer_load_dwordx4 a[180:183], v253, s[16:19], s81 offen offset:1024
    s_add_u32 s81, s30, 229376
    buffer_load_dwordx4 a[184:187], v252, s[16:19], s81 offen
    buffer_load_dwordx4 a[188:191], v253, s[16:19], s81 offen offset:1024
    s_add_u32 s81, s30, 262144
    buffer_load_dwordx4 a[192:195], v252, s[16:19], s81 offen
    buffer_load_dwordx4 a[196:199], v253, s[16:19], s81 offen offset:1024
    s_add_u32 s81, s30, 294912
    buffer_load_dwordx4 a[200:203], v252, s[16:19], s81 offen
    buffer_load_dwordx4 a[204:207], v253, s[16:19], s81 offen offset:1024
    s_add_u32 s81, s30, 327680
    buffer_load_dwordx4 a[208:211], v252, s[16:19], s81 offen
    buffer_load_dwordx4 a[212:215], v253, s[16:19], s81 offen offset:1024
    s_add_u32 s81, s30, 360448
    buffer_load_dwordx4 a[216:219], v252, s[16:19], s81 offen
    buffer_load_dwordx4 a[220:223], v253, s[16:19], s81 offen offset:1024
    s_add_u32 s81, s30, 393216
    buffer_load_dwordx4 a[224:227], v252, s[16:19], s81 offen
    buffer_load_dwordx4 a[228:231], v253, s[16:19], s81 offen offset:1024
    s_add_u32 s81, s30, 425984
    buffer_load_dwordx4 a[232:235], v252, s[16:19], s81 offen
    buffer_load_dwordx4 a[236:239], v253, s[16:19], s81 offen offset:1024
    s_add_u32 s81, s30, 458752
    buffer_load_dwordx4 a[240:243], v252, s[16:19], s81 offen
    buffer_load_dwordx4 a[244:247], v253, s[16:19], s81 offen offset:1024
    s_add_u32 s81, s30, 491520
    buffer_load_dwordx4 a[248:251], v252, s[16:19], s81 offen
    buffer_load_dwordx4 a[252:255], v253, s[16:19], s81 offen offset:1024
    s_branch L_gdone_a
L_gfast_a:
    s_add_u32 s37, s29, 0
    buffer_load_dwordx4 a[0:3], v1, s[20:23], s37 offen offset:0 sc1
    buffer_load_dwordx4 a[4:7], v1, s[20:23], s37 offen offset:1024 sc1
    buffer_load_dwordx4 a[8:11], v1, s[20:23], s37 offen offset:2048 sc1
    buffer_load_dwordx4 a[12:15], v1, s[20:23], s37 offen offset:3072 sc1
    s_add_u32 s37, s29, 8192
    buffer_load_dwordx4 a[16:19], v1, s[20:23], s37 offen offset:0 sc1
    buffer_load_dwordx4 a[20:23], v1, s[20:23], s37 offen offset:1024 sc1
    buffer_load_dwordx4 a[24:27], v1, s[20:23], s37 offen offset:2048 sc1
    buffer_load_dwordx4 a[28:31], v1, s[20:23], s37 offen offset:3072 sc1
    s_add_u32 s37, s29, 16384
    buffer_load_dwordx4 a[32:35], v1, s[20:23], s37 offen offset:0 sc1
    buffer_load_dwordx4 a[36:39], v1, s[20:23], s37 offen offset:1024 sc1
    buffer_load_dwordx4 a[40:43], v1, s[20:23], s37 offen offset:2048 sc1
    buffer_load_dwordx4 a[44:47], v1, s[20:23], s37 offen offset:3072 sc1
    s_add_u32 s37, s29, 24576
    buffer_load_dwordx4 a[48:51], v1, s[20:23], s37 offen offset:0 sc1
    buffer_load_dwordx4 a[52:55], v1, s[20:23], s37 offen offset:1024 sc1
    buffer_load_dwordx4 a[56:59], v1, s[20:23], s37 offen offset:2048 sc1
    buffer_load_dwordx4 a[60:63], v1, s[20:23], s37 offen offset:3072 sc1
    ds_read_b64_tr_b16 v[32:33], v160 offset:0
    ds_read_b64_tr_b16 v[34:35], v161 offset:1024
    ds_read_b64_tr_b16 v[36:37], v162 offset:0
    ds_read_b64_tr_b16 v[38:39], v163 offset:1024
    ds_read_b64_tr_b16 v[40:41], v164 offset:0
    ds_read_b64_tr_b16 v[42:43], v165 offset:1024
    ds_read_b64_tr_b16 v[44:45], v166 offset:0
    ds_read_b64_tr_b16 v[46:47], v167 offset:1024
    ds_read_b64_tr_b16 v[48:49], v160 offset:4096
    ds_read_b64_tr_b16 v[50:51], v161 offset:5120
    ds_read_b64_tr_b16 v[52:53], v162 offset:4096
    ds_read_b64_tr_b16 v[54:55], v163 offset:5120
    ds_read_b64_tr_b16 v[56:57], v164 offset:4096
    ds_read_b64_tr_b16 v[58:59], v165 offset:5120
    s_waitcnt vmcnt(12) lgkmcnt(6)
    v_mfma_f32_32x32x16_bf16 v[96:111], v[32:35], a[0:3], v[96:111]
    ds_read_b64_tr_b16 v[60:61], v166 offset:4096
    ds_read_b64_tr_b16 v[62:63], v167 offset:5120
    ds_read_b64_tr_b16 v[64:65], v160 offset:8192
    v_mfma_f32_32x32x16_bf16 v[112:127], v[36:39], a[0:3], v[112:127]
    ds_read_b64_tr_b16 v[66:67], v161 offset:9216
    s_add_u32 s37, s29, 32768
    buffer_load_dwordx4 a[64:67], v1, s[20:23], s37 offen offset:0 sc1
    v_mfma_f32_32x32x16_bf16 v[128:143], v[40:43], a[0:3], v[128:143]
    buffer_load_dwordx4 a[68:71], v1, s[20:23], s37 offen offset:1024 sc1
    ds_read_b64_tr_b16 v[68:69], v162 offset:8192
    ds_read_b64_tr_b16 v[70:71], v163 offset:9216
    v_mfma_f32_32x32x16_bf16 v[144:159], v[44:47], a[0:3], v[144:159]
    ds_read_b64_tr_b16 v[72:73], v164 offset:8192
    ds_read_b64_tr_b16 v[74:75], v165 offset:9216
    s_waitcnt lgkmcnt(6)
    v_mfma_f32_32x32x16_bf16 v[96:111], v[48:51], a[4:7], v[96:111]
    ds_read_b64_tr_b16 v[76:77], v166 offset:8192
    ds_read_b64_tr_b16 v[78:79], v167 offset:9216
    ds_read_b64_tr_b16 v[80:81], v160 offset:12288
    v_mfma_f32_32x32x16_bf16 v[112:127], v[52:55], a[4:7], v[112:127]
    ds_read_b64_tr_b16 v[82:83], v161 offset:13312
    buffer_load_dwordx4 a[72:75], v1, s[20:23], s37 offen offset:2048 sc1
    buffer_load_dwordx4 a[76:79], v1, s[20:23], s37 offen offset:3072 sc1
    v_mfma_f32_32x32x16_bf16 v[128:143], v[56:59], a[4:7], v[128:143]
    ds_read_b64_tr_b16 v[84:85], v162 offset:12288
    ds_read_b64_tr_b16 v[86:87], v163 offset:13312
    v_mfma_f32_32x32x16_bf16 v[144:159], v[60:63], a[4:7], v[144:159]
    ds_read_b64_tr_b16 v[88:89], v164 offset:12288
    ds_read_b64_tr_b16 v[90:91], v165 offset:13312
    s_waitcnt lgkmcnt(6)
    v_mfma_f32_32x32x16_bf16 v[96:111], v[64:67], a[8:11], v[96:111]
    ds_read_b64_tr_b16 v[92:93], v166 offset:12288
    ds_read_b64_tr_b16 v[94:95], v167 offset:13312
    v_mfma_f32_32x32x16_bf16 v[112:127], v[68:71], a[8:11], v[112:127]
    ds_read_b64_tr_b16 v[32:33], v160 offset:16384
    ds_read_b64_tr_b16 v[34:35], v161 offset:17408
    v_mfma_f32_32x32x16_bf16 v[128:143], v[72:75], a[8:11], v[128:143]
    ds_read_b64_tr_b16 v[36:37], v162 offset:16384
    ds_read_b64_tr_b16 v[38:39], v163 offset:17408
    v_mfma_f32_32x32x16_bf16 v[144:159], v[76:79], a[8:11], v[144:159]
    ds_read_b64_tr_b16 v[40:41], v164 offset:16384
    ds_read_b64_tr_b16 v[42:43], v165 offset:17408
    s_waitcnt lgkmcnt(6)
    v_mfma_f32_32x32x16_bf16 v[96:111], v[80:83], a[12:15], v[96:111]
    ds_read_b64_tr_b16 v[44:45], v166 offset:16384
    ds_read_b64_tr_b16 v[46:47], v167 offset:17408
    v_mfma_f32_32x32x16_bf16 v[112:127], v[84:87], a[12:15], v[112:127]
    ds_read_b64_tr_b16 v[48:49], v160 offset:20480
    ds_read_b64_tr_b16 v[50:51], v161 offset:21504
    v_mfma_f32_32x32x16_bf16 v[128:143], v[88:91], a[12:15], v[128:143]
    ds_read_b64_tr_b16 v[52:53], v162 offset:20480
    ds_read_b64_tr_b16 v[54:55], v163 offset:21504
    v_mfma_f32_32x32x16_bf16 v[144:159], v[92:95], a[12:15], v[144:159]
    ds_read_b64_tr_b16 v[56:57], v164 offset:20480
    ds_read_b64_tr_b16 v[58:59], v165 offset:21504
    s_waitcnt vmcnt(12) lgkmcnt(6)
    v_mfma_f32_32x32x16_bf16 v[96:111], v[32:35], a[16:19], v[96:111]
    ds_read_b64_tr_b16 v[60:61], v166 offset:20480
    ds_read_b64_tr_b16 v[62:63], v167 offset:21504
    ds_read_b64_tr_b16 v[64:65], v160 offset:24576
    v_mfma_f32_32x32x16_bf16 v[112:127], v[36:39], a[16:19], v[112:127]
    ds_read_b64_tr_b16 v[66:67], v161 offset:25600
    s_add_u32 s37, s29, 40960
    buffer_load_dwordx4 a[80:83], v1, s[20:23], s37 offen offset:0 sc1
    v_mfma_f32_32x32x16_bf16 v[128:143], v[40:43], a[16:19], v[128:143]
    buffer_load_dwordx4 a[84:87], v1, s[20:23], s37 offen offset:1024 sc1
    ds_read_b64_tr_b16 v[68:69], v162 offset:24576
    ds_read_b64_tr_b16 v[70:71], v163 offset:25600
    v_mfma_f32_32x32x16_bf16 v[144:159], v[44:47], a[16:19], v[144:159]
    ds_read_b64_tr_b16 v[72:73], v164 offset:24576
    ds_read_b64_tr_b16 v[74:75], v165 offset:25600
    s_waitcnt lgkmcnt(6)
    v_mfma_f32_32x32x16_bf16 v[96:111], v[48:51], a[20:23], v[96:111]
    ds_read_b64_tr_b16 v[76:77], v166 offset:24576
    ds_read_b64_tr_b16 v[78:79], v167 offset:25600
    ds_read_b64_tr_b16 v[80:81], v160 offset:28672
    v_mfma_f32_32x32x16_bf16 v[112:127], v[52:55], a[20:23], v[112:127]
    ds_read_b64_tr_b16 v[82:83], v161 offset:29696
    buffer_load_dwordx4 a[88:91], v1, s[20:23], s37 offen offset:2048 sc1
    buffer_load_dwordx4 a[92:95], v1, s[20:23], s37 offen offset:3072 sc1
    v_mfma_f32_32x32x16_bf16 v[128:143], v[56:59], a[20:23], v[128:143]
    ds_read_b64_tr_b16 v[84:85], v162 offset:28672
    ds_read_b64_tr_b16 v[86:87], v163 offset:29696
    v_mfma_f32_32x32x16_bf16 v[144:159], v[60:63], a[20:23], v[144:159]
    ds_read_b64_tr_b16 v[88:89], v164 offset:28672
    ds_read_b64_tr_b16 v[90:91], v165 offset:29696
    s_waitcnt lgkmcnt(6)
    v_mfma_f32_32x32x16_bf16 v[96:111], v[64:67], a[24:27], v[96:111]
    ds_read_b64_tr_b16 v[92:93], v166 offset:28672
    ds_read_b64_tr_b16 v[94:95], v167 offset:29696
    v_mfma_f32_32x32x16_bf16 v[112:127], v[68:71], a[24:27], v[112:127]
    ds_read_b64_tr_b16 v[32:33], v160 offset:32768
    ds_read_b64_tr_b16 v[34:35], v161 offset:33792
    v_mfma_f32_32x32x16_bf16 v[128:143], v[72:75], a[24:27], v[128:143]
    ds_read_b64_tr_b16 v[36:37], v162 offset:32768
    ds_read_b64_tr_b16 v[38:39], v163 offset:33792
    v_mfma_f32_32x32x16_bf16 v[144:159], v[76:79], a[24:27], v[144:159]
    ds_read_b64_tr_b16 v[40:41], v164 offset:32768
    ds_read_b64_tr_b16 v[42:43], v165 offset:33792
    s_waitcnt lgkmcnt(6)
    v_mfma_f32_32x32x16_bf16 v[96:111], v[80:83], a[28:31], v[96:111]
    ds_read_b64_tr_b16 v[44:45], v166 offset:32768
    ds_read_b64_tr_b16 v[46:47], v167 offset:33792
    v_mfma_f32_32x32x16_bf16 v[112:127], v[84:87], a[28:31], v[112:127]
    ds_read_b64_tr_b16 v[48:49], v160 offset:36864
    ds_read_b64_tr_b16 v[50:51], v161 offset:37888
    v_mfma_f32_32x32x16_bf16 v[128:143], v[88:91], a[28:31], v[128:143]
    ds_read_b64_tr_b16 v[52:53], v162 offset:36864
    ds_read_b64_tr_b16 v[54:55], v163 offset:37888
    v_mfma_f32_32x32x16_bf16 v[144:159], v[92:95], a[28:31], v[144:159]
    ds_read_b64_tr_b16 v[56:57], v164 offset:36864
    ds_read_b64_tr_b16 v[58:59], v165 offset:37888
    s_waitcnt vmcnt(12) lgkmcnt(6)
    v_mfma_f32_32x32x16_bf16 v[96:111], v[32:35], a[32:35], v[96:111]
    ds_read_b64_tr_b16 v[60:61], v166 offset:36864
    ds_read_b64_tr_b16 v[62:63], v167 offset:37888
    ds_read_b64_tr_b16 v[64:65], v160 offset:40960
    v_mfma_f32_32x32x16_bf16 v[112:127], v[36:39], a[32:35], v[112:127]
    ds_read_b64_tr_b16 v[66:67], v161 offset:41984
    s_add_u32 s37, s29, 49152
    buffer_load_dwordx4 a[96:99], v1, s[20:23], s37 offen offset:0 sc1
    v_mfma_f32_32x32x16_bf16 v[128:143], v[40:43], a[32:35], v[128:143]
    buffer_load_dwordx4 a[100:103], v1, s[20:23], s37 offen offset:1024 sc1
    ds_read_b64_tr_b16 v[68:69], v162 offset:40960
    ds_read_b64_tr_b16 v[70:71], v163 offset:41984
    v_mfma_f32_32x32x16_bf16 v[144:159], v[44:47], a[32:35], v[144:159]
    ds_read_b64_tr_b16 v[72:73], v164 offset:40960
    ds_read_b64_tr_b16 v[74:75], v165 offset:41984
    s_waitcnt lgkmcnt(6)
    v_mfma_f32_32x32x16_bf16 v[96:111], v[48:51], a[36:39], v[96:111]
    ds_read_b64_tr_b16 v[76:77], v166 offset:40960
    ds_read_b64_tr_b16 v[78:79], v167 offset:41984
    ds_read_b64_tr_b16 v[80:81], v160 offset:45056
    v_mfma_f32_32x32x16_bf16 v[112:127], v[52:55], a[36:39], v[112:127]
    ds_read_b64_tr_b16 v[82:83], v161 offset:46080
    buffer_load_dwordx4 a[104:107], v1, s[20:23], s37 offen offset:2048 sc1
    buffer_load_dwordx4 a[108:111], v1, s[20:23], s37 offen offset:3072 sc1
    v_mfma_f32_32x32x16_bf16 v[128:143], v[56:59], a[36:39], v[128:143]
    ds_read_b64_tr_b16 v[84:85], v162 offset:45056
    ds_read_b64_tr_b16 v[86:87], v163 offset:46080
    v_mfma_f32_32x32x16_bf16 v[144:159], v[60:63], a[36:39], v[144:159]
    ds_read_b64_tr_b16 v[88:89], v164 offset:45056
    ds_read_b64_tr_b16 v[90:91], v165 offset:46080
    s_waitcnt lgkmcnt(6)
    v_mfma_f32_32x32x16_bf16 v[96:111], v[64:67], a[40:43], v[96:111]
    ds_read_b64_tr_b16 v[92:93], v166 offset:45056
    ds_read_b64_tr_b16 v[94:95], v167 offset:46080
    v_mfma_f32_32x32x16_bf16 v[112:127], v[68:71], a[40:43], v[112:127]
    ds_read_b64_tr_b16 v[32:33], v160 offset:49152
    ds_read_b64_tr_b16 v[34:35], v161 offset:50176
    v_mfma_f32_32x32x16_bf16 v[128:143], v[72:75], a[40:43], v[128:143]
    ds_read_b64_tr_b16 v[36:37], v162 offset:49152
    ds_read_b64_tr_b16 v[38:39], v163 offset:50176
    v_mfma_f32_32x32x16_bf16 v[144:159], v[76:79], a[40:43], v[144:159]
    ds_read_b64_tr_b16 v[40:41], v164 offset:49152
    ds_read_b64_tr_b16 v[42:43], v165 offset:50176
    s_waitcnt lgkmcnt(6)
    v_mfma_f32_32x32x16_bf16 v[96:111], v[80:83], a[44:47], v[96:111]
    ds_read_b64_tr_b16 v[44:45], v166 offset:49152
    ds_read_b64_tr_b16 v[46:47], v167 offset:50176
    v_mfma_f32_32x32x16_bf16 v[112:127], v[84:87], a[44:47], v[112:127]
    ds_read_b64_tr_b16 v[48:49], v160 offset:53248
    ds_read_b64_tr_b16 v[50:51], v161 offset:54272
    v_mfma_f32_32x32x16_bf16 v[128:143], v[88:91], a[44:47], v[128:143]
    ds_read_b64_tr_b16 v[52:53], v162 offset:53248
    ds_read_b64_tr_b16 v[54:55], v163 offset:54272
    v_mfma_f32_32x32x16_bf16 v[144:159], v[92:95], a[44:47], v[144:159]
    ds_read_b64_tr_b16 v[56:57], v164 offset:53248
    ds_read_b64_tr_b16 v[58:59], v165 offset:54272
    s_waitcnt vmcnt(12) lgkmcnt(6)
    v_mfma_f32_32x32x16_bf16 v[96:111], v[32:35], a[48:51], v[96:111]
    ds_read_b64_tr_b16 v[60:61], v166 offset:53248
    ds_read_b64_tr_b16 v[62:63], v167 offset:54272
    ds_read_b64_tr_b16 v[64:65], v160 offset:57344
    v_mfma_f32_32x32x16_bf16 v[112:127], v[36:39], a[48:51], v[112:127]
    ds_read_b64_tr_b16 v[66:67], v161 offset:58368
    s_add_u32 s37, s29, 57344
    buffer_load_dwordx4 a[112:115], v1, s[20:23], s37 offen offset:0 sc1
    v_mfma_f32_32x32x16_bf16 v[128:143], v[40:43], a[48:51], v[128:143]
    buffer_load_dwordx4 a[116:119], v1, s[20:23], s37 offen offset:1024 sc1
    ds_read_b64_tr_b16 v[68:69], v162 offset:57344
    ds_read_b64_tr_b16 v[70:71], v163 offset:58368
    v_mfma_f32_32x32x16_bf16 v[144:159], v[44:47], a[48:51], v[144:159]
    ds_read_b64_tr_b16 v[72:73], v164 offset:57344
    ds_read_b64_tr_b16 v[74:75], v165 offset:58368
    s_waitcnt lgkmcnt(6)
    v_mfma_f32_32x32x16_bf16 v[96:111], v[48:51], a[52:55], v[96:111]
    ds_read_b64_tr_b16 v[76:77], v166 offset:57344
    ds_read_b64_tr_b16 v[78:79], v167 offset:58368
    ds_read_b64_tr_b16 v[80:81], v160 offset:61440
    v_mfma_f32_32x32x16_bf16 v[112:127], v[52:55], a[52:55], v[112:127]
    ds_read_b64_tr_b16 v[82:83], v161 offset:62464
    buffer_load_dwordx4 a[120:123], v1, s[20:23], s37 offen offset:2048 sc1
    buffer_load_dwordx4 a[124:127], v1, s[20:23], s37 offen offset:3072 sc1
    v_mfma_f32_32x32x16_bf16 v[128:143], v[56:59], a[52:55], v[128:143]
    ds_read_b64_tr_b16 v[84:85], v162 offset:61440
    ds_read_b64_tr_b16 v[86:87], v163 offset:62464
    v_mfma_f32_32x32x16_bf16 v[144:159], v[60:63], a[52:55], v[144:159]
    ds_read_b64_tr_b16 v[88:89], v164 offset:61440
    ds_read_b64_tr_b16 v[90:91], v165 offset:62464
    s_waitcnt lgkmcnt(6)
    v_mfma_f32_32x32x16_bf16 v[96:111], v[64:67], a[56:59], v[96:111]
    ds_read_b64_tr_b16 v[92:93], v166 offset:61440
    ds_read_b64_tr_b16 v[94:95], v167 offset:62464
    ds_read_b64_tr_b16 v[32:33], v168 offset:0
    v_mfma_f32_32x32x16_bf16 v[112:127], v[68:71], a[56:59], v[112:127]
    s_add_u32 s81, s30, 0
    buffer_load_dwordx4 a[128:131], v252, s[16:19], s81 offen
    buffer_load_dwordx4 a[132:135], v253, s[16:19], s81 offen offset:1024
    v_mfma_f32_32x32x16_bf16 v[128:143], v[72:75], a[56:59], v[128:143]
    ds_read_b64_tr_b16 v[34:35], v169 offset:1024
    ds_read_b64_tr_b16 v[36:37], v170 offset:0
    ds_read_b64_tr_b16 v[38:39], v171 offset:1024
    v_mfma_f32_32x32x16_bf16 v[144:159], v[76:79], a[56:59], v[144:159]
    ds_read_b64_tr_b16 v[40:41], v172 offset:0
    ds_read_b64_tr_b16 v[42:43], v173 offset:1024
    s_waitcnt lgkmcnt(6)
    v_mfma_f32_32x32x16_bf16 v[96:111], v[80:83], a[60:63], v[96:111]
    ds_read_b64_tr_b16 v[44:45], v174 offset:0
    ds_read_b64_tr_b16 v[46:47], v175 offset:1024
    ds_read_b64_tr_b16 v[48:49], v168 offset:4096
    v_mfma_f32_32x32x16_bf16 v[112:127], v[84:87], a[60:63], v[112:127]
    s_add_u32 s81, s30, 32768
    buffer_load_dwordx4 a[136:139], v252, s[16:19], s81 offen
    buffer_load_dwordx4 a[140:143], v253, s[16:19], s81 offen offset:1024
    v_mfma_f32_32x32x16_bf16 v[128:143], v[88:91], a[60:63], v[128:143]
    ds_read_b64_tr_b16 v[50:51], v169 offset:5120
    ds_read_b64_tr_b16 v[52:53], v170 offset:4096
    ds_read_b64_tr_b16 v[54:55], v171 offset:5120
    v_mfma_f32_32x32x16_bf16 v[144:159], v[92:95], a[60:63], v[144:159]
    ds_read_b64_tr_b16 v[56:57], v172 offset:4096
    ds_read_b64_tr_b16 v[58:59], v173 offset:5120
    s_waitcnt vmcnt(16) lgkmcnt(6)
    v_mfma_f32_32x32x16_bf16 v[96:111], v[32:35], a[64:67], v[96:111]
    ds_read_b64_tr_b16 v[60:61], v174 offset:4096
    ds_read_b64_tr_b16 v[62:63], v175 offset:5120
    ds_read_b64_tr_b16 v[64:65], v168 offset:8192
    v_mfma_f32_32x32x16_bf16 v[112:127], v[36:39], a[64:67], v[112:127]
    s_add_u32 s81, s30, 65536
    buffer_load_dwordx4 a[144:147], v252, s[16:19], s81 offen
    buffer_load_dwordx4 a[148:151], v253, s[16:19], s81 offen offset:1024
    v_mfma_f32_32x32x16_bf16 v[128:143], v[40:43], a[64:67], v[128:143]
    ds_read_b64_tr_b16 v[66:67], v169 offset:9216
    ds_read_b64_tr_b16 v[68:69], v170 offset:8192
    ds_read_b64_tr_b16 v[70:71], v171 offset:9216
    v_mfma_f32_32x32x16_bf16 v[144:159], v[44:47], a[64:67], v[144:159]
    ds_read_b64_tr_b16 v[72:73], v172 offset:8192
    ds_read_b64_tr_b16 v[74:75], v173 offset:9216
    s_waitcnt lgkmcnt(6)
    v_mfma_f32_32x32x16_bf16 v[96:111], v[48:51], a[68:71], v[96:111]
    ds_read_b64_tr_b16 v[76:77], v174 offset:8192
    ds_read_b64_tr_b16 v[78:79], v175 offset:9216
    ds_read_b64_tr_b16 v[80:81], v168 offset:12288
    v_mfma_f32_32x32x16_bf16 v[112:127], v[52:55], a[68:71], v[112:127]
    s_add_u32 s81, s30, 98304
    buffer_load_dwordx4 a[152:155], v252, s[16:19], s81 offen
    buffer_load_dwordx4 a[156:159], v253, s[16:19], s81 offen offset:1024
    v_mfma_f32_32x32x16_bf16 v[128:143], v[56:59], a[68:71], v[128:143]
    ds_read_b64_tr_b16 v[82:83], v169 offset:13312
    ds_read_b64_tr_b16 v[84:85], v170 offset:12288
    ds_read_b64_tr_b16 v[86:87], v171 offset:13312
    v_mfma_f32_32x32x16_bf16 v[144:159], v[60:63], a[68:71], v[144:159]
    ds_read_b64_tr_b16 v[88:89], v172 offset:12288
    ds_read_b64_tr_b16 v[90:91], v173 offset:13312
    s_waitcnt lgkmcnt(6)
    v_mfma_f32_32x32x16_bf16 v[96:111], v[64:67], a[72:75], v[96:111]
    ds_read_b64_tr_b16 v[92:93], v174 offset:12288
    ds_read_b64_tr_b16 v[94:95], v175 offset:13312
    ds_read_b64_tr_b16 v[32:33], v168 offset:16384
    v_mfma_f32_32x32x16_bf16 v[112:127], v[68:71], a[72:75], v[112:127]
    s_add_u32 s81, s30, 131072
    buffer_load_dwordx4 a[160:163], v252, s[16:19], s81 offen
    buffer_load_dwordx4 a[164:167], v253, s[16:19], s81 offen offset:1024
    v_mfma_f32_32x32x16_bf16 v[128:143], v[72:75], a[72:75], v[128:143]
    ds_read_b64_tr_b16 v[34:35], v169 offset:17408
    ds_read_b64_tr_b16 v[36:37], v170 offset:16384
    ds_read_b64_tr_b16 v[38:39], v171 offset:17408
    v_mfma_f32_32x32x16_bf16 v[144:159], v[76:79], a[72:75], v[144:159]
    ds_read_b64_tr_b16 v[40:41], v172 offset:16384
    ds_read_b64_tr_b16 v[42:43], v173 offset:17408
    s_waitcnt lgkmcnt(6)
    v_mfma_f32_32x32x16_bf16 v[96:111], v[80:83], a[76:79], v[96:111]
    ds_read_b64_tr_b16 v[44:45], v174 offset:16384
    ds_read_b64_tr_b16 v[46:47], v175 offset:17408
    ds_read_b64_tr_b16 v[48:49], v168 offset:20480
    v_mfma_f32_32x32x16_bf16 v[112:127], v[84:87], a[76:79], v[112:127]
    s_add_u32 s81, s30, 163840
    buffer_load_dwordx4 a[168:171], v252, s[16:19], s81 offen
    buffer_load_dwordx4 a[172:175], v253, s[16:19], s81 offen offset:1024
    v_mfma_f32_32x32x16_bf16 v[128:143], v[88:91], a[76:79], v[128:143]
    ds_read_b64_tr_b16 v[50:51], v169 offset:21504
    ds_read_b64_tr_b16 v[52:53], v170 offset:20480
    ds_read_b64_tr_b16 v[54:55], v171 offset:21504
    v_mfma_f32_32x32x16_bf16 v[144:159], v[92:95], a[76:79], v[144:159]
    ds_read_b64_tr_b16 v[56:57], v172 offset:20480
    ds_read_b64_tr_b16 v[58:59], v173 offset:21504
    s_waitcnt vmcnt(20) lgkmcnt(6)
    v_mfma_f32_32x32x16_bf16 v[96:111], v[32:35], a[80:83], v[96:111]
    ds_read_b64_tr_b16 v[60:61], v174 offset:20480
    ds_read_b64_tr_b16 v[62:63], v175 offset:21504
    ds_read_b64_tr_b16 v[64:65], v168 offset:24576
    v_mfma_f32_32x32x16_bf16 v[112:127], v[36:39], a[80:83], v[112:127]
    s_add_u32 s81, s30, 196608
    buffer_load_dwordx4 a[176:179], v252, s[16:19], s81 offen
    buffer_load_dwordx4 a[180:183], v253, s[16:19], s81 offen offset:1024
    v_mfma_f32_32x32x16_bf16 v[128:143], v[40:43], a[80:83], v[128:143]
    ds_read_b64_tr_b16 v[66:67], v169 offset:25600
    ds_read_b64_tr_b16 v[68:69], v170 offset:24576
    ds_read_b64_tr_b16 v[70:71], v171 offset:25600
    v_mfma_f32_32x32x16_bf16 v[144:159], v[44:47], a[80:83], v[144:159]
    ds_read_b64_tr_b16 v[72:73], v172 offset:24576
    ds_read_b64_tr_b16 v[74:75], v173 offset:25600
    s_waitcnt lgkmcnt(6)
    v_mfma_f32_32x32x16_bf16 v[96:111], v[48:51], a[84:87], v[96:111]
    ds_read_b64_tr_b16 v[76:77], v174 offset:24576
    ds_read_b64_tr_b16 v[78:79], v175 offset:25600
    ds_read_b64_tr_b16 v[80:81], v168 offset:28672
    v_mfma_f32_32x32x16_bf16 v[112:127], v[52:55], a[84:87], v[112:127]
    s_add_u32 s81, s30, 229376
    buffer_load_dwordx4 a[184:187], v252, s[16:19], s81 offen
    buffer_load_dwordx4 a[188:191], v253, s[16:19], s81 offen offset:1024
    v_mfma_f32_32x32x16_bf16 v[128:143], v[56:59], a[84:87], v[128:143]
    ds_read_b64_tr_b16 v[82:83], v169 offset:29696
    ds_read_b64_tr_b16 v[84:85], v170 offset:28672
    ds_read_b64_tr_b16 v[86:87], v171 offset:29696
    v_mfma_f32_32x32x16_bf16 v[144:159], v[60:63], a[84:87], v[144:159]
    ds_read_b64_tr_b16 v[88:89], v172 offset:28672
    ds_read_b64_tr_b16 v[90:91], v173 offset:29696
    s_waitcnt lgkmcnt(6)
    v_mfma_f32_32x32x16_bf16 v[96:111], v[64:67], a[88:91], v[96:111]
    ds_read_b64_tr_b16 v[92:93], v174 offset:28672
    ds_read_b64_tr_b16 v[94:95], v175 offset:29696
    ds_read_b64_tr_b16 v[32:33], v176 offset:0
    v_mfma_f32_32x32x16_bf16 v[112:127], v[68:71], a[88:91], v[112:127]
    s_add_u32 s81, s30, 262144
    buffer_load_dwordx4 a[192:195], v252, s[16:19], s81 offen
    buffer_load_dwordx4 a[196:199], v253, s[16:19], s81 offen offset:1024
    v_mfma_f32_32x32x16_bf16 v[128:143], v[72:75], a[88:91], v[128:143]
    ds_read_b64_tr_b16 v[34:35], v177 offset:1024
    ds_read_b64_tr_b16 v[36:37], v178 offset:0
    ds_read_b64_tr_b16 v[38:39], v179 offset:1024
    v_mfma_f32_32x32x16_bf16 v[144:159], v[76:79], a[88:91], v[144:159]
    ds_read_b64_tr_b16 v[40:41], v180 offset:0
    ds_read_b64_tr_b16 v[42:43], v181 offset:1024
    s_waitcnt lgkmcnt(6)
    v_mfma_f32_32x32x16_bf16 v[96:111], v[80:83], a[92:95], v[96:111]
    ds_read_b64_tr_b16 v[44:45], v182 offset:0
    ds_read_b64_tr_b16 v[46:47], v183 offset:1024
    ds_read_b64_tr_b16 v[48:49], v176 offset:4096
    v_mfma_f32_32x32x16_bf16 v[112:127], v[84:87], a[92:95], v[112:127]
    s_add_u32 s81, s30, 294912
    buffer_load_dwordx4 a[200:203], v252, s[16:19], s81 offen
    buffer_load_dwordx4 a[204:207], v253, s[16:19], s81 offen offset:1024
    v_mfma_f32_32x32x16_bf16 v[128:143], v[88:91], a[92:95], v[128:143]
    ds_read_b64_tr_b16 v[50:51], v177 offset:5120
    ds_read_b64_tr_b16 v[52:53], v178 offset:4096
    ds_read_b64_tr_b16 v[54:55], v179 offset:5120
    v_mfma_f32_32x32x16_bf16 v[144:159], v[92:95], a[92:95], v[144:159]
    ds_read_b64_tr_b16 v[56:57], v180 offset:4096
    ds_read_b64_tr_b16 v[58:59], v181 offset:5120
    s_waitcnt vmcnt(24) lgkmcnt(6)
    v_mfma_f32_32x32x16_bf16 v[96:111], v[32:35], a[96:99], v[96:111]
    ds_read_b64_tr_b16 v[60:61], v182 offset:4096
    ds_read_b64_tr_b16 v[62:63], v183 offset:5120
    ds_read_b64_tr_b16 v[64:65], v176 offset:8192
    v_mfma_f32_32x32x16_bf16 v[112:127], v[36:39], a[96:99], v[112:127]
    s_add_u32 s81, s30, 327680
    buffer_load_dwordx4 a[208:211], v252, s[16:19], s81 offen
    buffer_load_dwordx4 a[212:215], v253, s[16:19], s81 offen offset:1024
    v_mfma_f32_32x32x16_bf16 v[128:143], v[40:43], a[96:99], v[128:143]
    ds_read_b64_tr_b16 v[66:67], v177 offset:9216
    ds_read_b64_tr_b16 v[68:69], v178 offset:8192
    ds_read_b64_tr_b16 v[70:71], v179 offset:9216
    v_mfma_f32_32x32x16_bf16 v[144:159], v[44:47], a[96:99], v[144:159]
    ds_read_b64_tr_b16 v[72:73], v180 offset:8192
    ds_read_b64_tr_b16 v[74:75], v181 offset:9216
    s_waitcnt lgkmcnt(6)
    v_mfma_f32_32x32x16_bf16 v[96:111], v[48:51], a[100:103], v[96:111]
    ds_read_b64_tr_b16 v[76:77], v182 offset:8192
    ds_read_b64_tr_b16 v[78:79], v183 offset:9216
    ds_read_b64_tr_b16 v[80:81], v176 offset:12288
    v_mfma_f32_32x32x16_bf16 v[112:127], v[52:55], a[100:103], v[112:127]
    s_add_u32 s81, s30, 360448
    buffer_load_dwordx4 a[216:219], v252, s[16:19], s81 offen
    buffer_load_dwordx4 a[220:223], v253, s[16:19], s81 offen offset:1024
    v_mfma_f32_32x32x16_bf16 v[128:143], v[56:59], a[100:103], v[128:143]
    ds_read_b64_tr_b16 v[82:83], v177 offset:13312
    ds_read_b64_tr_b16 v[84:85], v178 offset:12288
    ds_read_b64_tr_b16 v[86:87], v179 offset:13312
    v_mfma_f32_32x32x16_bf16 v[144:159], v[60:63], a[100:103], v[144:159]
    ds_read_b64_tr_b16 v[88:89], v180 offset:12288
    ds_read_b64_tr_b16 v[90:91], v181 offset:13312
    s_waitcnt lgkmcnt(6)
    v_mfma_f32_32x32x16_bf16 v[96:111], v[64:67], a[104:107], v[96:111]
    ds_read_b64_tr_b16 v[92:93], v182 offset:12288
    ds_read_b64_tr_b16 v[94:95], v183 offset:13312
    ds_read_b64_tr_b16 v[32:33], v176 offset:16384
    v_mfma_f32_32x32x16_bf16 v[112:127], v[68:71], a[104:107], v[112:127]
    s_add_u32 s81, s30, 393216
    buffer_load_dwordx4 a[224:227], v252, s[16:19], s81 offen
    buffer_load_dwordx4 a[228:231], v253, s[16:19], s81 offen offset:1024
    v_mfma_f32_32x32x16_bf16 v[128:143], v[72:75], a[104:107], v[128:143]
    ds_read_b64_tr_b16 v[34:35], v177 offset:17408
    ds_read_b64_tr_b16 v[36:37], v178 offset:16384
    ds_read_b64_tr_b16 v[38:39], v179 offset:17408
    v_mfma_f32_32x32x16_bf16 v[144:159], v[76:79], a[104:107], v[144:159]
    ds_read_b64_tr_b16 v[40:41], v180 offset:16384
    ds_read_b64_tr_b16 v[42:43], v181 offset:17408
    s_waitcnt lgkmcnt(6)
    v_mfma_f32_32x32x16_bf16 v[96:111], v[80:83], a[108:111], v[96:111]
    ds_read_b64_tr_b16 v[44:45], v182 offset:16384
    ds_read_b64_tr_b16 v[46:47], v183 offset:17408
    ds_read_b64_tr_b16 v[48:49], v176 offset:20480
    v_mfma_f32_32x32x16_bf16 v[112:127], v[84:87], a[108:111], v[112:127]
    s_add_u32 s81, s30, 425984
    buffer_load_dwordx4 a[232:235], v252, s[16:19], s81 offen
    buffer_load_dwordx4 a[236:239], v253, s[16:19], s81 offen offset:1024
    v_mfma_f32_32x32x16_bf16 v[128:143], v[88:91], a[108:111], v[128:143]
    ds_read_b64_tr_b16 v[50:51], v177 offset:21504
    ds_read_b64_tr_b16 v[52:53], v178 offset:20480
    ds_read_b64_tr_b16 v[54:55], v179 offset:21504
    v_mfma_f32_32x32x16_bf16 v[144:159], v[92:95], a[108:111], v[144:159]
    ds_read_b64_tr_b16 v[56:57], v180 offset:20480
    ds_read_b64_tr_b16 v[58:59], v181 offset:21504
    s_waitcnt vmcnt(28) lgkmcnt(6)
    v_mfma_f32_32x32x16_bf16 v[96:111], v[32:35], a[112:115], v[96:111]
    ds_read_b64_tr_b16 v[60:61], v182 offset:20480
    ds_read_b64_tr_b16 v[62:63], v183 offset:21504
    ds_read_b64_tr_b16 v[64:65], v176 offset:24576
    v_mfma_f32_32x32x16_bf16 v[112:127], v[36:39], a[112:115], v[112:127]
    s_add_u32 s81, s30, 458752
    buffer_load_dwordx4 a[240:243], v252, s[16:19], s81 offen
    buffer_load_dwordx4 a[244:247], v253, s[16:19], s81 offen offset:1024
    v_mfma_f32_32x32x16_bf16 v[128:143], v[40:43], a[112:115], v[128:143]
    ds_read_b64_tr_b16 v[66:67], v177 offset:25600
    ds_read_b64_tr_b16 v[68:69], v178 offset:24576
    ds_read_b64_tr_b16 v[70:71], v179 offset:25600
    v_mfma_f32_32x32x16_bf16 v[144:159], v[44:47], a[112:115], v[144:159]
    ds_read_b64_tr_b16 v[72:73], v180 offset:24576
    ds_read_b64_tr_b16 v[74:75], v181 offset:25600
    s_waitcnt lgkmcnt(6)
    v_mfma_f32_32x32x16_bf16 v[96:111], v[48:51], a[116:119], v[96:111]
    ds_read_b64_tr_b16 v[76:77], v182 offset:24576
    ds_read_b64_tr_b16 v[78:79], v183 offset:25600
    ds_read_b64_tr_b16 v[80:81], v176 offset:28672
    v_mfma_f32_32x32x16_bf16 v[112:127], v[52:55], a[116:119], v[112:127]
    s_add_u32 s81, s30, 491520
    buffer_load_dwordx4 a[248:251], v252, s[16:19], s81 offen
    buffer_load_dwordx4 a[252:255], v253, s[16:19], s81 offen offset:1024
    v_mfma_f32_32x32x16_bf16 v[128:143], v[56:59], a[116:119], v[128:143]
    ds_read_b64_tr_b16 v[82:83], v177 offset:29696
    ds_read_b64_tr_b16 v[84:85], v178 offset:28672
    ds_read_b64_tr_b16 v[86:87], v179 offset:29696
    v_mfma_f32_32x32x16_bf16 v[144:159], v[60:63], a[116:119], v[144:159]
    ds_read_b64_tr_b16 v[88:89], v180 offset:28672
    ds_read_b64_tr_b16 v[90:91], v181 offset:29696
    s_waitcnt lgkmcnt(6)
    v_mfma_f32_32x32x16_bf16 v[96:111], v[64:67], a[120:123], v[96:111]
    ds_read_b64_tr_b16 v[92:93], v182 offset:28672
    v_mfma_f32_32x32x16_bf16 v[112:127], v[68:71], a[120:123], v[112:127]
    v_mfma_f32_32x32x16_bf16 v[128:143], v[72:75], a[120:123], v[128:143]
    ds_read_b64_tr_b16 v[94:95], v183 offset:29696
    v_mfma_f32_32x32x16_bf16 v[144:159], v[76:79], a[120:123], v[144:159]
    s_waitcnt lgkmcnt(0)
    v_mfma_f32_32x32x16_bf16 v[96:111], v[80:83], a[124:127], v[96:111]
    v_mfma_f32_32x32x16_bf16 v[112:127], v[84:87], a[124:127], v[112:127]
    v_mfma_f32_32x32x16_bf16 v[128:143], v[88:91], a[124:127], v[128:143]
    v_mfma_f32_32x32x16_bf16 v[144:159], v[92:95], a[124:127], v[144:159]
L_gdone_a:
    s_lshl_b32 s59, s60, 3
    s_add_u32 s59, s59, s3
    s_lshl_b32 s59, s59, 15
    s_lshl_b32 s62, s24, 13
    s_add_u32 s59, s59, s62
    s_add_u32 s59, s59, 8388608
    s_add_u32 s62, s59, 4096
    s_nop 7
    v_cvt_pk_bf16_f32 v192, v96, v97
    v_cvt_pk_bf16_f32 v193, v98, v99
    v_cvt_pk_bf16_f32 v194, v100, v101
    v_cvt_pk_bf16_f32 v195, v102, v103
    buffer_store_dwordx4 v[192:195], v1, s[20:23], s59 offen offset:0 sc1
    v_cvt_pk_bf16_f32 v196, v104, v105
    v_cvt_pk_bf16_f32 v197, v106, v107
    v_cvt_pk_bf16_f32 v198, v108, v109
    v_cvt_pk_bf16_f32 v199, v110, v111
    buffer_store_dwordx4 v[196:199], v1, s[20:23], s59 offen offset:1024 sc1
    v_cvt_pk_bf16_f32 v200, v112, v113
    v_cvt_pk_bf16_f32 v201, v114, v115
    v_cvt_pk_bf16_f32 v202, v116, v117
    v_cvt_pk_bf16_f32 v203, v118, v119
    buffer_store_dwordx4 v[200:203], v1, s[20:23], s59 offen offset:2048 sc1
    v_cvt_pk_bf16_f32 v204, v120, v121
    v_cvt_pk_bf16_f32 v205, v122, v123
    v_cvt_pk_bf16_f32 v206, v124, v125
    v_cvt_pk_bf16_f32 v207, v126, v127
    buffer_store_dwordx4 v[204:207], v1, s[20:23], s59 offen offset:3072 sc1
    v_cvt_pk_bf16_f32 v208, v128, v129
    v_cvt_pk_bf16_f32 v209, v130, v131
    v_cvt_pk_bf16_f32 v210, v132, v133
    v_cvt_pk_bf16_f32 v211, v134, v135
    buffer_store_dwordx4 v[208:211], v1, s[20:23], s62 offen offset:0 sc1
    v_cvt_pk_bf16_f32 v212, v136, v137
    v_cvt_pk_bf16_f32 v213, v138, v139
    v_cvt_pk_bf16_f32 v214, v140, v141
    v_cvt_pk_bf16_f32 v215, v142, v143
    buffer_store_dwordx4 v[212:215], v1, s[20:23], s62 offen offset:1024 sc1
    v_cvt_pk_bf16_f32 v216, v144, v145
    v_cvt_pk_bf16_f32 v217, v146, v147
    v_cvt_pk_bf16_f32 v218, v148, v149
    v_cvt_pk_bf16_f32 v219, v150, v151
    buffer_store_dwordx4 v[216:219], v1, s[20:23], s62 offen offset:2048 sc1
    v_cvt_pk_bf16_f32 v220, v152, v153
    v_cvt_pk_bf16_f32 v221, v154, v155
    v_cvt_pk_bf16_f32 v222, v156, v157
    v_cvt_pk_bf16_f32 v223, v158, v159
    buffer_store_dwordx4 v[220:223], v1, s[20:23], s62 offen offset:3072 sc1
    s_lshl_b32 s63, s60, 2
    s_add_u32 s63, s63, s24
    s_lshl_b32 s63, s63, 3
    s_add_u32 s63, s63, s3
    s_lshl_b32 s63, s63, 3
    s_add_u32 s63, s63, 25174016
    s_barrier
    v_add_u32 v4, 131072, v2
    s_waitcnt vmcnt(8)
    ds_write_b128 v2, a[128:131] offset:0
    ds_write_b128 v2, a[132:135] offset:1024
    ds_write_b128 v2, a[136:139] offset:8192
    ds_write_b128 v2, a[140:143] offset:9216
    ds_write_b128 v2, a[144:147] offset:16384
    ds_write_b128 v2, a[148:151] offset:17408
    ds_write_b128 v2, a[152:155] offset:24576
    ds_write_b128 v2, a[156:159] offset:25600
    s_waitcnt lgkmcnt(4)
    ds_write_b128 v2, a[160:163] offset:32768
    ds_write_b128 v2, a[164:167] offset:33792
    ds_write_b128 v2, a[168:171] offset:40960
    ds_write_b128 v2, a[172:175] offset:41984
    ds_write_b128 v2, a[176:179] offset:49152
    ds_write_b128 v2, a[180:183] offset:50176
    ds_write_b128 v2, a[184:187] offset:57344
    ds_write_b128 v2, a[188:191] offset:58368
    s_waitcnt lgkmcnt(4)
    ds_write_b128 v3, a[192:195] offset:0
    ds_write_b128 v3, a[196:199] offset:1024
    ds_write_b128 v3, a[200:203] offset:8192
    ds_write_b128 v3, a[204:207] offset:9216
    ds_write_b128 v3, a[208:211] offset:16384
    ds_write_b128 v3, a[212:215] offset:17408
    ds_write_b128 v3, a[216:219] offset:24576
    ds_write_b128 v3, a[220:223] offset:25600
    s_waitcnt lgkmcnt(4)
    ds_write_b128 v4, a[224:227] offset:0
    ds_write_b128 v4, a[228:231] offset:1024
    ds_write_b128 v4, a[232:235] offset:8192
    ds_write_b128 v4, a[236:239] offset:9216
    ds_write_b128 v4, a[240:243] offset:16384
    ds_write_b128 v4, a[244:247] offset:17408
    ds_write_b128 v4, a[248:251] offset:24576
    ds_write_b128 v4, a[252:255] offset:25600
    s_waitcnt lgkmcnt(4)
    s_waitcnt vmcnt(0)
    v_mov_b32 v246, 0
    s_mov_b64 exec, 1
    buffer_store_dwordx2 v[244:245], v246, s[20:23], s63 offen sc1
    s_mov_b64 exec, -1
    s_and_b32 s60, s45, 15
    s_add_u32 s60, s60, 16
    s_lshl_b32 s61, s77, 1
    s_add_u32 s61, s61, s46
    s_add_u32 s61, s61, 8
    s_lshl_b32 s61, s61, 3
    s_add_u32 s61, s61, s3
    s_lshl_b32 s61, s61, 3
    s_lshl_b32 s29, s61, 13
    s_lshl_b32 s59, s47, 12
    s_add_u32 s29, s29, s59
    s_lshl_b32 s61, s61, 3
    s_add_u32 s61, s61, 25165824
    s_mov_b32 s85, 0
    s_mov_b32 s83, 0xff
    v_mov_b32 v32, 0
    v_mov_b32 v33, 0
    v_mov_b32 v34, 0
    v_mov_b32 v35, 0
    s_nop 1
    v_mfma_f32_32x32x16_bf16 v[96:111], v[32:35], v[32:35], 0
    v_mfma_f32_32x32x16_bf16 v[112:127], v[32:35], v[32:35], 0
    v_mfma_f32_32x32x16_bf16 v[128:143], v[32:35], v[32:35], 0
    v_mfma_f32_32x32x16_bf16 v[144:159], v[32:35], v[32:35], 0
    s_waitcnt lgkmcnt(0)
    s_barrier
L_ground_b:
    buffer_load_dwordx2 v[248:249], v11, s[20:23], s61 offen sc1
L_gchk_b:
    s_add_u32 s85, s85, 1
    s_waitcnt vmcnt(0)
    v_cmp_eq_u64 vcc, v[248:249], v[244:245]
    s_cmp_ge_u32 s85, 4000000
    s_cselect_b32 s82, 0xff, vcc_lo
    s_and_b32 s82, s82, s83
    s_cbranch_scc1 L_gwork_b
    s_sleep 8
    s_branch L_ground_b
L_gwork_b:
    s_cmp_eq_u32 s82, 0xff
    s_cbranch_scc1 L_gfast_b
    s_bitcmp1_b32 s82, 0
    s_cbranch_scc0 L_gl0_b
    s_add_u32 s37, s29, 0
    buffer_load_dwordx4 a[0:3], v1, s[20:23], s37 offen offset:0 sc1
    buffer_load_dwordx4 a[4:7], v1, s[20:23], s37 offen offset:1024 sc1
    buffer_load_dwordx4 a[8:11], v1, s[20:23], s37 offen offset:2048 sc1
    buffer_load_dwordx4 a[12:15], v1, s[20:23], s37 offen offset:3072 sc1
L_gl0_b:
    s_bitcmp1_b32 s82, 1
    s_cbranch_scc0 L_gl1_b
    s_add_u32 s37, s29, 8192
    buffer_load_dwordx4 a[16:19], v1, s[20:23], s37 offen offset:0 sc1
    buffer_load_dwordx4 a[20:23], v1, s[20:23], s37 offen offset:1024 sc1
    buffer_load_dwordx4 a[24:27], v1, s[20:23], s37 offen offset:2048 sc1
    buffer_load_dwordx4 a[28:31], v1, s[20:23], s37 offen offset:3072 sc1
L_gl1_b:
    s_bitcmp1_b32 s82, 2
    s_cbranch_scc0 L_gl2_b
    s_add_u32 s37, s29, 16384
    buffer_load_dwordx4 a[32:35], v1, s[20:23], s37 offen offset:0 sc1
    buffer_load_dwordx4 a[36:39], v1, s[20:23], s37 offen offset:1024 sc1
    buffer_load_dwordx4 a[40:43], v1, s[20:23], s37 offen offset:2048 sc1
    buffer_load_dwordx4 a[44:47], v1, s[20:23], s37 offen offset:3072 sc1
L_gl2_b:
    s_bitcmp1_b32 s82, 3
    s_cbranch_scc0 L_gl3_b
    s_add_u32 s37, s29, 24576
    buffer_load_dwordx4 a[48:51], v1, s[20:23], s37 offen offset:0 sc1
    buffer_load_dwordx4 a[52:55], v1, s[20:23], s37 offen offset:1024 sc1
    buffer_load_dwordx4 a[56:59], v1, s[20:23], s37 offen offset:2048 sc1
    buffer_load_dwordx4 a[60:63], v1, s[20:23], s37 offen offset:3072 sc1
L_gl3_b:
    s_bitcmp1_b32 s82, 4
    s_cbranch_scc0 L_gl4_b
    s_add_u32 s37, s29, 32768
    buffer_load_dwordx4 a[64:67], v1, s[20:23], s37 offen offset:0 sc1
    buffer_load_dwordx4 a[68:71], v1, s[20:23], s37 offen offset:1024 sc1
    buffer_load_dwordx4 a[72:75], v1, s[20:23], s37 offen offset:2048 sc1
    buffer_load_dwordx4 a[76:79], v1, s[20:23], s37 offen offset:3072 sc1
L_gl4_b:
    s_bitcmp1_b32 s82, 5
    s_cbranch_scc0 L_gl5_b
    s_add_u32 s37, s29, 40960
    buffer_load_dwordx4 a[80:83], v1, s[20:23], s37 offen offset:0 sc1
    buffer_load_dwordx4 a[84:87], v1, s[20:23], s37 offen offset:1024 sc1
    buffer_load_dwordx4 a[88:91], v1, s[20:23], s37 offen offset:2048 sc1
    buffer_load_dwordx4 a[92:95], v1, s[20:23], s37 offen offset:3072 sc1
L_gl5_b:
    s_bitcmp1_b32 s82, 6
    s_cbranch_scc0 L_gl6_b
    s_add_u32 s37, s29, 49152
    buffer_load_dwordx4 a[96:99], v1, s[20:23], s37 offen offset:0 sc1
    buffer_load_dwordx4 a[100:103], v1, s[20:23], s37 offen offset:1024 sc1
    buffer_load_dwordx4 a[104:107], v1, s[20:23], s37 offen offset:2048 sc1
    buffer_load_dwordx4 a[108:111], v1, s[20:23], s37 offen offset:3072 sc1
L_gl6_b:
    s_bitcmp1_b32 s82, 7
    s_cbranch_scc0 L_gl7_b
    s_add_u32 s37, s29, 57344
    buffer_load_dwordx4 a[112:115], v1, s[20:23], s37 offen offset:0 sc1
    buffer_load_dwordx4 a[116:119], v1, s[20:23], s37 offen offset:1024 sc1
    buffer_load_dwordx4 a[120:123], v1, s[20:23], s37 offen offset:2048 sc1
    buffer_load_dwordx4 a[124:127], v1, s[20:23], s37 offen offset:3072 sc1
L_gl7_b:
    s_waitcnt vmcnt(0)
    buffer_load_dwordx2 v[248:249], v11, s[20:23], s61 offen sc1
    s_bitcmp1_b32 s82, 0
    s_cbranch_scc0 L_gm0_b
    ds_read_b64_tr_b16 v[32:33], v160 offset:0
    ds_read_b64_tr_b16 v[34:35], v161 offset:1024
    ds_read_b64_tr_b16 v[36:37], v162 offset:0
    ds_read_b64_tr_b16 v[38:39], v163 offset:1024
    ds_read_b64_tr_b16 v[40:41], v164 offset:0
    ds_read_b64_tr_b16 v[42:43], v165 offset:1024
    ds_read_b64_tr_b16 v[44:45], v166 offset:0
    ds_read_b64_tr_b16 v[46:47], v167 offset:1024
    ds_read_b64_tr_b16 v[48:49], v160 offset:4096
    ds_read_b64_tr_b16 v[50:51], v161 offset:5120
    ds_read_b64_tr_b16 v[52:53], v162 offset:4096
    ds_read_b64_tr_b16 v[54:55], v163 offset:5120
    ds_read_b64_tr_b16 v[56:57], v164 offset:4096
    ds_read_b64_tr_b16 v[58:59], v165 offset:5120
    s_waitcnt lgkmcnt(6)
    v_mfma_f32_32x32x16_bf16 v[96:111], v[32:35], a[0:3], v[96:111]
    ds_read_b64_tr_b16 v[60:61], v166 offset:4096
    ds_read_b64_tr_b16 v[62:63], v167 offset:5120
    v_mfma_f32_32x32x16_bf16 v[112:127], v[36:39], a[0:3], v[112:127]
    ds_read_b64_tr_b16 v[64:65], v160 offset:8192
    ds_read_b64_tr_b16 v[66:67], v161 offset:9216
    v_mfma_f32_32x32x16_bf16 v[128:143], v[40:43], a[0:3], v[128:143]
    ds_read_b64_tr_b16 v[68:69], v162 offset:8192
    ds_read_b64_tr_b16 v[70:71], v163 offset:9216
    v_mfma_f32_32x32x16_bf16 v[144:159], v[44:47], a[0:3], v[144:159]
    ds_read_b64_tr_b16 v[72:73], v164 offset:8192
    ds_read_b64_tr_b16 v[74:75], v165 offset:9216
    s_waitcnt lgkmcnt(6)
    v_mfma_f32_32x32x16_bf16 v[96:111], v[48:51], a[4:7], v[96:111]
    ds_read_b64_tr_b16 v[76:77], v166 offset:8192
    ds_read_b64_tr_b16 v[78:79], v167 offset:9216
    v_mfma_f32_32x32x16_bf16 v[112:127], v[52:55], a[4:7], v[112:127]
    ds_read_b64_tr_b16 v[80:81], v160 offset:12288
    ds_read_b64_tr_b16 v[82:83], v161 offset:13312
    v_mfma_f32_32x32x16_bf16 v[128:143], v[56:59], a[4:7], v[128:143]
    ds_read_b64_tr_b16 v[84:85], v162 offset:12288
    ds_read_b64_tr_b16 v[86:87], v163 offset:13312
    v_mfma_f32_32x32x16_bf16 v[144:159], v[60:63], a[4:7], v[144:159]
    ds_read_b64_tr_b16 v[88:89], v164 offset:12288
    ds_read_b64_tr_b16 v[90:91], v165 offset:13312
    s_waitcnt lgkmcnt(6)
    v_mfma_f32_32x32x16_bf16 v[96:111], v[64:67], a[8:11], v[96:111]
    ds_read_b64_tr_b16 v[92:93], v166 offset:12288
    v_mfma_f32_32x32x16_bf16 v[112:127], v[68:71], a[8:11], v[112:127]
    v_mfma_f32_32x32x16_bf16 v[128:143], v[72:75], a[8:11], v[128:143]
    ds_read_b64_tr_b16 v[94:95], v167 offset:13312
    v_mfma_f32_32x32x16_bf16 v[144:159], v[76:79], a[8:11], v[144:159]
    s_waitcnt lgkmcnt(0)
    v_mfma_f32_32x32x16_bf16 v[96:111], v[80:83], a[12:15], v[96:111]
    v_mfma_f32_32x32x16_bf16 v[112:127], v[84:87], a[12:15], v[112:127]
    v_mfma_f32_32x32x16_bf16 v[128:143], v[88:91], a[12:15], v[128:143]
    v_mfma_f32_32x32x16_bf16 v[144:159], v[92:95], a[12:15], v[144:159]
L_gm0_b:
    s_bitcmp1_b32 s82, 1
    s_cbranch_scc0 L_gm1_b
    ds_read_b64_tr_b16 v[32:33], v160 offset:16384
    ds_read_b64_tr_b16 v[34:35], v161 offset:17408
    ds_read_b64_tr_b16 v[36:37], v162 offset:16384
    ds_read_b64_tr_b16 v[38:39], v163 offset:17408
    ds_read_b64_tr_b16 v[40:41], v164 offset:16384
    ds_read_b64_tr_b16 v[42:43], v165 offset:17408
    ds_read_b64_tr_b16 v[44:45], v166 offset:16384
    ds_read_b64_tr_b16 v[46:47], v167 offset:17408
    ds_read_b64_tr_b16 v[48:49], v160 offset:20480
    ds_read_b64_tr_b16 v[50:51], v161 offset:21504
    ds_read_b64_tr_b16 v[52:53], v162 offset:20480
    ds_read_b64_tr_b16 v[54:55], v163 offset:21504
    ds_read_b64_tr_b16 v[56:57], v164 offset:20480
    ds_read_b64_tr_b16 v[58:59], v165 offset:21504
    s_waitcnt lgkmcnt(6)
    v_mfma_f32_32x32x16_bf16 v[96:111], v[32:35], a[16:19], v[96:111]
    ds_read_b64_tr_b16 v[60:61], v166 offset:20480
    ds_read_b64_tr_b16 v[62:63], v167 offset:21504
    v_mfma_f32_32x32x16_bf16 v[112:127], v[36:39], a[16:19], v[112:127]
    ds_read_b64_tr_b16 v[64:65], v160 offset:24576
    ds_read_b64_tr_b16 v[66:67], v161 offset:25600
    v_mfma_f32_32x32x16_bf16 v[128:143], v[40:43], a[16:19], v[128:143]
    ds_read_b64_tr_b16 v[68:69], v162 offset:24576
    ds_read_b64_tr_b16 v[70:71], v163 offset:25600
    v_mfma_f32_32x32x16_bf16 v[144:159], v[44:47], a[16:19], v[144:159]
    ds_read_b64_tr_b16 v[72:73], v164 offset:24576
    ds_read_b64_tr_b16 v[74:75], v165 offset:25600
    s_waitcnt lgkmcnt(6)
    v_mfma_f32_32x32x16_bf16 v[96:111], v[48:51], a[20:23], v[96:111]
    ds_read_b64_tr_b16 v[76:77], v166 offset:24576
    ds_read_b64_tr_b16 v[78:79], v167 offset:25600
    v_mfma_f32_32x32x16_bf16 v[112:127], v[52:55], a[20:23], v[112:127]
    ds_read_b64_tr_b16 v[80:81], v160 offset:28672
    ds_read_b64_tr_b16 v[82:83], v161 offset:29696
    v_mfma_f32_32x32x16_bf16 v[128:143], v[56:59], a[20:23], v[128:143]
    ds_read_b64_tr_b16 v[84:85], v162 offset:28672
    ds_read_b64_tr_b16 v[86:87], v163 offset:29696
    v_mfma_f32_32x32x16_bf16 v[144:159], v[60:63], a[20:23], v[144:159]
    ds_read_b64_tr_b16 v[88:89], v164 offset:28672
    ds_read_b64_tr_b16 v[90:91], v165 offset:29696
    s_waitcnt lgkmcnt(6)
    v_mfma_f32_32x32x16_bf16 v[96:111], v[64:67], a[24:27], v[96:111]
    ds_read_b64_tr_b16 v[92:93], v166 offset:28672
    v_mfma_f32_32x32x16_bf16 v[112:127], v[68:71], a[24:27], v[112:127]
    v_mfma_f32_32x32x16_bf16 v[128:143], v[72:75], a[24:27], v[128:143]
    ds_read_b64_tr_b16 v[94:95], v167 offset:29696
    v_mfma_f32_32x32x16_bf16 v[144:159], v[76:79], a[24:27], v[144:159]
    s_waitcnt lgkmcnt(0)
    v_mfma_f32_32x32x16_bf16 v[96:111], v[80:83], a[28:31], v[96:111]
    v_mfma_f32_32x32x16_bf16 v[112:127], v[84:87], a[28:31], v[112:127]
    v_mfma_f32_32x32x16_bf16 v[128:143], v[88:91], a[28:31], v[128:143]
    v_mfma_f32_32x32x16_bf16 v[144:159], v[92:95], a[28:31], v[144:159]
L_gm1_b:
    s_bitcmp1_b32 s82, 2
    s_cbranch_scc0 L_gm2_b
    ds_read_b64_tr_b16 v[32:33], v160 offset:32768
    ds_read_b64_tr_b16 v[34:35], v161 offset:33792
    ds_read_b64_tr_b16 v[36:37], v162 offset:32768
    ds_read_b64_tr_b16 v[38:39], v163 offset:33792
    ds_read_b64_tr_b16 v[40:41], v164 offset:32768
    ds_read_b64_tr_b16 v[42:43], v165 offset:33792
    ds_read_b64_tr_b16 v[44:45], v166 offset:32768
    ds_read_b64_tr_b16 v[46:47], v167 offset:33792
    ds_read_b64_tr_b16 v[48:49], v160 offset:36864
    ds_read_b64_tr_b16 v[50:51], v161 offset:37888
    ds_read_b64_tr_b16 v[52:53], v162 offset:36864
    ds_read_b64_tr_b16 v[54:55], v163 offset:37888
    ds_read_b64_tr_b16 v[56:57], v164 offset:36864
    ds_read_b64_tr_b16 v[58:59], v165 offset:37888
    s_waitcnt lgkmcnt(6)
    v_mfma_f32_32x32x16_bf16 v[96:111], v[32:35], a[32:35], v[96:111]
    ds_read_b64_tr_b16 v[60:61], v166 offset:36864
    ds_read_b64_tr_b16 v[62:63], v167 offset:37888
    v_mfma_f32_32x32x16_bf16 v[112:127], v[36:39], a[32:35], v[112:127]
    ds_read_b64_tr_b16 v[64:65], v160 offset:40960
    ds_read_b64_tr_b16 v[66:67], v161 offset:41984
    v_mfma_f32_32x32x16_bf16 v[128:143], v[40:43], a[32:35], v[128:143]
    ds_read_b64_tr_b16 v[68:69], v162 offset:40960
    ds_read_b64_tr_b16 v[70:71], v163 offset:41984
    v_mfma_f32_32x32x16_bf16 v[144:159], v[44:47], a[32:35], v[144:159]
    ds_read_b64_tr_b16 v[72:73], v164 offset:40960
    ds_read_b64_tr_b16 v[74:75], v165 offset:41984
    s_waitcnt lgkmcnt(6)
    v_mfma_f32_32x32x16_bf16 v[96:111], v[48:51], a[36:39], v[96:111]
    ds_read_b64_tr_b16 v[76:77], v166 offset:40960
    ds_read_b64_tr_b16 v[78:79], v167 offset:41984
    v_mfma_f32_32x32x16_bf16 v[112:127], v[52:55], a[36:39], v[112:127]
    ds_read_b64_tr_b16 v[80:81], v160 offset:45056
    ds_read_b64_tr_b16 v[82:83], v161 offset:46080
    v_mfma_f32_32x32x16_bf16 v[128:143], v[56:59], a[36:39], v[128:143]
    ds_read_b64_tr_b16 v[84:85], v162 offset:45056
    ds_read_b64_tr_b16 v[86:87], v163 offset:46080
    v_mfma_f32_32x32x16_bf16 v[144:159], v[60:63], a[36:39], v[144:159]
    ds_read_b64_tr_b16 v[88:89], v164 offset:45056
    ds_read_b64_tr_b16 v[90:91], v165 offset:46080
    s_waitcnt lgkmcnt(6)
    v_mfma_f32_32x32x16_bf16 v[96:111], v[64:67], a[40:43], v[96:111]
    ds_read_b64_tr_b16 v[92:93], v166 offset:45056
    v_mfma_f32_32x32x16_bf16 v[112:127], v[68:71], a[40:43], v[112:127]
    v_mfma_f32_32x32x16_bf16 v[128:143], v[72:75], a[40:43], v[128:143]
    ds_read_b64_tr_b16 v[94:95], v167 offset:46080
    v_mfma_f32_32x32x16_bf16 v[144:159], v[76:79], a[40:43], v[144:159]
    s_waitcnt lgkmcnt(0)
    v_mfma_f32_32x32x16_bf16 v[96:111], v[80:83], a[44:47], v[96:111]
    v_mfma_f32_32x32x16_bf16 v[112:127], v[84:87], a[44:47], v[112:127]
    v_mfma_f32_32x32x16_bf16 v[128:143], v[88:91], a[44:47], v[128:143]
    v_mfma_f32_32x32x16_bf16 v[144:159], v[92:95], a[44:47], v[144:159]
L_gm2_b:
    s_bitcmp1_b32 s82, 3
    s_cbranch_scc0 L_gm3_b
    ds_read_b64_tr_b16 v[32:33], v160 offset:49152
    ds_read_b64_tr_b16 v[34:35], v161 offset:50176
    ds_read_b64_tr_b16 v[36:37], v162 offset:49152
    ds_read_b64_tr_b16 v[38:39], v163 offset:50176
    ds_read_b64_tr_b16 v[40:41], v164 offset:49152
    ds_read_b64_tr_b16 v[42:43], v165 offset:50176
    ds_read_b64_tr_b16 v[44:45], v166 offset:49152
    ds_read_b64_tr_b16 v[46:47], v167 offset:50176
    ds_read_b64_tr_b16 v[48:49], v160 offset:53248
    ds_read_b64_tr_b16 v[50:51], v161 offset:54272
    ds_read_b64_tr_b16 v[52:53], v162 offset:53248
    ds_read_b64_tr_b16 v[54:55], v163 offset:54272
    ds_read_b64_tr_b16 v[56:57], v164 offset:53248
    ds_read_b64_tr_b16 v[58:59], v165 offset:54272
    s_waitcnt lgkmcnt(6)
    v_mfma_f32_32x32x16_bf16 v[96:111], v[32:35], a[48:51], v[96:111]
    ds_read_b64_tr_b16 v[60:61], v166 offset:53248
    ds_read_b64_tr_b16 v[62:63], v167 offset:54272
    v_mfma_f32_32x32x16_bf16 v[112:127], v[36:39], a[48:51], v[112:127]
    ds_read_b64_tr_b16 v[64:65], v160 offset:57344
    ds_read_b64_tr_b16 v[66:67], v161 offset:58368
    v_mfma_f32_32x32x16_bf16 v[128:143], v[40:43], a[48:51], v[128:143]
    ds_read_b64_tr_b16 v[68:69], v162 offset:57344
    ds_read_b64_tr_b16 v[70:71], v163 offset:58368
    v_mfma_f32_32x32x16_bf16 v[144:159], v[44:47], a[48:51], v[144:159]
    ds_read_b64_tr_b16 v[72:73], v164 offset:57344
    ds_read_b64_tr_b16 v[74:75], v165 offset:58368
    s_waitcnt lgkmcnt(6)
    v_mfma_f32_32x32x16_bf16 v[96:111], v[48:51], a[52:55], v[96:111]
    ds_read_b64_tr_b16 v[76:77], v166 offset:57344
    ds_read_b64_tr_b16 v[78:79], v167 offset:58368
    v_mfma_f32_32x32x16_bf16 v[112:127], v[52:55], a[52:55], v[112:127]
    ds_read_b64_tr_b16 v[80:81], v160 offset:61440
    ds_read_b64_tr_b16 v[82:83], v161 offset:62464
    v_mfma_f32_32x32x16_bf16 v[128:143], v[56:59], a[52:55], v[128:143]
    ds_read_b64_tr_b16 v[84:85], v162 offset:61440
    ds_read_b64_tr_b16 v[86:87], v163 offset:62464
    v_mfma_f32_32x32x16_bf16 v[144:159], v[60:63], a[52:55], v[144:159]
    ds_read_b64_tr_b16 v[88:89], v164 offset:61440
    ds_read_b64_tr_b16 v[90:91], v165 offset:62464
    s_waitcnt lgkmcnt(6)
    v_mfma_f32_32x32x16_bf16 v[96:111], v[64:67], a[56:59], v[96:111]
    ds_read_b64_tr_b16 v[92:93], v166 offset:61440
    v_mfma_f32_32x32x16_bf16 v[112:127], v[68:71], a[56:59], v[112:127]
    v_mfma_f32_32x32x16_bf16 v[128:143], v[72:75], a[56:59], v[128:143]
    ds_read_b64_tr_b16 v[94:95], v167 offset:62464
    v_mfma_f32_32x32x16_bf16 v[144:159], v[76:79], a[56:59], v[144:159]
    s_waitcnt lgkmcnt(0)
    v_mfma_f32_32x32x16_bf16 v[96:111], v[80:83], a[60:63], v[96:111]
    v_mfma_f32_32x32x16_bf16 v[112:127], v[84:87], a[60:63], v[112:127]
    v_mfma_f32_32x32x16_bf16 v[128:143], v[88:91], a[60:63], v[128:143]
    v_mfma_f32_32x32x16_bf16 v[144:159], v[92:95], a[60:63], v[144:159]
L_gm3_b:
    s_bitcmp1_b32 s82, 4
    s_cbranch_scc0 L_gm4_b
    ds_read_b64_tr_b16 v[32:33], v168 offset:0
    ds_read_b64_tr_b16 v[34:35], v169 offset:1024
    ds_read_b64_tr_b16 v[36:37], v170 offset:0
    ds_read_b64_tr_b16 v[38:39], v171 offset:1024
    ds_read_b64_tr_b16 v[40:41], v172 offset:0
    ds_read_b64_tr_b16 v[42:43], v173 offset:1024
    ds_read_b64_tr_b16 v[44:45], v174 offset:0
    ds_read_b64_tr_b16 v[46:47], v175 offset:1024
    ds_read_b64_tr_b16 v[48:49], v168 offset:4096
    ds_read_b64_tr_b16 v[50:51], v169 offset:5120
    ds_read_b64_tr_b16 v[52:53], v170 offset:4096
    ds_read_b64_tr_b16 v[54:55], v171 offset:5120
    ds_read_b64_tr_b16 v[56:57], v172 offset:4096
    ds_read_b64_tr_b16 v[58:59], v173 offset:5120
    s_waitcnt lgkmcnt(6)
    v_mfma_f32_32x32x16_bf16 v[96:111], v[32:35], a[64:67], v[96:111]
    ds_read_b64_tr_b16 v[60:61], v174 offset:4096
    ds_read_b64_tr_b16 v[62:63], v175 offset:5120
    v_mfma_f32_32x32x16_bf16 v[112:127], v[36:39], a[64:67], v[112:127]
    ds_read_b64_tr_b16 v[64:65], v168 offset:8192
    ds_read_b64_tr_b16 v[66:67], v169 offset:9216
    v_mfma_f32_32x32x16_bf16 v[128:143], v[40:43], a[64:67], v[128:143]
    ds_read_b64_tr_b16 v[68:69], v170 offset:8192
    ds_read_b64_tr_b16 v[70:71], v171 offset:9216
    v_mfma_f32_32x32x16_bf16 v[144:159], v[44:47], a[64:67], v[144:159]
    ds_read_b64_tr_b16 v[72:73], v172 offset:8192
    ds_read_b64_tr_b16 v[74:75], v173 offset:9216
    s_waitcnt lgkmcnt(6)
    v_mfma_f32_32x32x16_bf16 v[96:111], v[48:51], a[68:71], v[96:111]
    ds_read_b64_tr_b16 v[76:77], v174 offset:8192
    ds_read_b64_tr_b16 v[78:79], v175 offset:9216
    v_mfma_f32_32x32x16_bf16 v[112:127], v[52:55], a[68:71], v[112:127]
    ds_read_b64_tr_b16 v[80:81], v168 offset:12288
    ds_read_b64_tr_b16 v[82:83], v169 offset:13312
    v_mfma_f32_32x32x16_bf16 v[128:143], v[56:59], a[68:71], v[128:143]
    ds_read_b64_tr_b16 v[84:85], v170 offset:12288
    ds_read_b64_tr_b16 v[86:87], v171 offset:13312
    v_mfma_f32_32x32x16_bf16 v[144:159], v[60:63], a[68:71], v[144:159]
    ds_read_b64_tr_b16 v[88:89], v172 offset:12288
    ds_read_b64_tr_b16 v[90:91], v173 offset:13312
    s_waitcnt lgkmcnt(6)
    v_mfma_f32_32x32x16_bf16 v[96:111], v[64:67], a[72:75], v[96:111]
    ds_read_b64_tr_b16 v[92:93], v174 offset:12288
    v_mfma_f32_32x32x16_bf16 v[112:127], v[68:71], a[72:75], v[112:127]
    v_mfma_f32_32x32x16_bf16 v[128:143], v[72:75], a[72:75], v[128:143]
    ds_read_b64_tr_b16 v[94:95], v175 offset:13312
    v_mfma_f32_32x32x16_bf16 v[144:159], v[76:79], a[72:75], v[144:159]
    s_waitcnt lgkmcnt(0)
    v_mfma_f32_32x32x16_bf16 v[96:111], v[80:83], a[76:79], v[96:111]
    v_mfma_f32_32x32x16_bf16 v[112:127], v[84:87], a[76:79], v[112:127]
    v_mfma_f32_32x32x16_bf16 v[128:143], v[88:91], a[76:79], v[128:143]
    v_mfma_f32_32x32x16_bf16 v[144:159], v[92:95], a[76:79], v[144:159]
L_gm4_b:
    s_bitcmp1_b32 s82, 5
    s_cbranch_scc0 L_gm5_b
    ds_read_b64_tr_b16 v[32:33], v168 offset:16384
    ds_read_b64_tr_b16 v[34:35], v169 offset:17408
    ds_read_b64_tr_b16 v[36:37], v170 offset:16384
    ds_read_b64_tr_b16 v[38:39], v171 offset:17408
    ds_read_b64_tr_b16 v[40:41], v172 offset:16384
    ds_read_b64_tr_b16 v[42:43], v173 offset:17408
    ds_read_b64_tr_b16 v[44:45], v174 offset:16384
    ds_read_b64_tr_b16 v[46:47], v175 offset:17408
    ds_read_b64_tr_b16 v[48:49], v168 offset:20480
    ds_read_b64_tr_b16 v[50:51], v169 offset:21504
    ds_read_b64_tr_b16 v[52:53], v170 offset:20480
    ds_read_b64_tr_b16 v[54:55], v171 offset:21504
    ds_read_b64_tr_b16 v[56:57], v172 offset:20480
    ds_read_b64_tr_b16 v[58:59], v173 offset:21504
    s_waitcnt lgkmcnt(6)
    v_mfma_f32_32x32x16_bf16 v[96:111], v[32:35], a[80:83], v[96:111]
    ds_read_b64_tr_b16 v[60:61], v174 offset:20480
    ds_read_b64_tr_b16 v[62:63], v175 offset:21504
    v_mfma_f32_32x32x16_bf16 v[112:127], v[36:39], a[80:83], v[112:127]
    ds_read_b64_tr_b16 v[64:65], v168 offset:24576
    ds_read_b64_tr_b16 v[66:67], v169 offset:25600
    v_mfma_f32_32x32x16_bf16 v[128:143], v[40:43], a[80:83], v[128:143]
    ds_read_b64_tr_b16 v[68:69], v170 offset:24576
    ds_read_b64_tr_b16 v[70:71], v171 offset:25600
    v_mfma_f32_32x32x16_bf16 v[144:159], v[44:47], a[80:83], v[144:159]
    ds_read_b64_tr_b16 v[72:73], v172 offset:24576
    ds_read_b64_tr_b16 v[74:75], v173 offset:25600
    s_waitcnt lgkmcnt(6)
    v_mfma_f32_32x32x16_bf16 v[96:111], v[48:51], a[84:87], v[96:111]
    ds_read_b64_tr_b16 v[76:77], v174 offset:24576
    ds_read_b64_tr_b16 v[78:79], v175 offset:25600
    v_mfma_f32_32x32x16_bf16 v[112:127], v[52:55], a[84:87], v[112:127]
    ds_read_b64_tr_b16 v[80:81], v168 offset:28672
    ds_read_b64_tr_b16 v[82:83], v169 offset:29696
    v_mfma_f32_32x32x16_bf16 v[128:143], v[56:59], a[84:87], v[128:143]
    ds_read_b64_tr_b16 v[84:85], v170 offset:28672
    ds_read_b64_tr_b16 v[86:87], v171 offset:29696
    v_mfma_f32_32x32x16_bf16 v[144:159], v[60:63], a[84:87], v[144:159]
    ds_read_b64_tr_b16 v[88:89], v172 offset:28672
    ds_read_b64_tr_b16 v[90:91], v173 offset:29696
    s_waitcnt lgkmcnt(6)
    v_mfma_f32_32x32x16_bf16 v[96:111], v[64:67], a[88:91], v[96:111]
    ds_read_b64_tr_b16 v[92:93], v174 offset:28672
    v_mfma_f32_32x32x16_bf16 v[112:127], v[68:71], a[88:91], v[112:127]
    v_mfma_f32_32x32x16_bf16 v[128:143], v[72:75], a[88:91], v[128:143]
    ds_read_b64_tr_b16 v[94:95], v175 offset:29696
    v_mfma_f32_32x32x16_bf16 v[144:159], v[76:79], a[88:91], v[144:159]
    s_waitcnt lgkmcnt(0)
    v_mfma_f32_32x32x16_bf16 v[96:111], v[80:83], a[92:95], v[96:111]
    v_mfma_f32_32x32x16_bf16 v[112:127], v[84:87], a[92:95], v[112:127]
    v_mfma_f32_32x32x16_bf16 v[128:143], v[88:91], a[92:95], v[128:143]
    v_mfma_f32_32x32x16_bf16 v[144:159], v[92:95], a[92:95], v[144:159]
L_gm5_b:
    s_bitcmp1_b32 s82, 6
    s_cbranch_scc0 L_gm6_b
    ds_read_b64_tr_b16 v[32:33], v176 offset:0
    ds_read_b64_tr_b16 v[34:35], v177 offset:1024
    ds_read_b64_tr_b16 v[36:37], v178 offset:0
    ds_read_b64_tr_b16 v[38:39], v179 offset:1024
    ds_read_b64_tr_b16 v[40:41], v180 offset:0
    ds_read_b64_tr_b16 v[42:43], v181 offset:1024
    ds_read_b64_tr_b16 v[44:45], v182 offset:0
    ds_read_b64_tr_b16 v[46:47], v183 offset:1024
    ds_read_b64_tr_b16 v[48:49], v176 offset:4096
    ds_read_b64_tr_b16 v[50:51], v177 offset:5120
    ds_read_b64_tr_b16 v[52:53], v178 offset:4096
    ds_read_b64_tr_b16 v[54:55], v179 offset:5120
    ds_read_b64_tr_b16 v[56:57], v180 offset:4096
    ds_read_b64_tr_b16 v[58:59], v181 offset:5120
    s_waitcnt lgkmcnt(6)
    v_mfma_f32_32x32x16_bf16 v[96:111], v[32:35], a[96:99], v[96:111]
    ds_read_b64_tr_b16 v[60:61], v182 offset:4096
    ds_read_b64_tr_b16 v[62:63], v183 offset:5120
    v_mfma_f32_32x32x16_bf16 v[112:127], v[36:39], a[96:99], v[112:127]
    ds_read_b64_tr_b16 v[64:65], v176 offset:8192
    ds_read_b64_tr_b16 v[66:67], v177 offset:9216
    v_mfma_f32_32x32x16_bf16 v[128:143], v[40:43], a[96:99], v[128:143]
    ds_read_b64_tr_b16 v[68:69], v178 offset:8192
    ds_read_b64_tr_b16 v[70:71], v179 offset:9216
    v_mfma_f32_32x32x16_bf16 v[144:159], v[44:47], a[96:99], v[144:159]
    ds_read_b64_tr_b16 v[72:73], v180 offset:8192
    ds_read_b64_tr_b16 v[74:75], v181 offset:9216
    s_waitcnt lgkmcnt(6)
    v_mfma_f32_32x32x16_bf16 v[96:111], v[48:51], a[100:103], v[96:111]
    ds_read_b64_tr_b16 v[76:77], v182 offset:8192
    ds_read_b64_tr_b16 v[78:79], v183 offset:9216
    v_mfma_f32_32x32x16_bf16 v[112:127], v[52:55], a[100:103], v[112:127]
    ds_read_b64_tr_b16 v[80:81], v176 offset:12288
    ds_read_b64_tr_b16 v[82:83], v177 offset:13312
    v_mfma_f32_32x32x16_bf16 v[128:143], v[56:59], a[100:103], v[128:143]
    ds_read_b64_tr_b16 v[84:85], v178 offset:12288
    ds_read_b64_tr_b16 v[86:87], v179 offset:13312
    v_mfma_f32_32x32x16_bf16 v[144:159], v[60:63], a[100:103], v[144:159]
    ds_read_b64_tr_b16 v[88:89], v180 offset:12288
    ds_read_b64_tr_b16 v[90:91], v181 offset:13312
    s_waitcnt lgkmcnt(6)
    v_mfma_f32_32x32x16_bf16 v[96:111], v[64:67], a[104:107], v[96:111]
    ds_read_b64_tr_b16 v[92:93], v182 offset:12288
    v_mfma_f32_32x32x16_bf16 v[112:127], v[68:71], a[104:107], v[112:127]
    v_mfma_f32_32x32x16_bf16 v[128:143], v[72:75], a[104:107], v[128:143]
    ds_read_b64_tr_b16 v[94:95], v183 offset:13312
    v_mfma_f32_32x32x16_bf16 v[144:159], v[76:79], a[104:107], v[144:159]
    s_waitcnt lgkmcnt(0)
    v_mfma_f32_32x32x16_bf16 v[96:111], v[80:83], a[108:111], v[96:111]
    v_mfma_f32_32x32x16_bf16 v[112:127], v[84:87], a[108:111], v[112:127]
    v_mfma_f32_32x32x16_bf16 v[128:143], v[88:91], a[108:111], v[128:143]
    v_mfma_f32_32x32x16_bf16 v[144:159], v[92:95], a[108:111], v[144:159]
L_gm6_b:
    s_bitcmp1_b32 s82, 7
    s_cbranch_scc0 L_gm7_b
    ds_read_b64_tr_b16 v[32:33], v176 offset:16384
    ds_read_b64_tr_b16 v[34:35], v177 offset:17408
    ds_read_b64_tr_b16 v[36:37], v178 offset:16384
    ds_read_b64_tr_b16 v[38:39], v179 offset:17408
    ds_read_b64_tr_b16 v[40:41], v180 offset:16384
    ds_read_b64_tr_b16 v[42:43], v181 offset:17408
    ds_read_b64_tr_b16 v[44:45], v182 offset:16384
    ds_read_b64_tr_b16 v[46:47], v183 offset:17408
    ds_read_b64_tr_b16 v[48:49], v176 offset:20480
    ds_read_b64_tr_b16 v[50:51], v177 offset:21504
    ds_read_b64_tr_b16 v[52:53], v178 offset:20480
    ds_read_b64_tr_b16 v[54:55], v179 offset:21504
    ds_read_b64_tr_b16 v[56:57], v180 offset:20480
    ds_read_b64_tr_b16 v[58:59], v181 offset:21504
    s_waitcnt lgkmcnt(6)
    v_mfma_f32_32x32x16_bf16 v[96:111], v[32:35], a[112:115], v[96:111]
    ds_read_b64_tr_b16 v[60:61], v182 offset:20480
    ds_read_b64_tr_b16 v[62:63], v183 offset:21504
    v_mfma_f32_32x32x16_bf16 v[112:127], v[36:39], a[112:115], v[112:127]
    ds_read_b64_tr_b16 v[64:65], v176 offset:24576
    ds_read_b64_tr_b16 v[66:67], v177 offset:25600
    v_mfma_f32_32x32x16_bf16 v[128:143], v[40:43], a[112:115], v[128:143]
    ds_read_b64_tr_b16 v[68:69], v178 offset:24576
    ds_read_b64_tr_b16 v[70:71], v179 offset:25600
    v_mfma_f32_32x32x16_bf16 v[144:159], v[44:47], a[112:115], v[144:159]
    ds_read_b64_tr_b16 v[72:73], v180 offset:24576
    ds_read_b64_tr_b16 v[74:75], v181 offset:25600
    s_waitcnt lgkmcnt(6)
    v_mfma_f32_32x32x16_bf16 v[96:111], v[48:51], a[116:119], v[96:111]
    ds_read_b64_tr_b16 v[76:77], v182 offset:24576
    ds_read_b64_tr_b16 v[78:79], v183 offset:25600
    v_mfma_f32_32x32x16_bf16 v[112:127], v[52:55], a[116:119], v[112:127]
    ds_read_b64_tr_b16 v[80:81], v176 offset:28672
    ds_read_b64_tr_b16 v[82:83], v177 offset:29696
    v_mfma_f32_32x32x16_bf16 v[128:143], v[56:59], a[116:119], v[128:143]
    ds_read_b64_tr_b16 v[84:85], v178 offset:28672
    ds_read_b64_tr_b16 v[86:87], v179 offset:29696
    v_mfma_f32_32x32x16_bf16 v[144:159], v[60:63], a[116:119], v[144:159]
    ds_read_b64_tr_b16 v[88:89], v180 offset:28672
    ds_read_b64_tr_b16 v[90:91], v181 offset:29696
    s_waitcnt lgkmcnt(6)
    v_mfma_f32_32x32x16_bf16 v[96:111], v[64:67], a[120:123], v[96:111]
    ds_read_b64_tr_b16 v[92:93], v182 offset:28672
    v_mfma_f32_32x32x16_bf16 v[112:127], v[68:71], a[120:123], v[112:127]
    v_mfma_f32_32x32x16_bf16 v[128:143], v[72:75], a[120:123], v[128:143]
    ds_read_b64_tr_b16 v[94:95], v183 offset:29696
    v_mfma_f32_32x32x16_bf16 v[144:159], v[76:79], a[120:123], v[144:159]
    s_waitcnt lgkmcnt(0)
    v_mfma_f32_32x32x16_bf16 v[96:111], v[80:83], a[124:127], v[96:111]
    v_mfma_f32_32x32x16_bf16 v[112:127], v[84:87], a[124:127], v[112:127]
    v_mfma_f32_32x32x16_bf16 v[128:143], v[88:91], a[124:127], v[128:143]
    v_mfma_f32_32x32x16_bf16 v[144:159], v[92:95], a[124:127], v[144:159]
L_gm7_b:
    s_andn2_b32 s83, s83, s82
    s_cbranch_scc1 L_gchk_b
    s_branch L_gdone_b
L_gfast_b:
    s_add_u32 s37, s29, 0
    buffer_load_dwordx4 a[0:3], v1, s[20:23], s37 offen offset:0 sc1
    buffer_load_dwordx4 a[4:7], v1, s[20:23], s37 offen offset:1024 sc1
    buffer_load_dwordx4 a[8:11], v1, s[20:23], s37 offen offset:2048 sc1
    buffer_load_dwordx4 a[12:15], v1, s[20:23], s37 offen offset:3072 sc1
    s_add_u32 s37, s29, 8192
    buffer_load_dwordx4 a[16:19], v1, s[20:23], s37 offen offset:0 sc1
    buffer_load_dwordx4 a[20:23], v1, s[20:23], s37 offen offset:1024 sc1
    buffer_load_dwordx4 a[24:27], v1, s[20:23], s37 offen offset:2048 sc1
    buffer_load_dwordx4 a[28:31], v1, s[20:23], s37 offen offset:3072 sc1
    s_add_u32 s37, s29, 16384
    buffer_load_dwordx4 a[32:35], v1, s[20:23], s37 offen offset:0 sc1
    buffer_load_dwordx4 a[36:39], v1, s[20:23], s37 offen offset:1024 sc1
    buffer_load_dwordx4 a[40:43], v1, s[20:23], s37 offen offset:2048 sc1
    buffer_load_dwordx4 a[44:47], v1, s[20:23], s37 offen offset:3072 sc1
    s_add_u32 s37, s29, 24576
    buffer_load_dwordx4 a[48:51], v1, s[20:23], s37 offen offset:0 sc1
    buffer_load_dwordx4 a[52:55], v1, s[20:23], s37 offen offset:1024 sc1
    buffer_load_dwordx4 a[56:59], v1, s[20:23], s37 offen offset:2048 sc1
    buffer_load_dwordx4 a[60:63], v1, s[20:23], s37 offen offset:3072 sc1
    ds_read_b64_tr_b16 v[32:33], v160 offset:0
    ds_read_b64_tr_b16 v[34:35], v161 offset:1024
    ds_read_b64_tr_b16 v[36:37], v162 offset:0
    ds_read_b64_tr_b16 v[38:39], v163 offset:1024
    ds_read_b64_tr_b16 v[40:41], v164 offset:0
    ds_read_b64_tr_b16 v[42:43], v165 offset:1024
    ds_read_b64_tr_b16 v[44:45], v166 offset:0
    ds_read_b64_tr_b16 v[46:47], v167 offset:1024
    ds_read_b64_tr_b16 v[48:49], v160 offset:4096
    ds_read_b64_tr_b16 v[50:51], v161 offset:5120
    ds_read_b64_tr_b16 v[52:53], v162 offset:4096
    ds_read_b64_tr_b16 v[54:55], v163 offset:5120
    ds_read_b64_tr_b16 v[56:57], v164 offset:4096
    ds_read_b64_tr_b16 v[58:59], v165 offset:5120
    s_waitcnt vmcnt(12) lgkmcnt(6)
    v_mfma_f32_32x32x16_bf16 v[96:111], v[32:35], a[0:3], v[96:111]
    ds_read_b64_tr_b16 v[60:61], v166 offset:4096
    ds_read_b64_tr_b16 v[62:63], v167 offset:5120
    ds_read_b64_tr_b16 v[64:65], v160 offset:8192
    v_mfma_f32_32x32x16_bf16 v[112:127], v[36:39], a[0:3], v[112:127]
    ds_read_b64_tr_b16 v[66:67], v161 offset:9216
    s_add_u32 s37, s29, 32768
    buffer_load_dwordx4 a[64:67], v1, s[20:23], s37 offen offset:0 sc1
    v_mfma_f32_32x32x16_bf16 v[128:143], v[40:43], a[0:3], v[128:143]
    buffer_load_dwordx4 a[68:71], v1, s[20:23], s37 offen offset:1024 sc1
    ds_read_b64_tr_b16 v[68:69], v162 offset:8192
    ds_read_b64_tr_b16 v[70:71], v163 offset:9216
    v_mfma_f32_32x32x16_bf16 v[144:159], v[44:47], a[0:3], v[144:159]
    ds_read_b64_tr_b16 v[72:73], v164 offset:8192
    ds_read_b64_tr_b16 v[74:75], v165 offset:9216
    s_waitcnt lgkmcnt(6)
    v_mfma_f32_32x32x16_bf16 v[96:111], v[48:51], a[4:7], v[96:111]
    ds_read_b64_tr_b16 v[76:77], v166 offset:8192
    ds_read_b64_tr_b16 v[78:79], v167 offset:9216
    ds_read_b64_tr_b16 v[80:81], v160 offset:12288
    v_mfma_f32_32x32x16_bf16 v[112:127], v[52:55], a[4:7], v[112:127]
    ds_read_b64_tr_b16 v[82:83], v161 offset:13312
    buffer_load_dwordx4 a[72:75], v1, s[20:23], s37 offen offset:2048 sc1
    buffer_load_dwordx4 a[76:79], v1, s[20:23], s37 offen offset:3072 sc1
    v_mfma_f32_32x32x16_bf16 v[128:143], v[56:59], a[4:7], v[128:143]
    ds_read_b64_tr_b16 v[84:85], v162 offset:12288
    ds_read_b64_tr_b16 v[86:87], v163 offset:13312
    v_mfma_f32_32x32x16_bf16 v[144:159], v[60:63], a[4:7], v[144:159]
    ds_read_b64_tr_b16 v[88:89], v164 offset:12288
    ds_read_b64_tr_b16 v[90:91], v165 offset:13312
    s_waitcnt lgkmcnt(6)
    v_mfma_f32_32x32x16_bf16 v[96:111], v[64:67], a[8:11], v[96:111]
    ds_read_b64_tr_b16 v[92:93], v166 offset:12288
    ds_read_b64_tr_b16 v[94:95], v167 offset:13312
    v_mfma_f32_32x32x16_bf16 v[112:127], v[68:71], a[8:11], v[112:127]
    ds_read_b64_tr_b16 v[32:33], v160 offset:16384
    ds_read_b64_tr_b16 v[34:35], v161 offset:17408
    v_mfma_f32_32x32x16_bf16 v[128:143], v[72:75], a[8:11], v[128:143]
    ds_read_b64_tr_b16 v[36:37], v162 offset:16384
    ds_read_b64_tr_b16 v[38:39], v163 offset:17408
    v_mfma_f32_32x32x16_bf16 v[144:159], v[76:79], a[8:11], v[144:159]
    ds_read_b64_tr_b16 v[40:41], v164 offset:16384
    ds_read_b64_tr_b16 v[42:43], v165 offset:17408
    s_waitcnt lgkmcnt(6)
    v_mfma_f32_32x32x16_bf16 v[96:111], v[80:83], a[12:15], v[96:111]
    ds_read_b64_tr_b16 v[44:45], v166 offset:16384
    ds_read_b64_tr_b16 v[46:47], v167 offset:17408
    v_mfma_f32_32x32x16_bf16 v[112:127], v[84:87], a[12:15], v[112:127]
    ds_read_b64_tr_b16 v[48:49], v160 offset:20480
    ds_read_b64_tr_b16 v[50:51], v161 offset:21504
    v_mfma_f32_32x32x16_bf16 v[128:143], v[88:91], a[12:15], v[128:143]
    ds_read_b64_tr_b16 v[52:53], v162 offset:20480
    ds_read_b64_tr_b16 v[54:55], v163 offset:21504
    v_mfma_f32_32x32x16_bf16 v[144:159], v[92:95], a[12:15], v[144:159]
    ds_read_b64_tr_b16 v[56:57], v164 offset:20480
    ds_read_b64_tr_b16 v[58:59], v165 offset:21504
    s_waitcnt vmcnt(12) lgkmcnt(6)
    v_mfma_f32_32x32x16_bf16 v[96:111], v[32:35], a[16:19], v[96:111]
    ds_read_b64_tr_b16 v[60:61], v166 offset:20480
    ds_read_b64_tr_b16 v[62:63], v167 offset:21504
    ds_read_b64_tr_b16 v[64:65], v160 offset:24576
    v_mfma_f32_32x32x16_bf16 v[112:127], v[36:39], a[16:19], v[112:127]
    ds_read_b64_tr_b16 v[66:67], v161 offset:25600
    s_add_u32 s37, s29, 40960
    buffer_load_dwordx4 a[80:83], v1, s[20:23], s37 offen offset:0 sc1
    v_mfma_f32_32x32x16_bf16 v[128:143], v[40:43], a[16:19], v[128:143]
    buffer_load_dwordx4 a[84:87], v1, s[20:23], s37 offen offset:1024 sc1
    ds_read_b64_tr_b16 v[68:69], v162 offset:24576
    ds_read_b64_tr_b16 v[70:71], v163 offset:25600
    v_mfma_f32_32x32x16_bf16 v[144:159], v[44:47], a[16:19], v[144:159]
    ds_read_b64_tr_b16 v[72:73], v164 offset:24576
    ds_read_b64_tr_b16 v[74:75], v165 offset:25600
    s_waitcnt lgkmcnt(6)
    v_mfma_f32_32x32x16_bf16 v[96:111], v[48:51], a[20:23], v[96:111]
    ds_read_b64_tr_b16 v[76:77], v166 offset:24576
    ds_read_b64_tr_b16 v[78:79], v167 offset:25600
    ds_read_b64_tr_b16 v[80:81], v160 offset:28672
    v_mfma_f32_32x32x16_bf16 v[112:127], v[52:55], a[20:23], v[112:127]
    ds_read_b64_tr_b16 v[82:83], v161 offset:29696
    buffer_load_dwordx4 a[88:91], v1, s[20:23], s37 offen offset:2048 sc1
    buffer_load_dwordx4 a[92:95], v1, s[20:23], s37 offen offset:3072 sc1
    v_mfma_f32_32x32x16_bf16 v[128:143], v[56:59], a[20:23], v[128:143]
    ds_read_b64_tr_b16 v[84:85], v162 offset:28672
    ds_read_b64_tr_b16 v[86:87], v163 offset:29696
    v_mfma_f32_32x32x16_bf16 v[144:159], v[60:63], a[20:23], v[144:159]
    ds_read_b64_tr_b16 v[88:89], v164 offset:28672
    ds_read_b64_tr_b16 v[90:91], v165 offset:29696
    s_waitcnt lgkmcnt(6)
    v_mfma_f32_32x32x16_bf16 v[96:111], v[64:67], a[24:27], v[96:111]
    ds_read_b64_tr_b16 v[92:93], v166 offset:28672
    ds_read_b64_tr_b16 v[94:95], v167 offset:29696
    v_mfma_f32_32x32x16_bf16 v[112:127], v[68:71], a[24:27], v[112:127]
    ds_read_b64_tr_b16 v[32:33], v160 offset:32768
    ds_read_b64_tr_b16 v[34:35], v161 offset:33792
    v_mfma_f32_32x32x16_bf16 v[128:143], v[72:75], a[24:27], v[128:143]
    ds_read_b64_tr_b16 v[36:37], v162 offset:32768
    ds_read_b64_tr_b16 v[38:39], v163 offset:33792
    v_mfma_f32_32x32x16_bf16 v[144:159], v[76:79], a[24:27], v[144:159]
    ds_read_b64_tr_b16 v[40:41], v164 offset:32768
    ds_read_b64_tr_b16 v[42:43], v165 offset:33792
    s_waitcnt lgkmcnt(6)
    v_mfma_f32_32x32x16_bf16 v[96:111], v[80:83], a[28:31], v[96:111]
    ds_read_b64_tr_b16 v[44:45], v166 offset:32768
    ds_read_b64_tr_b16 v[46:47], v167 offset:33792
    v_mfma_f32_32x32x16_bf16 v[112:127], v[84:87], a[28:31], v[112:127]
    ds_read_b64_tr_b16 v[48:49], v160 offset:36864
    ds_read_b64_tr_b16 v[50:51], v161 offset:37888
    v_mfma_f32_32x32x16_bf16 v[128:143], v[88:91], a[28:31], v[128:143]
    ds_read_b64_tr_b16 v[52:53], v162 offset:36864
    ds_read_b64_tr_b16 v[54:55], v163 offset:37888
    v_mfma_f32_32x32x16_bf16 v[144:159], v[92:95], a[28:31], v[144:159]
    ds_read_b64_tr_b16 v[56:57], v164 offset:36864
    ds_read_b64_tr_b16 v[58:59], v165 offset:37888
    s_waitcnt vmcnt(12) lgkmcnt(6)
    v_mfma_f32_32x32x16_bf16 v[96:111], v[32:35], a[32:35], v[96:111]
    ds_read_b64_tr_b16 v[60:61], v166 offset:36864
    ds_read_b64_tr_b16 v[62:63], v167 offset:37888
    ds_read_b64_tr_b16 v[64:65], v160 offset:40960
    v_mfma_f32_32x32x16_bf16 v[112:127], v[36:39], a[32:35], v[112:127]
    ds_read_b64_tr_b16 v[66:67], v161 offset:41984
    s_add_u32 s37, s29, 49152
    buffer_load_dwordx4 a[96:99], v1, s[20:23], s37 offen offset:0 sc1
    v_mfma_f32_32x32x16_bf16 v[128:143], v[40:43], a[32:35], v[128:143]
    buffer_load_dwordx4 a[100:103], v1, s[20:23], s37 offen offset:1024 sc1
    ds_read_b64_tr_b16 v[68:69], v162 offset:40960
    ds_read_b64_tr_b16 v[70:71], v163 offset:41984
    v_mfma_f32_32x32x16_bf16 v[144:159], v[44:47], a[32:35], v[144:159]
    ds_read_b64_tr_b16 v[72:73], v164 offset:40960
    ds_read_b64_tr_b16 v[74:75], v165 offset:41984
    s_waitcnt lgkmcnt(6)
    v_mfma_f32_32x32x16_bf16 v[96:111], v[48:51], a[36:39], v[96:111]
    ds_read_b64_tr_b16 v[76:77], v166 offset:40960
    ds_read_b64_tr_b16 v[78:79], v167 offset:41984
    ds_read_b64_tr_b16 v[80:81], v160 offset:45056
    v_mfma_f32_32x32x16_bf16 v[112:127], v[52:55], a[36:39], v[112:127]
    ds_read_b64_tr_b16 v[82:83], v161 offset:46080
    buffer_load_dwordx4 a[104:107], v1, s[20:23], s37 offen offset:2048 sc1
    buffer_load_dwordx4 a[108:111], v1, s[20:23], s37 offen offset:3072 sc1
    v_mfma_f32_32x32x16_bf16 v[128:143], v[56:59], a[36:39], v[128:143]
    ds_read_b64_tr_b16 v[84:85], v162 offset:45056
    ds_read_b64_tr_b16 v[86:87], v163 offset:46080
    v_mfma_f32_32x32x16_bf16 v[144:159], v[60:63], a[36:39], v[144:159]
    ds_read_b64_tr_b16 v[88:89], v164 offset:45056
    ds_read_b64_tr_b16 v[90:91], v165 offset:46080
    s_waitcnt lgkmcnt(6)
    v_mfma_f32_32x32x16_bf16 v[96:111], v[64:67], a[40:43], v[96:111]
    ds_read_b64_tr_b16 v[92:93], v166 offset:45056
    ds_read_b64_tr_b16 v[94:95], v167 offset:46080
    v_mfma_f32_32x32x16_bf16 v[112:127], v[68:71], a[40:43], v[112:127]
    ds_read_b64_tr_b16 v[32:33], v160 offset:49152
    ds_read_b64_tr_b16 v[34:35], v161 offset:50176
    v_mfma_f32_32x32x16_bf16 v[128:143], v[72:75], a[40:43], v[128:143]
    ds_read_b64_tr_b16 v[36:37], v162 offset:49152
    ds_read_b64_tr_b16 v[38:39], v163 offset:50176
    v_mfma_f32_32x32x16_bf16 v[144:159], v[76:79], a[40:43], v[144:159]
    ds_read_b64_tr_b16 v[40:41], v164 offset:49152
    ds_read_b64_tr_b16 v[42:43], v165 offset:50176
    s_waitcnt lgkmcnt(6)
    v_mfma_f32_32x32x16_bf16 v[96:111], v[80:83], a[44:47], v[96:111]
    ds_read_b64_tr_b16 v[44:45], v166 offset:49152
    ds_read_b64_tr_b16 v[46:47], v167 offset:50176
    v_mfma_f32_32x32x16_bf16 v[112:127], v[84:87], a[44:47], v[112:127]
    ds_read_b64_tr_b16 v[48:49], v160 offset:53248
    ds_read_b64_tr_b16 v[50:51], v161 offset:54272
    v_mfma_f32_32x32x16_bf16 v[128:143], v[88:91], a[44:47], v[128:143]
    ds_read_b64_tr_b16 v[52:53], v162 offset:53248
    ds_read_b64_tr_b16 v[54:55], v163 offset:54272
    v_mfma_f32_32x32x16_bf16 v[144:159], v[92:95], a[44:47], v[144:159]
    ds_read_b64_tr_b16 v[56:57], v164 offset:53248
    ds_read_b64_tr_b16 v[58:59], v165 offset:54272
    s_waitcnt vmcnt(12) lgkmcnt(6)
    v_mfma_f32_32x32x16_bf16 v[96:111], v[32:35], a[48:51], v[96:111]
    ds_read_b64_tr_b16 v[60:61], v166 offset:53248
    ds_read_b64_tr_b16 v[62:63], v167 offset:54272
    ds_read_b64_tr_b16 v[64:65], v160 offset:57344
    v_mfma_f32_32x32x16_bf16 v[112:127], v[36:39], a[48:51], v[112:127]
    ds_read_b64_tr_b16 v[66:67], v161 offset:58368
    s_add_u32 s37, s29, 57344
    buffer_load_dwordx4 a[112:115], v1, s[20:23], s37 offen offset:0 sc1
    v_mfma_f32_32x32x16_bf16 v[128:143], v[40:43], a[48:51], v[128:143]
    buffer_load_dwordx4 a[116:119], v1, s[20:23], s37 offen offset:1024 sc1
    ds_read_b64_tr_b16 v[68:69], v162 offset:57344
    ds_read_b64_tr_b16 v[70:71], v163 offset:58368
    v_mfma_f32_32x32x16_bf16 v[144:159], v[44:47], a[48:51], v[144:159]
    ds_read_b64_tr_b16 v[72:73], v164 offset:57344
    ds_read_b64_tr_b16 v[74:75], v165 offset:58368
    s_waitcnt lgkmcnt(6)
    v_mfma_f32_32x32x16_bf16 v[96:111], v[48:51], a[52:55], v[96:111]
    ds_read_b64_tr_b16 v[76:77], v166 offset:57344
    ds_read_b64_tr_b16 v[78:79], v167 offset:58368
    ds_read_b64_tr_b16 v[80:81], v160 offset:61440
    v_mfma_f32_32x32x16_bf16 v[112:127], v[52:55], a[52:55], v[112:127]
    ds_read_b64_tr_b16 v[82:83], v161 offset:62464
    buffer_load_dwordx4 a[120:123], v1, s[20:23], s37 offen offset:2048 sc1
    buffer_load_dwordx4 a[124:127], v1, s[20:23], s37 offen offset:3072 sc1
    v_mfma_f32_32x32x16_bf16 v[128:143], v[56:59], a[52:55], v[128:143]
    ds_read_b64_tr_b16 v[84:85], v162 offset:61440
    ds_read_b64_tr_b16 v[86:87], v163 offset:62464
    v_mfma_f32_32x32x16_bf16 v[144:159], v[60:63], a[52:55], v[144:159]
    ds_read_b64_tr_b16 v[88:89], v164 offset:61440
    ds_read_b64_tr_b16 v[90:91], v165 offset:62464
    s_waitcnt lgkmcnt(6)
    v_mfma_f32_32x32x16_bf16 v[96:111], v[64:67], a[56:59], v[96:111]
    ds_read_b64_tr_b16 v[92:93], v166 offset:61440
    ds_read_b64_tr_b16 v[94:95], v167 offset:62464
    v_mfma_f32_32x32x16_bf16 v[112:127], v[68:71], a[56:59], v[112:127]
    ds_read_b64_tr_b16 v[32:33], v168 offset:0
    ds_read_b64_tr_b16 v[34:35], v169 offset:1024
    v_mfma_f32_32x32x16_bf16 v[128:143], v[72:75], a[56:59], v[128:143]
    ds_read_b64_tr_b16 v[36:37], v170 offset:0
    ds_read_b64_tr_b16 v[38:39], v171 offset:1024
    v_mfma_f32_32x32x16_bf16 v[144:159], v[76:79], a[56:59], v[144:159]
    ds_read_b64_tr_b16 v[40:41], v172 offset:0
    ds_read_b64_tr_b16 v[42:43], v173 offset:1024
    s_waitcnt lgkmcnt(6)
    v_mfma_f32_32x32x16_bf16 v[96:111], v[80:83], a[60:63], v[96:111]
    ds_read_b64_tr_b16 v[44:45], v174 offset:0
    ds_read_b64_tr_b16 v[46:47], v175 offset:1024
    v_mfma_f32_32x32x16_bf16 v[112:127], v[84:87], a[60:63], v[112:127]
    ds_read_b64_tr_b16 v[48:49], v168 offset:4096
    ds_read_b64_tr_b16 v[50:51], v169 offset:5120
    v_mfma_f32_32x32x16_bf16 v[128:143], v[88:91], a[60:63], v[128:143]
    ds_read_b64_tr_b16 v[52:53], v170 offset:4096
    ds_read_b64_tr_b16 v[54:55], v171 offset:5120
    v_mfma_f32_32x32x16_bf16 v[144:159], v[92:95], a[60:63], v[144:159]
    ds_read_b64_tr_b16 v[56:57], v172 offset:4096
    ds_read_b64_tr_b16 v[58:59], v173 offset:5120
    s_waitcnt vmcnt(12) lgkmcnt(6)
    v_mfma_f32_32x32x16_bf16 v[96:111], v[32:35], a[64:67], v[96:111]
    ds_read_b64_tr_b16 v[60:61], v174 offset:4096
    ds_read_b64_tr_b16 v[62:63], v175 offset:5120
    v_mfma_f32_32x32x16_bf16 v[112:127], v[36:39], a[64:67], v[112:127]
    ds_read_b64_tr_b16 v[64:65], v168 offset:8192
    ds_read_b64_tr_b16 v[66:67], v169 offset:9216
    v_mfma_f32_32x32x16_bf16 v[128:143], v[40:43], a[64:67], v[128:143]
    ds_read_b64_tr_b16 v[68:69], v170 offset:8192
    ds_read_b64_tr_b16 v[70:71], v171 offset:9216
    v_mfma_f32_32x32x16_bf16 v[144:159], v[44:47], a[64:67], v[144:159]
    ds_read_b64_tr_b16 v[72:73], v172 offset:8192
    ds_read_b64_tr_b16 v[74:75], v173 offset:9216
    s_waitcnt lgkmcnt(6)
    v_mfma_f32_32x32x16_bf16 v[96:111], v[48:51], a[68:71], v[96:111]
    ds_read_b64_tr_b16 v[76:77], v174 offset:8192
    ds_read_b64_tr_b16 v[78:79], v175 offset:9216
    v_mfma_f32_32x32x16_bf16 v[112:127], v[52:55], a[68:71], v[112:127]
    ds_read_b64_tr_b16 v[80:81], v168 offset:12288
    ds_read_b64_tr_b16 v[82:83], v169 offset:13312
    v_mfma_f32_32x32x16_bf16 v[128:143], v[56:59], a[68:71], v[128:143]
    ds_read_b64_tr_b16 v[84:85], v170 offset:12288
    ds_read_b64_tr_b16 v[86:87], v171 offset:13312
    v_mfma_f32_32x32x16_bf16 v[144:159], v[60:63], a[68:71], v[144:159]
    ds_read_b64_tr_b16 v[88:89], v172 offset:12288
    ds_read_b64_tr_b16 v[90:91], v173 offset:13312
    s_waitcnt lgkmcnt(6)
    v_mfma_f32_32x32x16_bf16 v[96:111], v[64:67], a[72:75], v[96:111]
    ds_read_b64_tr_b16 v[92:93], v174 offset:12288
    ds_read_b64_tr_b16 v[94:95], v175 offset:13312
    v_mfma_f32_32x32x16_bf16 v[112:127], v[68:71], a[72:75], v[112:127]
    ds_read_b64_tr_b16 v[32:33], v168 offset:16384
    ds_read_b64_tr_b16 v[34:35], v169 offset:17408
    v_mfma_f32_32x32x16_bf16 v[128:143], v[72:75], a[72:75], v[128:143]
    ds_read_b64_tr_b16 v[36:37], v170 offset:16384
    ds_read_b64_tr_b16 v[38:39], v171 offset:17408
    v_mfma_f32_32x32x16_bf16 v[144:159], v[76:79], a[72:75], v[144:159]
    ds_read_b64_tr_b16 v[40:41], v172 offset:16384
    ds_read_b64_tr_b16 v[42:43], v173 offset:17408
    s_waitcnt lgkmcnt(6)
    v_mfma_f32_32x32x16_bf16 v[96:111], v[80:83], a[76:79], v[96:111]
    ds_read_b64_tr_b16 v[44:45], v174 offset:16384
    ds_read_b64_tr_b16 v[46:47], v175 offset:17408
    v_mfma_f32_32x32x16_bf16 v[112:127], v[84:87], a[76:79], v[112:127]
    ds_read_b64_tr_b16 v[48:49], v168 offset:20480
    ds_read_b64_tr_b16 v[50:51], v169 offset:21504
    v_mfma_f32_32x32x16_bf16 v[128:143], v[88:91], a[76:79], v[128:143]
    ds_read_b64_tr_b16 v[52:53], v170 offset:20480
    ds_read_b64_tr_b16 v[54:55], v171 offset:21504
    v_mfma_f32_32x32x16_bf16 v[144:159], v[92:95], a[76:79], v[144:159]
    ds_read_b64_tr_b16 v[56:57], v172 offset:20480
    ds_read_b64_tr_b16 v[58:59], v173 offset:21504
    s_waitcnt vmcnt(8) lgkmcnt(6)
    v_mfma_f32_32x32x16_bf16 v[96:111], v[32:35], a[80:83], v[96:111]
    ds_read_b64_tr_b16 v[60:61], v174 offset:20480
    ds_read_b64_tr_b16 v[62:63], v175 offset:21504
    v_mfma_f32_32x32x16_bf16 v[112:127], v[36:39], a[80:83], v[112:127]
    ds_read_b64_tr_b16 v[64:65], v168 offset:24576
    ds_read_b64_tr_b16 v[66:67], v169 offset:25600
    v_mfma_f32_32x32x16_bf16 v[128:143], v[40:43], a[80:83], v[128:143]
    ds_read_b64_tr_b16 v[68:69], v170 offset:24576
    ds_read_b64_tr_b16 v[70:71], v171 offset:25600
    v_mfma_f32_32x32x16_bf16 v[144:159], v[44:47], a[80:83], v[144:159]
    ds_read_b64_tr_b16 v[72:73], v172 offset:24576
    ds_read_b64_tr_b16 v[74:75], v173 offset:25600
    s_waitcnt lgkmcnt(6)
    v_mfma_f32_32x32x16_bf16 v[96:111], v[48:51], a[84:87], v[96:111]
    ds_read_b64_tr_b16 v[76:77], v174 offset:24576
    ds_read_b64_tr_b16 v[78:79], v175 offset:25600
    v_mfma_f32_32x32x16_bf16 v[112:127], v[52:55], a[84:87], v[112:127]
    ds_read_b64_tr_b16 v[80:81], v168 offset:28672
    ds_read_b64_tr_b16 v[82:83], v169 offset:29696
    v_mfma_f32_32x32x16_bf16 v[128:143], v[56:59], a[84:87], v[128:143]
    ds_read_b64_tr_b16 v[84:85], v170 offset:28672
    ds_read_b64_tr_b16 v[86:87], v171 offset:29696
    v_mfma_f32_32x32x16_bf16 v[144:159], v[60:63], a[84:87], v[144:159]
    ds_read_b64_tr_b16 v[88:89], v172 offset:28672
    ds_read_b64_tr_b16 v[90:91], v173 offset:29696
    s_waitcnt lgkmcnt(6)
    v_mfma_f32_32x32x16_bf16 v[96:111], v[64:67], a[88:91], v[96:111]
    ds_read_b64_tr_b16 v[92:93], v174 offset:28672
    ds_read_b64_tr_b16 v[94:95], v175 offset:29696
    v_mfma_f32_32x32x16_bf16 v[112:127], v[68:71], a[88:91], v[112:127]
    ds_read_b64_tr_b16 v[32:33], v176 offset:0
    ds_read_b64_tr_b16 v[34:35], v177 offset:1024
    v_mfma_f32_32x32x16_bf16 v[128:143], v[72:75], a[88:91], v[128:143]
    ds_read_b64_tr_b16 v[36:37], v178 offset:0
    ds_read_b64_tr_b16 v[38:39], v179 offset:1024
    v_mfma_f32_32x32x16_bf16 v[144:159], v[76:79], a[88:91], v[144:159]
    ds_read_b64_tr_b16 v[40:41], v180 offset:0
    ds_read_b64_tr_b16 v[42:43], v181 offset:1024
    s_waitcnt lgkmcnt(6)
    v_mfma_f32_32x32x16_bf16 v[96:111], v[80:83], a[92:95], v[96:111]
    ds_read_b64_tr_b16 v[44:45], v182 offset:0
    ds_read_b64_tr_b16 v[46:47], v183 offset:1024
    v_mfma_f32_32x32x16_bf16 v[112:127], v[84:87], a[92:95], v[112:127]
    ds_read_b64_tr_b16 v[48:49], v176 offset:4096
    ds_read_b64_tr_b16 v[50:51], v177 offset:5120
    v_mfma_f32_32x32x16_bf16 v[128:143], v[88:91], a[92:95], v[128:143]
    ds_read_b64_tr_b16 v[52:53], v178 offset:4096
    ds_read_b64_tr_b16 v[54:55], v179 offset:5120
    v_mfma_f32_32x32x16_bf16 v[144:159], v[92:95], a[92:95], v[144:159]
    ds_read_b64_tr_b16 v[56:57], v180 offset:4096
    ds_read_b64_tr_b16 v[58:59], v181 offset:5120
    s_waitcnt vmcnt(4) lgkmcnt(6)
    v_mfma_f32_32x32x16_bf16 v[96:111], v[32:35], a[96:99], v[96:111]
    ds_read_b64_tr_b16 v[60:61], v182 offset:4096
    ds_read_b64_tr_b16 v[62:63], v183 offset:5120
    v_mfma_f32_32x32x16_bf16 v[112:127], v[36:39], a[96:99], v[112:127]
    ds_read_b64_tr_b16 v[64:65], v176 offset:8192
    ds_read_b64_tr_b16 v[66:67], v177 offset:9216
    v_mfma_f32_32x32x16_bf16 v[128:143], v[40:43], a[96:99], v[128:143]
    ds_read_b64_tr_b16 v[68:69], v178 offset:8192
    ds_read_b64_tr_b16 v[70:71], v179 offset:9216
    v_mfma_f32_32x32x16_bf16 v[144:159], v[44:47], a[96:99], v[144:159]
    ds_read_b64_tr_b16 v[72:73], v180 offset:8192
    ds_read_b64_tr_b16 v[74:75], v181 offset:9216
    s_waitcnt lgkmcnt(6)
    v_mfma_f32_32x32x16_bf16 v[96:111], v[48:51], a[100:103], v[96:111]
    ds_read_b64_tr_b16 v[76:77], v182 offset:8192
    ds_read_b64_tr_b16 v[78:79], v183 offset:9216
    v_mfma_f32_32x32x16_bf16 v[112:127], v[52:55], a[100:103], v[112:127]
    ds_read_b64_tr_b16 v[80:81], v176 offset:12288
    ds_read_b64_tr_b16 v[82:83], v177 offset:13312
    v_mfma_f32_32x32x16_bf16 v[128:143], v[56:59], a[100:103], v[128:143]
    ds_read_b64_tr_b16 v[84:85], v178 offset:12288
    ds_read_b64_tr_b16 v[86:87], v179 offset:13312
    v_mfma_f32_32x32x16_bf16 v[144:159], v[60:63], a[100:103], v[144:159]
    ds_read_b64_tr_b16 v[88:89], v180 offset:12288
    ds_read_b64_tr_b16 v[90:91], v181 offset:13312
    s_waitcnt lgkmcnt(6)
    v_mfma_f32_32x32x16_bf16 v[96:111], v[64:67], a[104:107], v[96:111]
    ds_read_b64_tr_b16 v[92:93], v182 offset:12288
    ds_read_b64_tr_b16 v[94:95], v183 offset:13312
    v_mfma_f32_32x32x16_bf16 v[112:127], v[68:71], a[104:107], v[112:127]
    ds_read_b64_tr_b16 v[32:33], v176 offset:16384
    ds_read_b64_tr_b16 v[34:35], v177 offset:17408
    v_mfma_f32_32x32x16_bf16 v[128:143], v[72:75], a[104:107], v[128:143]
    ds_read_b64_tr_b16 v[36:37], v178 offset:16384
    ds_read_b64_tr_b16 v[38:39], v179 offset:17408
    v_mfma_f32_32x32x16_bf16 v[144:159], v[76:79], a[104:107], v[144:159]
    ds_read_b64_tr_b16 v[40:41], v180 offset:16384
    ds_read_b64_tr_b16 v[42:43], v181 offset:17408
    s_waitcnt lgkmcnt(6)
    v_mfma_f32_32x32x16_bf16 v[96:111], v[80:83], a[108:111], v[96:111]
    ds_read_b64_tr_b16 v[44:45], v182 offset:16384
    ds_read_b64_tr_b16 v[46:47], v183 offset:17408
    v_mfma_f32_32x32x16_bf16 v[112:127], v[84:87], a[108:111], v[112:127]
    ds_read_b64_tr_b16 v[48:49], v176 offset:20480
    ds_read_b64_tr_b16 v[50:51], v177 offset:21504
    v_mfma_f32_32x32x16_bf16 v[128:143], v[88:91], a[108:111], v[128:143]
    ds_read_b64_tr_b16 v[52:53], v178 offset:20480
    ds_read_b64_tr_b16 v[54:55], v179 offset:21504
    v_mfma_f32_32x32x16_bf16 v[144:159], v[92:95], a[108:111], v[144:159]
    ds_read_b64_tr_b16 v[56:57], v180 offset:20480
    ds_read_b64_tr_b16 v[58:59], v181 offset:21504
    s_waitcnt vmcnt(0) lgkmcnt(6)
    v_mfma_f32_32x32x16_bf16 v[96:111], v[32:35], a[112:115], v[96:111]
    ds_read_b64_tr_b16 v[60:61], v182 offset:20480
    ds_read_b64_tr_b16 v[62:63], v183 offset:21504
    v_mfma_f32_32x32x16_bf16 v[112:127], v[36:39], a[112:115], v[112:127]
    ds_read_b64_tr_b16 v[64:65], v176 offset:24576
    ds_read_b64_tr_b16 v[66:67], v177 offset:25600
    v_mfma_f32_32x32x16_bf16 v[128:143], v[40:43], a[112:115], v[128:143]
    ds_read_b64_tr_b16 v[68:69], v178 offset:24576
    ds_read_b64_tr_b16 v[70:71], v179 offset:25600
    v_mfma_f32_32x32x16_bf16 v[144:159], v[44:47], a[112:115], v[144:159]
    ds_read_b64_tr_b16 v[72:73], v180 offset:24576
    ds_read_b64_tr_b16 v[74:75], v181 offset:25600
    s_waitcnt lgkmcnt(6)
    v_mfma_f32_32x32x16_bf16 v[96:111], v[48:51], a[116:119], v[96:111]
    ds_read_b64_tr_b16 v[76:77], v182 offset:24576
    ds_read_b64_tr_b16 v[78:79], v183 offset:25600
    v_mfma_f32_32x32x16_bf16 v[112:127], v[52:55], a[116:119], v[112:127]
    ds_read_b64_tr_b16 v[80:81], v176 offset:28672
    ds_read_b64_tr_b16 v[82:83], v177 offset:29696
    v_mfma_f32_32x32x16_bf16 v[128:143], v[56:59], a[116:119], v[128:143]
    ds_read_b64_tr_b16 v[84:85], v178 offset:28672
    ds_read_b64_tr_b16 v[86:87], v179 offset:29696
    v_mfma_f32_32x32x16_bf16 v[144:159], v[60:63], a[116:119], v[144:159]
    ds_read_b64_tr_b16 v[88:89], v180 offset:28672
    ds_read_b64_tr_b16 v[90:91], v181 offset:29696
    s_waitcnt lgkmcnt(6)
    v_mfma_f32_32x32x16_bf16 v[96:111], v[64:67], a[120:123], v[96:111]
    ds_read_b64_tr_b16 v[92:93], v182 offset:28672
    v_mfma_f32_32x32x16_bf16 v[112:127], v[68:71], a[120:123], v[112:127]
    v_mfma_f32_32x32x16_bf16 v[128:143], v[72:75], a[120:123], v[128:143]
    ds_read_b64_tr_b16 v[94:95], v183 offset:29696
    v_mfma_f32_32x32x16_bf16 v[144:159], v[76:79], a[120:123], v[144:159]
    s_waitcnt lgkmcnt(0)
    v_mfma_f32_32x32x16_bf16 v[96:111], v[80:83], a[124:127], v[96:111]
    v_mfma_f32_32x32x16_bf16 v[112:127], v[84:87], a[124:127], v[112:127]
    v_mfma_f32_32x32x16_bf16 v[128:143], v[88:91], a[124:127], v[128:143]
    v_mfma_f32_32x32x16_bf16 v[144:159], v[92:95], a[124:127], v[144:159]
L_gdone_b:
    s_lshl_b32 s59, s60, 3
    s_add_u32 s59, s59, s3
    s_lshl_b32 s59, s59, 15
    s_lshl_b32 s62, s24, 13
    s_add_u32 s59, s59, s62
    s_add_u32 s59, s59, 8388608
    s_add_u32 s62, s59, 4096
    s_nop 7
    v_cvt_pk_bf16_f32 v192, v96, v97
    v_cvt_pk_bf16_f32 v193, v98, v99
    v_cvt_pk_bf16_f32 v194, v100, v101
    v_cvt_pk_bf16_f32 v195, v102, v103
    buffer_store_dwordx4 v[192:195], v1, s[20:23], s59 offen offset:0 sc1
    v_cvt_pk_bf16_f32 v196, v104, v105
    v_cvt_pk_bf16_f32 v197, v106, v107
    v_cvt_pk_bf16_f32 v198, v108, v109
    v_cvt_pk_bf16_f32 v199, v110, v111
    buffer_store_dwordx4 v[196:199], v1, s[20:23], s59 offen offset:1024 sc1
    v_cvt_pk_bf16_f32 v200, v112, v113
    v_cvt_pk_bf16_f32 v201, v114, v115
    v_cvt_pk_bf16_f32 v202, v116, v117
    v_cvt_pk_bf16_f32 v203, v118, v119
    buffer_store_dwordx4 v[200:203], v1, s[20:23], s59 offen offset:2048 sc1
    v_cvt_pk_bf16_f32 v204, v120, v121
    v_cvt_pk_bf16_f32 v205, v122, v123
    v_cvt_pk_bf16_f32 v206, v124, v125
    v_cvt_pk_bf16_f32 v207, v126, v127
    buffer_store_dwordx4 v[204:207], v1, s[20:23], s59 offen offset:3072 sc1
    v_cvt_pk_bf16_f32 v208, v128, v129
    v_cvt_pk_bf16_f32 v209, v130, v131
    v_cvt_pk_bf16_f32 v210, v132, v133
    v_cvt_pk_bf16_f32 v211, v134, v135
    buffer_store_dwordx4 v[208:211], v1, s[20:23], s62 offen offset:0 sc1
    v_cvt_pk_bf16_f32 v212, v136, v137
    v_cvt_pk_bf16_f32 v213, v138, v139
    v_cvt_pk_bf16_f32 v214, v140, v141
    v_cvt_pk_bf16_f32 v215, v142, v143
    buffer_store_dwordx4 v[212:215], v1, s[20:23], s62 offen offset:1024 sc1
    v_cvt_pk_bf16_f32 v216, v144, v145
    v_cvt_pk_bf16_f32 v217, v146, v147
    v_cvt_pk_bf16_f32 v218, v148, v149
    v_cvt_pk_bf16_f32 v219, v150, v151
    buffer_store_dwordx4 v[216:219], v1, s[20:23], s62 offen offset:2048 sc1
    v_cvt_pk_bf16_f32 v220, v152, v153
    v_cvt_pk_bf16_f32 v221, v154, v155
    v_cvt_pk_bf16_f32 v222, v156, v157
    v_cvt_pk_bf16_f32 v223, v158, v159
    buffer_store_dwordx4 v[220:223], v1, s[20:23], s62 offen offset:3072 sc1
    s_lshl_b32 s63, s60, 2
    s_add_u32 s63, s63, s24
    s_lshl_b32 s63, s63, 3
    s_add_u32 s63, s63, s3
    s_lshl_b32 s63, s63, 3
    s_add_u32 s63, s63, 25174016
    s_waitcnt vmcnt(0)
    v_mov_b32 v246, 0
    s_mov_b64 exec, 1
    buffer_store_dwordx2 v[244:245], v246, s[20:23], s63 offen sc1
    s_mov_b64 exec, -1
L_end1:
    s_endpgm
L_wo0_a:
    s_add_u32 s37, s30, 0
    buffer_load_dwordx4 a[160:163], v252, s[16:19], s37 offen
    buffer_load_dwordx4 a[164:167], v253, s[16:19], s37 offen offset:1024
    s_add_u32 s37, s30, 32768
    buffer_load_dwordx4 a[168:171], v252, s[16:19], s37 offen
    buffer_load_dwordx4 a[172:175], v253, s[16:19], s37 offen offset:1024
    s_add_u32 s37, s30, 65536
    buffer_load_dwordx4 a[176:179], v252, s[16:19], s37 offen
    buffer_load_dwordx4 a[180:183], v253, s[16:19], s37 offen offset:1024
    s_add_u32 s37, s30, 98304
    buffer_load_dwordx4 a[184:187], v252, s[16:19], s37 offen
    buffer_load_dwordx4 a[188:191], v253, s[16:19], s37 offen offset:1024
    s_branch L_woback0_a
L_wo1_a:
    s_add_u32 s37, s30, 131072
    buffer_load_dwordx4 a[192:195], v252, s[16:19], s37 offen
    buffer_load_dwordx4 a[196:199], v253, s[16:19], s37 offen offset:1024
    s_add_u32 s37, s30, 163840
    buffer_load_dwordx4 a[200:203], v252, s[16:19], s37 offen
    buffer_load_dwordx4 a[204:207], v253, s[16:19], s37 offen offset:1024
    s_add_u32 s37, s30, 196608
    buffer_load_dwordx4 a[208:211], v252, s[16:19], s37 offen
    buffer_load_dwordx4 a[212:215], v253, s[16:19], s37 offen offset:1024
    s_add_u32 s37, s30, 229376
    buffer_load_dwordx4 a[216:219], v252, s[16:19], s37 offen
    buffer_load_dwordx4 a[220:223], v253, s[16:19], s37 offen offset:1024
    s_branch L_woback1_a
L_wo2_a:
    s_add_u32 s37, s30, 262144
    buffer_load_dwordx4 a[224:227], v252, s[16:19], s37 offen
    buffer_load_dwordx4 a[228:231], v253, s[16:19], s37 offen offset:1024
    s_add_u32 s37, s30, 294912
    buffer_load_dwordx4 a[232:235], v252, s[16:19], s37 offen
    buffer_load_dwordx4 a[236:239], v253, s[16:19], s37 offen offset:1024
    s_add_u32 s37, s30, 327680
    buffer_load_dwordx4 a[240:243], v252, s[16:19], s37 offen
    buffer_load_dwordx4 a[244:247], v253, s[16:19], s37 offen offset:1024
    s_add_u32 s37, s30, 360448
    buffer_load_dwordx4 a[248:251], v252, s[16:19], s37 offen
    buffer_load_dwordx4 a[252:255], v253, s[16:19], s37 offen offset:1024
    s_branch L_woback0_a
L_wo3_a:
    s_add_u32 s37, s30, 393216
    s_add_u32 m0, s80, 131072
    s_nop 0
    buffer_load_dwordx4 v252, s[16:19], s37 offen lds
    buffer_load_dwordx4 v253, s[16:19], s37 offen offset:1024 lds
    s_add_u32 s37, s30, 425984
    s_add_u32 m0, s80, 139264
    s_nop 0
    buffer_load_dwordx4 v252, s[16:19], s37 offen lds
    buffer_load_dwordx4 v253, s[16:19], s37 offen offset:1024 lds
    s_add_u32 s37, s30, 458752
    s_add_u32 m0, s80, 147456
    s_nop 0
    buffer_load_dwordx4 v252, s[16:19], s37 offen lds
    buffer_load_dwordx4 v253, s[16:19], s37 offen offset:1024 lds
    s_add_u32 s37, s30, 491520
    s_add_u32 m0, s80, 155648
    s_nop 0
    buffer_load_dwordx4 v252, s[16:19], s37 offen lds
    buffer_load_dwordx4 v253, s[16:19], s37 offen offset:1024 lds
    s_branch L_woback1_a
L_slow_a00:
    v_mov_b32 v18, v17
    v_mov_b32 v19, v17
    s_nop 1
    v_permlane32_swap_b32 v18, v19
    s_nop 1
    v_max_f32 v18, v18, v19
    s_cmp_eq_u32 s27, 0
    s_cbranch_scc1 L_slow2_a00
    v_max_f32 v18, 0, v18
    v_sub_f32 v19, 0, v18
    v_exp_f32 v19, v19
    s_nop 7
    s_nop 7
    v_accvgpr_read_b32 v20, a0
    v_accvgpr_read_b32 v21, a1
    v_accvgpr_read_b32 v22, a2
    v_accvgpr_read_b32 v23, a3
    v_mul_f32 v20, v20, v19
    v_mul_f32 v21, v21, v19
    v_mul_f32 v22, v22, v19
    v_mul_f32 v23, v23, v19
    v_accvgpr_write_b32 a0, v20
    v_accvgpr_write_b32 a1, v21
    v_accvgpr_write_b32 a2, v22
    v_accvgpr_write_b32 a3, v23
    v_accvgpr_read_b32 v20, a4
    v_accvgpr_read_b32 v21, a5
    v_accvgpr_read_b32 v22, a6
    v_accvgpr_read_b32 v23, a7
    v_mul_f32 v20, v20, v19
    v_mul_f32 v21, v21, v19
    v_mul_f32 v22, v22, v19
    v_mul_f32 v23, v23, v19
    v_accvgpr_write_b32 a4, v20
    v_accvgpr_write_b32 a5, v21
    v_accvgpr_write_b32 a6, v22
    v_accvgpr_write_b32 a7, v23
    v_accvgpr_read_b32 v20, a8
    v_accvgpr_read_b32 v21, a9
    v_accvgpr_read_b32 v22, a10
    v_accvgpr_read_b32 v23, a11
    v_mul_f32 v20, v20, v19
    v_mul_f32 v21, v21, v19
    v_mul_f32 v22, v22, v19
    v_mul_f32 v23, v23, v19
    v_accvgpr_write_b32 a8, v20
    v_accvgpr_write_b32 a9, v21
    v_accvgpr_write_b32 a10, v22
    v_accvgpr_write_b32 a11, v23
    v_accvgpr_read_b32 v20, a12
    v_accvgpr_read_b32 v21, a13
    v_accvgpr_read_b32 v22, a14
    v_accvgpr_read_b32 v23, a15
    v_mul_f32 v20, v20, v19
    v_mul_f32 v21, v21, v19
    v_mul_f32 v22, v22, v19
    v_mul_f32 v23, v23, v19
    v_accvgpr_write_b32 a12, v20
    v_accvgpr_write_b32 a13, v21
    v_accvgpr_write_b32 a14, v22
    v_accvgpr_write_b32 a15, v23
    v_accvgpr_read_b32 v20, a16
    v_accvgpr_read_b32 v21, a17
    v_accvgpr_read_b32 v22, a18
    v_accvgpr_read_b32 v23, a19
    v_mul_f32 v20, v20, v19
    v_mul_f32 v21, v21, v19
    v_mul_f32 v22, v22, v19
    v_mul_f32 v23, v23, v19
    v_accvgpr_write_b32 a16, v20
    v_accvgpr_write_b32 a17, v21
    v_accvgpr_write_b32 a18, v22
    v_accvgpr_write_b32 a19, v23
    v_accvgpr_read_b32 v20, a20
    v_accvgpr_read_b32 v21, a21
    v_accvgpr_read_b32 v22, a22
    v_accvgpr_read_b32 v23, a23
    v_mul_f32 v20, v20, v19
    v_mul_f32 v21, v21, v19
    v_mul_f32 v22, v22, v19
    v_mul_f32 v23, v23, v19
    v_accvgpr_write_b32 a20, v20
    v_accvgpr_write_b32 a21, v21
    v_accvgpr_write_b32 a22, v22
    v_accvgpr_write_b32 a23, v23
    v_accvgpr_read_b32 v20, a24
    v_accvgpr_read_b32 v21, a25
    v_accvgpr_read_b32 v22, a26
    v_accvgpr_read_b32 v23, a27
    v_mul_f32 v20, v20, v19
    v_mul_f32 v21, v21, v19
    v_mul_f32 v22, v22, v19
    v_mul_f32 v23, v23, v19
    v_accvgpr_write_b32 a24, v20
    v_accvgpr_write_b32 a25, v21
    v_accvgpr_write_b32 a26, v22
    v_accvgpr_write_b32 a27, v23
    v_accvgpr_read_b32 v20, a28
    v_accvgpr_read_b32 v21, a29
    v_accvgpr_read_b32 v22, a30
    v_accvgpr_read_b32 v23, a31
    v_mul_f32 v20, v20, v19
    v_mul_f32 v21, v21, v19
    v_mul_f32 v22, v22, v19
    v_mul_f32 v23, v23, v19
    v_accvgpr_write_b32 a28, v20
    v_accvgpr_write_b32 a29, v21
    v_accvgpr_write_b32 a30, v22
    v_accvgpr_write_b32 a31, v23
    v_accvgpr_read_b32 v20, a32
    v_accvgpr_read_b32 v21, a33
    v_accvgpr_read_b32 v22, a34
    v_accvgpr_read_b32 v23, a35
    v_mul_f32 v20, v20, v19
    v_mul_f32 v21, v21, v19
    v_mul_f32 v22, v22, v19
    v_mul_f32 v23, v23, v19
    v_accvgpr_write_b32 a32, v20
    v_accvgpr_write_b32 a33, v21
    v_accvgpr_write_b32 a34, v22
    v_accvgpr_write_b32 a35, v23
    v_accvgpr_read_b32 v20, a36
    v_accvgpr_read_b32 v21, a37
    v_accvgpr_read_b32 v22, a38
    v_accvgpr_read_b32 v23, a39
    v_mul_f32 v20, v20, v19
    v_mul_f32 v21, v21, v19
    v_mul_f32 v22, v22, v19
    v_mul_f32 v23, v23, v19
    v_accvgpr_write_b32 a36, v20
    v_accvgpr_write_b32 a37, v21
    v_accvgpr_write_b32 a38, v22
    v_accvgpr_write_b32 a39, v23
    v_accvgpr_read_b32 v20, a40
    v_accvgpr_read_b32 v21, a41
    v_accvgpr_read_b32 v22, a42
    v_accvgpr_read_b32 v23, a43
    v_mul_f32 v20, v20, v19
    v_mul_f32 v21, v21, v19
    v_mul_f32 v22, v22, v19
    v_mul_f32 v23, v23, v19
    v_accvgpr_write_b32 a40, v20
    v_accvgpr_write_b32 a41, v21
    v_accvgpr_write_b32 a42, v22
    v_accvgpr_write_b32 a43, v23
    v_accvgpr_read_b32 v20, a44
    v_accvgpr_read_b32 v21, a45
    v_accvgpr_read_b32 v22, a46
    v_accvgpr_read_b32 v23, a47
    v_mul_f32 v20, v20, v19
    v_mul_f32 v21, v21, v19
    v_mul_f32 v22, v22, v19
    v_mul_f32 v23, v23, v19
    v_accvgpr_write_b32 a44, v20
    v_accvgpr_write_b32 a45, v21
    v_accvgpr_write_b32 a46, v22
    v_accvgpr_write_b32 a47, v23
    v_accvgpr_read_b32 v20, a48
    v_accvgpr_read_b32 v21, a49
    v_accvgpr_read_b32 v22, a50
    v_accvgpr_read_b32 v23, a51
    v_mul_f32 v20, v20, v19
    v_mul_f32 v21, v21, v19
    v_mul_f32 v22, v22, v19
    v_mul_f32 v23, v23, v19
    v_accvgpr_write_b32 a48, v20
    v_accvgpr_write_b32 a49, v21
    v_accvgpr_write_b32 a50, v22
    v_accvgpr_write_b32 a51, v23
    v_accvgpr_read_b32 v20, a52
    v_accvgpr_read_b32 v21, a53
    v_accvgpr_read_b32 v22, a54
    v_accvgpr_read_b32 v23, a55
    v_mul_f32 v20, v20, v19
    v_mul_f32 v21, v21, v19
    v_mul_f32 v22, v22, v19
    v_mul_f32 v23, v23, v19
    v_accvgpr_write_b32 a52, v20
    v_accvgpr_write_b32 a53, v21
    v_accvgpr_write_b32 a54, v22
    v_accvgpr_write_b32 a55, v23
    v_accvgpr_read_b32 v20, a56
    v_accvgpr_read_b32 v21, a57
    v_accvgpr_read_b32 v22, a58
    v_accvgpr_read_b32 v23, a59
    v_mul_f32 v20, v20, v19
    v_mul_f32 v21, v21, v19
    v_mul_f32 v22, v22, v19
    v_mul_f32 v23, v23, v19
    v_accvgpr_write_b32 a56, v20
    v_accvgpr_write_b32 a57, v21
    v_accvgpr_write_b32 a58, v22
    v_accvgpr_write_b32 a59, v23
    v_accvgpr_read_b32 v20, a60
    v_accvgpr_read_b32 v21, a61
    v_accvgpr_read_b32 v22, a62
    v_accvgpr_read_b32 v23, a63
    v_mul_f32 v20, v20, v19
    v_mul_f32 v21, v21, v19
    v_mul_f32 v22, v22, v19
    v_mul_f32 v23, v23, v19
    v_accvgpr_write_b32 a60, v20
    v_accvgpr_write_b32 a61, v21
    v_accvgpr_write_b32 a62, v22
    v_accvgpr_write_b32 a63, v23
    v_accvgpr_read_b32 v20, a128
    v_accvgpr_read_b32 v21, a129
    v_accvgpr_read_b32 v22, a130
    v_accvgpr_read_b32 v23, a131
    v_mul_f32 v20, v20, v19
    v_mul_f32 v21, v21, v19
    v_mul_f32 v22, v22, v19
    v_mul_f32 v23, v23, v19
    v_accvgpr_write_b32 a128, v20
    v_accvgpr_write_b32 a129, v21
    v_accvgpr_write_b32 a130, v22
    v_accvgpr_write_b32 a131, v23
L_slow2_a00:
    v_sub_f32 v96, v96, v18
    v_sub_f32 v97, v97, v18
    v_sub_f32 v98, v98, v18
    v_sub_f32 v99, v99, v18
    v_sub_f32 v100, v100, v18
    v_sub_f32 v101, v101, v18
    v_sub_f32 v102, v102, v18
    v_sub_f32 v103, v103, v18
    v_sub_f32 v104, v104, v18
    v_sub_f32 v105, v105, v18
    v_sub_f32 v106, v106, v18
    v_sub_f32 v107, v107, v18
    v_sub_f32 v108, v108, v18
    v_sub_f32 v109, v109, v18
    v_sub_f32 v110, v110, v18
    v_sub_f32 v111, v111, v18
    v_sub_f32 v192, v192, v18
    v_sub_f32 v193, v193, v18
    v_sub_f32 v194, v194, v18
    v_sub_f32 v195, v195, v18
    v_sub_f32 v196, v196, v18
    v_sub_f32 v197, v197, v18
    v_sub_f32 v198, v198, v18
    v_sub_f32 v199, v199, v18
    v_sub_f32 v200, v200, v18
    v_sub_f32 v201, v201, v18
    v_sub_f32 v202, v202, v18
    v_sub_f32 v203, v203, v18
    v_sub_f32 v204, v204, v18
    v_sub_f32 v205, v205, v18
    v_sub_f32 v206, v206, v18
    v_sub_f32 v207, v207, v18
    s_nop 1
    s_branch L_back_a00
L_slow_a01:
    v_mov_b32 v18, v17
    v_mov_b32 v19, v17
    s_nop 1
    v_permlane32_swap_b32 v18, v19
    s_nop 1
    v_max_f32 v18, v18, v19
    s_cmp_eq_u32 s27, 0
    s_cbranch_scc1 L_slow2_a01
    v_max_f32 v18, 0, v18
    v_sub_f32 v19, 0, v18
    v_exp_f32 v19, v19
    s_nop 7
    s_nop 7
    v_accvgpr_read_b32 v20, a64
    v_accvgpr_read_b32 v21, a65
    v_accvgpr_read_b32 v22, a66
    v_accvgpr_read_b32 v23, a67
    v_mul_f32 v20, v20, v19
    v_mul_f32 v21, v21, v19
    v_mul_f32 v22, v22, v19
    v_mul_f32 v23, v23, v19
    v_accvgpr_write_b32 a64, v20
    v_accvgpr_write_b32 a65, v21
    v_accvgpr_write_b32 a66, v22
    v_accvgpr_write_b32 a67, v23
    v_accvgpr_read_b32 v20, a68
    v_accvgpr_read_b32 v21, a69
    v_accvgpr_read_b32 v22, a70
    v_accvgpr_read_b32 v23, a71
    v_mul_f32 v20, v20, v19
    v_mul_f32 v21, v21, v19
    v_mul_f32 v22, v22, v19
    v_mul_f32 v23, v23, v19
    v_accvgpr_write_b32 a68, v20
    v_accvgpr_write_b32 a69, v21
    v_accvgpr_write_b32 a70, v22
    v_accvgpr_write_b32 a71, v23
    v_accvgpr_read_b32 v20, a72
    v_accvgpr_read_b32 v21, a73
    v_accvgpr_read_b32 v22, a74
    v_accvgpr_read_b32 v23, a75
    v_mul_f32 v20, v20, v19
    v_mul_f32 v21, v21, v19
    v_mul_f32 v22, v22, v19
    v_mul_f32 v23, v23, v19
    v_accvgpr_write_b32 a72, v20
    v_accvgpr_write_b32 a73, v21
    v_accvgpr_write_b32 a74, v22
    v_accvgpr_write_b32 a75, v23
    v_accvgpr_read_b32 v20, a76
    v_accvgpr_read_b32 v21, a77
    v_accvgpr_read_b32 v22, a78
    v_accvgpr_read_b32 v23, a79
    v_mul_f32 v20, v20, v19
    v_mul_f32 v21, v21, v19
    v_mul_f32 v22, v22, v19
    v_mul_f32 v23, v23, v19
    v_accvgpr_write_b32 a76, v20
    v_accvgpr_write_b32 a77, v21
    v_accvgpr_write_b32 a78, v22
    v_accvgpr_write_b32 a79, v23
    v_accvgpr_read_b32 v20, a80
    v_accvgpr_read_b32 v21, a81
    v_accvgpr_read_b32 v22, a82
    v_accvgpr_read_b32 v23, a83
    v_mul_f32 v20, v20, v19
    v_mul_f32 v21, v21, v19
    v_mul_f32 v22, v22, v19
    v_mul_f32 v23, v23, v19
    v_accvgpr_write_b32 a80, v20
    v_accvgpr_write_b32 a81, v21
    v_accvgpr_write_b32 a82, v22
    v_accvgpr_write_b32 a83, v23
    v_accvgpr_read_b32 v20, a84
    v_accvgpr_read_b32 v21, a85
    v_accvgpr_read_b32 v22, a86
    v_accvgpr_read_b32 v23, a87
    v_mul_f32 v20, v20, v19
    v_mul_f32 v21, v21, v19
    v_mul_f32 v22, v22, v19
    v_mul_f32 v23, v23, v19
    v_accvgpr_write_b32 a84, v20
    v_accvgpr_write_b32 a85, v21
    v_accvgpr_write_b32 a86, v22
    v_accvgpr_write_b32 a87, v23
    v_accvgpr_read_b32 v20, a88
    v_accvgpr_read_b32 v21, a89
    v_accvgpr_read_b32 v22, a90
    v_accvgpr_read_b32 v23, a91
    v_mul_f32 v20, v20, v19
    v_mul_f32 v21, v21, v19
    v_mul_f32 v22, v22, v19
    v_mul_f32 v23, v23, v19
    v_accvgpr_write_b32 a88, v20
    v_accvgpr_write_b32 a89, v21
    v_accvgpr_write_b32 a90, v22
    v_accvgpr_write_b32 a91, v23
    v_accvgpr_read_b32 v20, a92
    v_accvgpr_read_b32 v21, a93
    v_accvgpr_read_b32 v22, a94
    v_accvgpr_read_b32 v23, a95
    v_mul_f32 v20, v20, v19
    v_mul_f32 v21, v21, v19
    v_mul_f32 v22, v22, v19
    v_mul_f32 v23, v23, v19
    v_accvgpr_write_b32 a92, v20
    v_accvgpr_write_b32 a93, v21
    v_accvgpr_write_b32 a94, v22
    v_accvgpr_write_b32 a95, v23
    v_accvgpr_read_b32 v20, a96
    v_accvgpr_read_b32 v21, a97
    v_accvgpr_read_b32 v22, a98
    v_accvgpr_read_b32 v23, a99
    v_mul_f32 v20, v20, v19
    v_mul_f32 v21, v21, v19
    v_mul_f32 v22, v22, v19
    v_mul_f32 v23, v23, v19
    v_accvgpr_write_b32 a96, v20
    v_accvgpr_write_b32 a97, v21
    v_accvgpr_write_b32 a98, v22
    v_accvgpr_write_b32 a99, v23
    v_accvgpr_read_b32 v20, a100
    v_accvgpr_read_b32 v21, a101
    v_accvgpr_read_b32 v22, a102
    v_accvgpr_read_b32 v23, a103
    v_mul_f32 v20, v20, v19
    v_mul_f32 v21, v21, v19
    v_mul_f32 v22, v22, v19
    v_mul_f32 v23, v23, v19
    v_accvgpr_write_b32 a100, v20
    v_accvgpr_write_b32 a101, v21
    v_accvgpr_write_b32 a102, v22
    v_accvgpr_write_b32 a103, v23
    v_accvgpr_read_b32 v20, a104
    v_accvgpr_read_b32 v21, a105
    v_accvgpr_read_b32 v22, a106
    v_accvgpr_read_b32 v23, a107
    v_mul_f32 v20, v20, v19
    v_mul_f32 v21, v21, v19
    v_mul_f32 v22, v22, v19
    v_mul_f32 v23, v23, v19
    v_accvgpr_write_b32 a104, v20
    v_accvgpr_write_b32 a105, v21
    v_accvgpr_write_b32 a106, v22
    v_accvgpr_write_b32 a107, v23
    v_accvgpr_read_b32 v20, a108
    v_accvgpr_read_b32 v21, a109
    v_accvgpr_read_b32 v22, a110
    v_accvgpr_read_b32 v23, a111
    v_mul_f32 v20, v20, v19
    v_mul_f32 v21, v21, v19
    v_mul_f32 v22, v22, v19
    v_mul_f32 v23, v23, v19
    v_accvgpr_write_b32 a108, v20
    v_accvgpr_write_b32 a109, v21
    v_accvgpr_write_b32 a110, v22
    v_accvgpr_write_b32 a111, v23
    v_accvgpr_read_b32 v20, a112
    v_accvgpr_read_b32 v21, a113
    v_accvgpr_read_b32 v22, a114
    v_accvgpr_read_b32 v23, a115
    v_mul_f32 v20, v20, v19
    v_mul_f32 v21, v21, v19
    v_mul_f32 v22, v22, v19
    v_mul_f32 v23, v23, v19
    v_accvgpr_write_b32 a112, v20
    v_accvgpr_write_b32 a113, v21
    v_accvgpr_write_b32 a114, v22
    v_accvgpr_write_b32 a115, v23
    v_accvgpr_read_b32 v20, a116
    v_accvgpr_read_b32 v21, a117
    v_accvgpr_read_b32 v22, a118
    v_accvgpr_read_b32 v23, a119
    v_mul_f32 v20, v20, v19
    v_mul_f32 v21, v21, v19
    v_mul_f32 v22, v22, v19
    v_mul_f32 v23, v23, v19
    v_accvgpr_write_b32 a116, v20
    v_accvgpr_write_b32 a117, v21
    v_accvgpr_write_b32 a118, v22
    v_accvgpr_write_b32 a119, v23
    v_accvgpr_read_b32 v20, a120
    v_accvgpr_read_b32 v21, a121
    v_accvgpr_read_b32 v22, a122
    v_accvgpr_read_b32 v23, a123
    v_mul_f32 v20, v20, v19
    v_mul_f32 v21, v21, v19
    v_mul_f32 v22, v22, v19
    v_mul_f32 v23, v23, v19
    v_accvgpr_write_b32 a120, v20
    v_accvgpr_write_b32 a121, v21
    v_accvgpr_write_b32 a122, v22
    v_accvgpr_write_b32 a123, v23
    v_accvgpr_read_b32 v20, a124
    v_accvgpr_read_b32 v21, a125
    v_accvgpr_read_b32 v22, a126
    v_accvgpr_read_b32 v23, a127
    v_mul_f32 v20, v20, v19
    v_mul_f32 v21, v21, v19
    v_mul_f32 v22, v22, v19
    v_mul_f32 v23, v23, v19
    v_accvgpr_write_b32 a124, v20
    v_accvgpr_write_b32 a125, v21
    v_accvgpr_write_b32 a126, v22
    v_accvgpr_write_b32 a127, v23
    v_accvgpr_read_b32 v20, a144
    v_accvgpr_read_b32 v21, a145
    v_accvgpr_read_b32 v22, a146
    v_accvgpr_read_b32 v23, a147
    v_mul_f32 v20, v20, v19
    v_mul_f32 v21, v21, v19
    v_mul_f32 v22, v22, v19
    v_mul_f32 v23, v23, v19
    v_accvgpr_write_b32 a144, v20
    v_accvgpr_write_b32 a145, v21
    v_accvgpr_write_b32 a146, v22
    v_accvgpr_write_b32 a147, v23
L_slow2_a01:
    v_sub_f32 v112, v112, v18
    v_sub_f32 v113, v113, v18
    v_sub_f32 v114, v114, v18
    v_sub_f32 v115, v115, v18
    v_sub_f32 v116, v116, v18
    v_sub_f32 v117, v117, v18
    v_sub_f32 v118, v118, v18
    v_sub_f32 v119, v119, v18
    v_sub_f32 v120, v120, v18
    v_sub_f32 v121, v121, v18
    v_sub_f32 v122, v122, v18
    v_sub_f32 v123, v123, v18
    v_sub_f32 v124, v124, v18
    v_sub_f32 v125, v125, v18
    v_sub_f32 v126, v126, v18
    v_sub_f32 v127, v127, v18
    v_sub_f32 v208, v208, v18
    v_sub_f32 v209, v209, v18
    v_sub_f32 v210, v210, v18
    v_sub_f32 v211, v211, v18
    v_sub_f32 v212, v212, v18
    v_sub_f32 v213, v213, v18
    v_sub_f32 v214, v214, v18
    v_sub_f32 v215, v215, v18
    v_sub_f32 v216, v216, v18
    v_sub_f32 v217, v217, v18
    v_sub_f32 v218, v218, v18
    v_sub_f32 v219, v219, v18
    v_sub_f32 v220, v220, v18
    v_sub_f32 v221, v221, v18
    v_sub_f32 v222, v222, v18
    v_sub_f32 v223, v223, v18
    s_nop 1
    s_branch L_back_a01
L_slow_a10:
    v_mov_b32 v18, v17
    v_mov_b32 v19, v17
    s_nop 1
    v_permlane32_swap_b32 v18, v19
    s_nop 1
    v_max_f32 v18, v18, v19
    s_cmp_eq_u32 s27, 0
    s_cbranch_scc1 L_slow2_a10
    v_max_f32 v18, 0, v18
    v_sub_f32 v19, 0, v18
    v_exp_f32 v19, v19
    s_nop 7
    s_nop 7
    v_accvgpr_read_b32 v20, a0
    v_accvgpr_read_b32 v21, a1
    v_accvgpr_read_b32 v22, a2
    v_accvgpr_read_b32 v23, a3
    v_mul_f32 v20, v20, v19
    v_mul_f32 v21, v21, v19
    v_mul_f32 v22, v22, v19
    v_mul_f32 v23, v23, v19
    v_accvgpr_write_b32 a0, v20
    v_accvgpr_write_b32 a1, v21
    v_accvgpr_write_b32 a2, v22
    v_accvgpr_write_b32 a3, v23
    v_accvgpr_read_b32 v20, a4
    v_accvgpr_read_b32 v21, a5
    v_accvgpr_read_b32 v22, a6
    v_accvgpr_read_b32 v23, a7
    v_mul_f32 v20, v20, v19
    v_mul_f32 v21, v21, v19
    v_mul_f32 v22, v22, v19
    v_mul_f32 v23, v23, v19
    v_accvgpr_write_b32 a4, v20
    v_accvgpr_write_b32 a5, v21
    v_accvgpr_write_b32 a6, v22
    v_accvgpr_write_b32 a7, v23
    v_accvgpr_read_b32 v20, a8
    v_accvgpr_read_b32 v21, a9
    v_accvgpr_read_b32 v22, a10
    v_accvgpr_read_b32 v23, a11
    v_mul_f32 v20, v20, v19
    v_mul_f32 v21, v21, v19
    v_mul_f32 v22, v22, v19
    v_mul_f32 v23, v23, v19
    v_accvgpr_write_b32 a8, v20
    v_accvgpr_write_b32 a9, v21
    v_accvgpr_write_b32 a10, v22
    v_accvgpr_write_b32 a11, v23
    v_accvgpr_read_b32 v20, a12
    v_accvgpr_read_b32 v21, a13
    v_accvgpr_read_b32 v22, a14
    v_accvgpr_read_b32 v23, a15
    v_mul_f32 v20, v20, v19
    v_mul_f32 v21, v21, v19
    v_mul_f32 v22, v22, v19
    v_mul_f32 v23, v23, v19
    v_accvgpr_write_b32 a12, v20
    v_accvgpr_write_b32 a13, v21
    v_accvgpr_write_b32 a14, v22
    v_accvgpr_write_b32 a15, v23
    v_accvgpr_read_b32 v20, a16
    v_accvgpr_read_b32 v21, a17
    v_accvgpr_read_b32 v22, a18
    v_accvgpr_read_b32 v23, a19
    v_mul_f32 v20, v20, v19
    v_mul_f32 v21, v21, v19
    v_mul_f32 v22, v22, v19
    v_mul_f32 v23, v23, v19
    v_accvgpr_write_b32 a16, v20
    v_accvgpr_write_b32 a17, v21
    v_accvgpr_write_b32 a18, v22
    v_accvgpr_write_b32 a19, v23
    v_accvgpr_read_b32 v20, a20
    v_accvgpr_read_b32 v21, a21
    v_accvgpr_read_b32 v22, a22
    v_accvgpr_read_b32 v23, a23
    v_mul_f32 v20, v20, v19
    v_mul_f32 v21, v21, v19
    v_mul_f32 v22, v22, v19
    v_mul_f32 v23, v23, v19
    v_accvgpr_write_b32 a20, v20
    v_accvgpr_write_b32 a21, v21
    v_accvgpr_write_b32 a22, v22
    v_accvgpr_write_b32 a23, v23
    v_accvgpr_read_b32 v20, a24
    v_accvgpr_read_b32 v21, a25
    v_accvgpr_read_b32 v22, a26
    v_accvgpr_read_b32 v23, a27
    v_mul_f32 v20, v20, v19
    v_mul_f32 v21, v21, v19
    v_mul_f32 v22, v22, v19
    v_mul_f32 v23, v23, v19
    v_accvgpr_write_b32 a24, v20
    v_accvgpr_write_b32 a25, v21
    v_accvgpr_write_b32 a26, v22
    v_accvgpr_write_b32 a27, v23
    v_accvgpr_read_b32 v20, a28
    v_accvgpr_read_b32 v21, a29
    v_accvgpr_read_b32 v22, a30
    v_accvgpr_read_b32 v23, a31
    v_mul_f32 v20, v20, v19
    v_mul_f32 v21, v21, v19
    v_mul_f32 v22, v22, v19
    v_mul_f32 v23, v23, v19
    v_accvgpr_write_b32 a28, v20
    v_accvgpr_write_b32 a29, v21
    v_accvgpr_write_b32 a30, v22
    v_accvgpr_write_b32 a31, v23
    v_accvgpr_read_b32 v20, a32
    v_accvgpr_read_b32 v21, a33
    v_accvgpr_read_b32 v22, a34
    v_accvgpr_read_b32 v23, a35
    v_mul_f32 v20, v20, v19
    v_mul_f32 v21, v21, v19
    v_mul_f32 v22, v22, v19
    v_mul_f32 v23, v23, v19
    v_accvgpr_write_b32 a32, v20
    v_accvgpr_write_b32 a33, v21
    v_accvgpr_write_b32 a34, v22
    v_accvgpr_write_b32 a35, v23
    v_accvgpr_read_b32 v20, a36
    v_accvgpr_read_b32 v21, a37
    v_accvgpr_read_b32 v22, a38
    v_accvgpr_read_b32 v23, a39
    v_mul_f32 v20, v20, v19
    v_mul_f32 v21, v21, v19
    v_mul_f32 v22, v22, v19
    v_mul_f32 v23, v23, v19
    v_accvgpr_write_b32 a36, v20
    v_accvgpr_write_b32 a37, v21
    v_accvgpr_write_b32 a38, v22
    v_accvgpr_write_b32 a39, v23
    v_accvgpr_read_b32 v20, a40
    v_accvgpr_read_b32 v21, a41
    v_accvgpr_read_b32 v22, a42
    v_accvgpr_read_b32 v23, a43
    v_mul_f32 v20, v20, v19
    v_mul_f32 v21, v21, v19
    v_mul_f32 v22, v22, v19
    v_mul_f32 v23, v23, v19
    v_accvgpr_write_b32 a40, v20
    v_accvgpr_write_b32 a41, v21
    v_accvgpr_write_b32 a42, v22
    v_accvgpr_write_b32 a43, v23
    v_accvgpr_read_b32 v20, a44
    v_accvgpr_read_b32 v21, a45
    v_accvgpr_read_b32 v22, a46
    v_accvgpr_read_b32 v23, a47
    v_mul_f32 v20, v20, v19
    v_mul_f32 v21, v21, v19
    v_mul_f32 v22, v22, v19
    v_mul_f32 v23, v23, v19
    v_accvgpr_write_b32 a44, v20
    v_accvgpr_write_b32 a45, v21
    v_accvgpr_write_b32 a46, v22
    v_accvgpr_write_b32 a47, v23
    v_accvgpr_read_b32 v20, a48
    v_accvgpr_read_b32 v21, a49
    v_accvgpr_read_b32 v22, a50
    v_accvgpr_read_b32 v23, a51
    v_mul_f32 v20, v20, v19
    v_mul_f32 v21, v21, v19
    v_mul_f32 v22, v22, v19
    v_mul_f32 v23, v23, v19
    v_accvgpr_write_b32 a48, v20
    v_accvgpr_write_b32 a49, v21
    v_accvgpr_write_b32 a50, v22
    v_accvgpr_write_b32 a51, v23
    v_accvgpr_read_b32 v20, a52
    v_accvgpr_read_b32 v21, a53
    v_accvgpr_read_b32 v22, a54
    v_accvgpr_read_b32 v23, a55
    v_mul_f32 v20, v20, v19
    v_mul_f32 v21, v21, v19
    v_mul_f32 v22, v22, v19
    v_mul_f32 v23, v23, v19
    v_accvgpr_write_b32 a52, v20
    v_accvgpr_write_b32 a53, v21
    v_accvgpr_write_b32 a54, v22
    v_accvgpr_write_b32 a55, v23
    v_accvgpr_read_b32 v20, a56
    v_accvgpr_read_b32 v21, a57
    v_accvgpr_read_b32 v22, a58
    v_accvgpr_read_b32 v23, a59
    v_mul_f32 v20, v20, v19
    v_mul_f32 v21, v21, v19
    v_mul_f32 v22, v22, v19
    v_mul_f32 v23, v23, v19
    v_accvgpr_write_b32 a56, v20
    v_accvgpr_write_b32 a57, v21
    v_accvgpr_write_b32 a58, v22
    v_accvgpr_write_b32 a59, v23
    v_accvgpr_read_b32 v20, a60
    v_accvgpr_read_b32 v21, a61
    v_accvgpr_read_b32 v22, a62
    v_accvgpr_read_b32 v23, a63
    v_mul_f32 v20, v20, v19
    v_mul_f32 v21, v21, v19
    v_mul_f32 v22, v22, v19
    v_mul_f32 v23, v23, v19
    v_accvgpr_write_b32 a60, v20
    v_accvgpr_write_b32 a61, v21
    v_accvgpr_write_b32 a62, v22
    v_accvgpr_write_b32 a63, v23
    v_accvgpr_read_b32 v20, a128
    v_accvgpr_read_b32 v21, a129
    v_accvgpr_read_b32 v22, a130
    v_accvgpr_read_b32 v23, a131
    v_mul_f32 v20, v20, v19
    v_mul_f32 v21, v21, v19
    v_mul_f32 v22, v22, v19
    v_mul_f32 v23, v23, v19
    v_accvgpr_write_b32 a128, v20
    v_accvgpr_write_b32 a129, v21
    v_accvgpr_write_b32 a130, v22
    v_accvgpr_write_b32 a131, v23
L_slow2_a10:
    v_sub_f32 v96, v96, v18
    v_sub_f32 v97, v97, v18
    v_sub_f32 v98, v98, v18
    v_sub_f32 v99, v99, v18
    v_sub_f32 v100, v100, v18
    v_sub_f32 v101, v101, v18
    v_sub_f32 v102, v102, v18
    v_sub_f32 v103, v103, v18
    v_sub_f32 v104, v104, v18
    v_sub_f32 v105, v105, v18
    v_sub_f32 v106, v106, v18
    v_sub_f32 v107, v107, v18
    v_sub_f32 v108, v108, v18
    v_sub_f32 v109, v109, v18
    v_sub_f32 v110, v110, v18
    v_sub_f32 v111, v111, v18
    v_sub_f32 v192, v192, v18
    v_sub_f32 v193, v193, v18
    v_sub_f32 v194, v194, v18
    v_sub_f32 v195, v195, v18
    v_sub_f32 v196, v196, v18
    v_sub_f32 v197, v197, v18
    v_sub_f32 v198, v198, v18
    v_sub_f32 v199, v199, v18
    v_sub_f32 v200, v200, v18
    v_sub_f32 v201, v201, v18
    v_sub_f32 v202, v202, v18
    v_sub_f32 v203, v203, v18
    v_sub_f32 v204, v204, v18
    v_sub_f32 v205, v205, v18
    v_sub_f32 v206, v206, v18
    v_sub_f32 v207, v207, v18
    s_nop 1
    s_branch L_back_a10
L_slow_a11:
    v_mov_b32 v18, v17
    v_mov_b32 v19, v17
    s_nop 1
    v_permlane32_swap_b32 v18, v19
    s_nop 1
    v_max_f32 v18, v18, v19
    s_cmp_eq_u32 s27, 0
    s_cbranch_scc1 L_slow2_a11
    v_max_f32 v18, 0, v18
    v_sub_f32 v19, 0, v18
    v_exp_f32 v19, v19
    s_nop 7
    s_nop 7
    v_accvgpr_read_b32 v20, a64
    v_accvgpr_read_b32 v21, a65
    v_accvgpr_read_b32 v22, a66
    v_accvgpr_read_b32 v23, a67
    v_mul_f32 v20, v20, v19
    v_mul_f32 v21, v21, v19
    v_mul_f32 v22, v22, v19
    v_mul_f32 v23, v23, v19
    v_accvgpr_write_b32 a64, v20
    v_accvgpr_write_b32 a65, v21
    v_accvgpr_write_b32 a66, v22
    v_accvgpr_write_b32 a67, v23
    v_accvgpr_read_b32 v20, a68
    v_accvgpr_read_b32 v21, a69
    v_accvgpr_read_b32 v22, a70
    v_accvgpr_read_b32 v23, a71
    v_mul_f32 v20, v20, v19
    v_mul_f32 v21, v21, v19
    v_mul_f32 v22, v22, v19
    v_mul_f32 v23, v23, v19
    v_accvgpr_write_b32 a68, v20
    v_accvgpr_write_b32 a69, v21
    v_accvgpr_write_b32 a70, v22
    v_accvgpr_write_b32 a71, v23
    v_accvgpr_read_b32 v20, a72
    v_accvgpr_read_b32 v21, a73
    v_accvgpr_read_b32 v22, a74
    v_accvgpr_read_b32 v23, a75
    v_mul_f32 v20, v20, v19
    v_mul_f32 v21, v21, v19
    v_mul_f32 v22, v22, v19
    v_mul_f32 v23, v23, v19
    v_accvgpr_write_b32 a72, v20
    v_accvgpr_write_b32 a73, v21
    v_accvgpr_write_b32 a74, v22
    v_accvgpr_write_b32 a75, v23
    v_accvgpr_read_b32 v20, a76
    v_accvgpr_read_b32 v21, a77
    v_accvgpr_read_b32 v22, a78
    v_accvgpr_read_b32 v23, a79
    v_mul_f32 v20, v20, v19
    v_mul_f32 v21, v21, v19
    v_mul_f32 v22, v22, v19
    v_mul_f32 v23, v23, v19
    v_accvgpr_write_b32 a76, v20
    v_accvgpr_write_b32 a77, v21
    v_accvgpr_write_b32 a78, v22
    v_accvgpr_write_b32 a79, v23
    v_accvgpr_read_b32 v20, a80
    v_accvgpr_read_b32 v21, a81
    v_accvgpr_read_b32 v22, a82
    v_accvgpr_read_b32 v23, a83
    v_mul_f32 v20, v20, v19
    v_mul_f32 v21, v21, v19
    v_mul_f32 v22, v22, v19
    v_mul_f32 v23, v23, v19
    v_accvgpr_write_b32 a80, v20
    v_accvgpr_write_b32 a81, v21
    v_accvgpr_write_b32 a82, v22
    v_accvgpr_write_b32 a83, v23
    v_accvgpr_read_b32 v20, a84
    v_accvgpr_read_b32 v21, a85
    v_accvgpr_read_b32 v22, a86
    v_accvgpr_read_b32 v23, a87
    v_mul_f32 v20, v20, v19
    v_mul_f32 v21, v21, v19
    v_mul_f32 v22, v22, v19
    v_mul_f32 v23, v23, v19
    v_accvgpr_write_b32 a84, v20
    v_accvgpr_write_b32 a85, v21
    v_accvgpr_write_b32 a86, v22
    v_accvgpr_write_b32 a87, v23
    v_accvgpr_read_b32 v20, a88
    v_accvgpr_read_b32 v21, a89
    v_accvgpr_read_b32 v22, a90
    v_accvgpr_read_b32 v23, a91
    v_mul_f32 v20, v20, v19
    v_mul_f32 v21, v21, v19
    v_mul_f32 v22, v22, v19
    v_mul_f32 v23, v23, v19
    v_accvgpr_write_b32 a88, v20
    v_accvgpr_write_b32 a89, v21
    v_accvgpr_write_b32 a90, v22
    v_accvgpr_write_b32 a91, v23
    v_accvgpr_read_b32 v20, a92
    v_accvgpr_read_b32 v21, a93
    v_accvgpr_read_b32 v22, a94
    v_accvgpr_read_b32 v23, a95
    v_mul_f32 v20, v20, v19
    v_mul_f32 v21, v21, v19
    v_mul_f32 v22, v22, v19
    v_mul_f32 v23, v23, v19
    v_accvgpr_write_b32 a92, v20
    v_accvgpr_write_b32 a93, v21
    v_accvgpr_write_b32 a94, v22
    v_accvgpr_write_b32 a95, v23
    v_accvgpr_read_b32 v20, a96
    v_accvgpr_read_b32 v21, a97
    v_accvgpr_read_b32 v22, a98
    v_accvgpr_read_b32 v23, a99
    v_mul_f32 v20, v20, v19
    v_mul_f32 v21, v21, v19
    v_mul_f32 v22, v22, v19
    v_mul_f32 v23, v23, v19
    v_accvgpr_write_b32 a96, v20
    v_accvgpr_write_b32 a97, v21
    v_accvgpr_write_b32 a98, v22
    v_accvgpr_write_b32 a99, v23
    v_accvgpr_read_b32 v20, a100
    v_accvgpr_read_b32 v21, a101
    v_accvgpr_read_b32 v22, a102
    v_accvgpr_read_b32 v23, a103
    v_mul_f32 v20, v20, v19
    v_mul_f32 v21, v21, v19
    v_mul_f32 v22, v22, v19
    v_mul_f32 v23, v23, v19
    v_accvgpr_write_b32 a100, v20
    v_accvgpr_write_b32 a101, v21
    v_accvgpr_write_b32 a102, v22
    v_accvgpr_write_b32 a103, v23
    v_accvgpr_read_b32 v20, a104
    v_accvgpr_read_b32 v21, a105
    v_accvgpr_read_b32 v22, a106
    v_accvgpr_read_b32 v23, a107
    v_mul_f32 v20, v20, v19
    v_mul_f32 v21, v21, v19
    v_mul_f32 v22, v22, v19
    v_mul_f32 v23, v23, v19
    v_accvgpr_write_b32 a104, v20
    v_accvgpr_write_b32 a105, v21
    v_accvgpr_write_b32 a106, v22
    v_accvgpr_write_b32 a107, v23
    v_accvgpr_read_b32 v20, a108
    v_accvgpr_read_b32 v21, a109
    v_accvgpr_read_b32 v22, a110
    v_accvgpr_read_b32 v23, a111
    v_mul_f32 v20, v20, v19
    v_mul_f32 v21, v21, v19
    v_mul_f32 v22, v22, v19
    v_mul_f32 v23, v23, v19
    v_accvgpr_write_b32 a108, v20
    v_accvgpr_write_b32 a109, v21
    v_accvgpr_write_b32 a110, v22
    v_accvgpr_write_b32 a111, v23
    v_accvgpr_read_b32 v20, a112
    v_accvgpr_read_b32 v21, a113
    v_accvgpr_read_b32 v22, a114
    v_accvgpr_read_b32 v23, a115
    v_mul_f32 v20, v20, v19
    v_mul_f32 v21, v21, v19
    v_mul_f32 v22, v22, v19
    v_mul_f32 v23, v23, v19
    v_accvgpr_write_b32 a112, v20
    v_accvgpr_write_b32 a113, v21
    v_accvgpr_write_b32 a114, v22
    v_accvgpr_write_b32 a115, v23
    v_accvgpr_read_b32 v20, a116
    v_accvgpr_read_b32 v21, a117
    v_accvgpr_read_b32 v22, a118
    v_accvgpr_read_b32 v23, a119
    v_mul_f32 v20, v20, v19
    v_mul_f32 v21, v21, v19
    v_mul_f32 v22, v22, v19
    v_mul_f32 v23, v23, v19
    v_accvgpr_write_b32 a116, v20
    v_accvgpr_write_b32 a117, v21
    v_accvgpr_write_b32 a118, v22
    v_accvgpr_write_b32 a119, v23
    v_accvgpr_read_b32 v20, a120
    v_accvgpr_read_b32 v21, a121
    v_accvgpr_read_b32 v22, a122
    v_accvgpr_read_b32 v23, a123
    v_mul_f32 v20, v20, v19
    v_mul_f32 v21, v21, v19
    v_mul_f32 v22, v22, v19
    v_mul_f32 v23, v23, v19
    v_accvgpr_write_b32 a120, v20
    v_accvgpr_write_b32 a121, v21
    v_accvgpr_write_b32 a122, v22
    v_accvgpr_write_b32 a123, v23
    v_accvgpr_read_b32 v20, a124
    v_accvgpr_read_b32 v21, a125
    v_accvgpr_read_b32 v22, a126
    v_accvgpr_read_b32 v23, a127
    v_mul_f32 v20, v20, v19
    v_mul_f32 v21, v21, v19
    v_mul_f32 v22, v22, v19
    v_mul_f32 v23, v23, v19
    v_accvgpr_write_b32 a124, v20
    v_accvgpr_write_b32 a125, v21
    v_accvgpr_write_b32 a126, v22
    v_accvgpr_write_b32 a127, v23
    v_accvgpr_read_b32 v20, a144
    v_accvgpr_read_b32 v21, a145
    v_accvgpr_read_b32 v22, a146
    v_accvgpr_read_b32 v23, a147
    v_mul_f32 v20, v20, v19
    v_mul_f32 v21, v21, v19
    v_mul_f32 v22, v22, v19
    v_mul_f32 v23, v23, v19
    v_accvgpr_write_b32 a144, v20
    v_accvgpr_write_b32 a145, v21
    v_accvgpr_write_b32 a146, v22
    v_accvgpr_write_b32 a147, v23
L_slow2_a11:
    v_sub_f32 v112, v112, v18
    v_sub_f32 v113, v113, v18
    v_sub_f32 v114, v114, v18
    v_sub_f32 v115, v115, v18
    v_sub_f32 v116, v116, v18
    v_sub_f32 v117, v117, v18
    v_sub_f32 v118, v118, v18
    v_sub_f32 v119, v119, v18
    v_sub_f32 v120, v120, v18
    v_sub_f32 v121, v121, v18
    v_sub_f32 v122, v122, v18
    v_sub_f32 v123, v123, v18
    v_sub_f32 v124, v124, v18
    v_sub_f32 v125, v125, v18
    v_sub_f32 v126, v126, v18
    v_sub_f32 v127, v127, v18
    v_sub_f32 v208, v208, v18
    v_sub_f32 v209, v209, v18
    v_sub_f32 v210, v210, v18
    v_sub_f32 v211, v211, v18
    v_sub_f32 v212, v212, v18
    v_sub_f32 v213, v213, v18
    v_sub_f32 v214, v214, v18
    v_sub_f32 v215, v215, v18
    v_sub_f32 v216, v216, v18
    v_sub_f32 v217, v217, v18
    v_sub_f32 v218, v218, v18
    v_sub_f32 v219, v219, v18
    v_sub_f32 v220, v220, v18
    v_sub_f32 v221, v221, v18
    v_sub_f32 v222, v222, v18
    v_sub_f32 v223, v223, v18
    s_nop 1
    s_branch L_back_a11
L_slow_a20:
    v_mov_b32 v18, v17
    v_mov_b32 v19, v17
    s_nop 1
    v_permlane32_swap_b32 v18, v19
    s_nop 1
    v_max_f32 v18, v18, v19
    s_cmp_eq_u32 s27, 0
    s_cbranch_scc1 L_slow2_a20
    v_max_f32 v18, 0, v18
    v_sub_f32 v19, 0, v18
    v_exp_f32 v19, v19
    s_nop 7
    s_nop 7
    v_accvgpr_read_b32 v20, a0
    v_accvgpr_read_b32 v21, a1
    v_accvgpr_read_b32 v22, a2
    v_accvgpr_read_b32 v23, a3
    v_mul_f32 v20, v20, v19
    v_mul_f32 v21, v21, v19
    v_mul_f32 v22, v22, v19
    v_mul_f32 v23, v23, v19
    v_accvgpr_write_b32 a0, v20
    v_accvgpr_write_b32 a1, v21
    v_accvgpr_write_b32 a2, v22
    v_accvgpr_write_b32 a3, v23
    v_accvgpr_read_b32 v20, a4
    v_accvgpr_read_b32 v21, a5
    v_accvgpr_read_b32 v22, a6
    v_accvgpr_read_b32 v23, a7
    v_mul_f32 v20, v20, v19
    v_mul_f32 v21, v21, v19
    v_mul_f32 v22, v22, v19
    v_mul_f32 v23, v23, v19
    v_accvgpr_write_b32 a4, v20
    v_accvgpr_write_b32 a5, v21
    v_accvgpr_write_b32 a6, v22
    v_accvgpr_write_b32 a7, v23
    v_accvgpr_read_b32 v20, a8
    v_accvgpr_read_b32 v21, a9
    v_accvgpr_read_b32 v22, a10
    v_accvgpr_read_b32 v23, a11
    v_mul_f32 v20, v20, v19
    v_mul_f32 v21, v21, v19
    v_mul_f32 v22, v22, v19
    v_mul_f32 v23, v23, v19
    v_accvgpr_write_b32 a8, v20
    v_accvgpr_write_b32 a9, v21
    v_accvgpr_write_b32 a10, v22
    v_accvgpr_write_b32 a11, v23
    v_accvgpr_read_b32 v20, a12
    v_accvgpr_read_b32 v21, a13
    v_accvgpr_read_b32 v22, a14
    v_accvgpr_read_b32 v23, a15
    v_mul_f32 v20, v20, v19
    v_mul_f32 v21, v21, v19
    v_mul_f32 v22, v22, v19
    v_mul_f32 v23, v23, v19
    v_accvgpr_write_b32 a12, v20
    v_accvgpr_write_b32 a13, v21
    v_accvgpr_write_b32 a14, v22
    v_accvgpr_write_b32 a15, v23
    v_accvgpr_read_b32 v20, a16
    v_accvgpr_read_b32 v21, a17
    v_accvgpr_read_b32 v22, a18
    v_accvgpr_read_b32 v23, a19
    v_mul_f32 v20, v20, v19
    v_mul_f32 v21, v21, v19
    v_mul_f32 v22, v22, v19
    v_mul_f32 v23, v23, v19
    v_accvgpr_write_b32 a16, v20
    v_accvgpr_write_b32 a17, v21
    v_accvgpr_write_b32 a18, v22
    v_accvgpr_write_b32 a19, v23
    v_accvgpr_read_b32 v20, a20
    v_accvgpr_read_b32 v21, a21
    v_accvgpr_read_b32 v22, a22
    v_accvgpr_read_b32 v23, a23
    v_mul_f32 v20, v20, v19
    v_mul_f32 v21, v21, v19
    v_mul_f32 v22, v22, v19
    v_mul_f32 v23, v23, v19
    v_accvgpr_write_b32 a20, v20
    v_accvgpr_write_b32 a21, v21
    v_accvgpr_write_b32 a22, v22
    v_accvgpr_write_b32 a23, v23
    v_accvgpr_read_b32 v20, a24
    v_accvgpr_read_b32 v21, a25
    v_accvgpr_read_b32 v22, a26
    v_accvgpr_read_b32 v23, a27
    v_mul_f32 v20, v20, v19
    v_mul_f32 v21, v21, v19
    v_mul_f32 v22, v22, v19
    v_mul_f32 v23, v23, v19
    v_accvgpr_write_b32 a24, v20
    v_accvgpr_write_b32 a25, v21
    v_accvgpr_write_b32 a26, v22
    v_accvgpr_write_b32 a27, v23
    v_accvgpr_read_b32 v20, a28
    v_accvgpr_read_b32 v21, a29
    v_accvgpr_read_b32 v22, a30
    v_accvgpr_read_b32 v23, a31
    v_mul_f32 v20, v20, v19
    v_mul_f32 v21, v21, v19
    v_mul_f32 v22, v22, v19
    v_mul_f32 v23, v23, v19
    v_accvgpr_write_b32 a28, v20
    v_accvgpr_write_b32 a29, v21
    v_accvgpr_write_b32 a30, v22
    v_accvgpr_write_b32 a31, v23
    v_accvgpr_read_b32 v20, a32
    v_accvgpr_read_b32 v21, a33
    v_accvgpr_read_b32 v22, a34
    v_accvgpr_read_b32 v23, a35
    v_mul_f32 v20, v20, v19
    v_mul_f32 v21, v21, v19
    v_mul_f32 v22, v22, v19
    v_mul_f32 v23, v23, v19
    v_accvgpr_write_b32 a32, v20
    v_accvgpr_write_b32 a33, v21
    v_accvgpr_write_b32 a34, v22
    v_accvgpr_write_b32 a35, v23
    v_accvgpr_read_b32 v20, a36
    v_accvgpr_read_b32 v21, a37
    v_accvgpr_read_b32 v22, a38
    v_accvgpr_read_b32 v23, a39
    v_mul_f32 v20, v20, v19
    v_mul_f32 v21, v21, v19
    v_mul_f32 v22, v22, v19
    v_mul_f32 v23, v23, v19
    v_accvgpr_write_b32 a36, v20
    v_accvgpr_write_b32 a37, v21
    v_accvgpr_write_b32 a38, v22
    v_accvgpr_write_b32 a39, v23
    v_accvgpr_read_b32 v20, a40
    v_accvgpr_read_b32 v21, a41
    v_accvgpr_read_b32 v22, a42
    v_accvgpr_read_b32 v23, a43
    v_mul_f32 v20, v20, v19
    v_mul_f32 v21, v21, v19
    v_mul_f32 v22, v22, v19
    v_mul_f32 v23, v23, v19
    v_accvgpr_write_b32 a40, v20
    v_accvgpr_write_b32 a41, v21
    v_accvgpr_write_b32 a42, v22
    v_accvgpr_write_b32 a43, v23
    v_accvgpr_read_b32 v20, a44
    v_accvgpr_read_b32 v21, a45
    v_accvgpr_read_b32 v22, a46
    v_accvgpr_read_b32 v23, a47
    v_mul_f32 v20, v20, v19
    v_mul_f32 v21, v21, v19
    v_mul_f32 v22, v22, v19
    v_mul_f32 v23, v23, v19
    v_accvgpr_write_b32 a44, v20
    v_accvgpr_write_b32 a45, v21
    v_accvgpr_write_b32 a46, v22
    v_accvgpr_write_b32 a47, v23
    v_accvgpr_read_b32 v20, a48
    v_accvgpr_read_b32 v21, a49
    v_accvgpr_read_b32 v22, a50
    v_accvgpr_read_b32 v23, a51
    v_mul_f32 v20, v20, v19
    v_mul_f32 v21, v21, v19
    v_mul_f32 v22, v22, v19
    v_mul_f32 v23, v23, v19
    v_accvgpr_write_b32 a48, v20
    v_accvgpr_write_b32 a49, v21
    v_accvgpr_write_b32 a50, v22
    v_accvgpr_write_b32 a51, v23
    v_accvgpr_read_b32 v20, a52
    v_accvgpr_read_b32 v21, a53
    v_accvgpr_read_b32 v22, a54
    v_accvgpr_read_b32 v23, a55
    v_mul_f32 v20, v20, v19
    v_mul_f32 v21, v21, v19
    v_mul_f32 v22, v22, v19
    v_mul_f32 v23, v23, v19
    v_accvgpr_write_b32 a52, v20
    v_accvgpr_write_b32 a53, v21
    v_accvgpr_write_b32 a54, v22
    v_accvgpr_write_b32 a55, v23
    v_accvgpr_read_b32 v20, a56
    v_accvgpr_read_b32 v21, a57
    v_accvgpr_read_b32 v22, a58
    v_accvgpr_read_b32 v23, a59
    v_mul_f32 v20, v20, v19
    v_mul_f32 v21, v21, v19
    v_mul_f32 v22, v22, v19
    v_mul_f32 v23, v23, v19
    v_accvgpr_write_b32 a56, v20
    v_accvgpr_write_b32 a57, v21
    v_accvgpr_write_b32 a58, v22
    v_accvgpr_write_b32 a59, v23
    v_accvgpr_read_b32 v20, a60
    v_accvgpr_read_b32 v21, a61
    v_accvgpr_read_b32 v22, a62
    v_accvgpr_read_b32 v23, a63
    v_mul_f32 v20, v20, v19
    v_mul_f32 v21, v21, v19
    v_mul_f32 v22, v22, v19
    v_mul_f32 v23, v23, v19
    v_accvgpr_write_b32 a60, v20
    v_accvgpr_write_b32 a61, v21
    v_accvgpr_write_b32 a62, v22
    v_accvgpr_write_b32 a63, v23
    v_accvgpr_read_b32 v20, a128
    v_accvgpr_read_b32 v21, a129
    v_accvgpr_read_b32 v22, a130
    v_accvgpr_read_b32 v23, a131
    v_mul_f32 v20, v20, v19
    v_mul_f32 v21, v21, v19
    v_mul_f32 v22, v22, v19
    v_mul_f32 v23, v23, v19
    v_accvgpr_write_b32 a128, v20
    v_accvgpr_write_b32 a129, v21
    v_accvgpr_write_b32 a130, v22
    v_accvgpr_write_b32 a131, v23
L_slow2_a20:
    v_sub_f32 v96, v96, v18
    v_sub_f32 v97, v97, v18
    v_sub_f32 v98, v98, v18
    v_sub_f32 v99, v99, v18
    v_sub_f32 v100, v100, v18
    v_sub_f32 v101, v101, v18
    v_sub_f32 v102, v102, v18
    v_sub_f32 v103, v103, v18
    v_sub_f32 v104, v104, v18
    v_sub_f32 v105, v105, v18
    v_sub_f32 v106, v106, v18
    v_sub_f32 v107, v107, v18
    v_sub_f32 v108, v108, v18
    v_sub_f32 v109, v109, v18
    v_sub_f32 v110, v110, v18
    v_sub_f32 v111, v111, v18
    v_sub_f32 v192, v192, v18
    v_sub_f32 v193, v193, v18
    v_sub_f32 v194, v194, v18
    v_sub_f32 v195, v195, v18
    v_sub_f32 v196, v196, v18
    v_sub_f32 v197, v197, v18
    v_sub_f32 v198, v198, v18
    v_sub_f32 v199, v199, v18
    v_sub_f32 v200, v200, v18
    v_sub_f32 v201, v201, v18
    v_sub_f32 v202, v202, v18
    v_sub_f32 v203, v203, v18
    v_sub_f32 v204, v204, v18
    v_sub_f32 v205, v205, v18
    v_sub_f32 v206, v206, v18
    v_sub_f32 v207, v207, v18
    s_nop 1
    s_branch L_back_a20
L_slow_a21:
    v_mov_b32 v18, v17
    v_mov_b32 v19, v17
    s_nop 1
    v_permlane32_swap_b32 v18, v19
    s_nop 1
    v_max_f32 v18, v18, v19
    s_cmp_eq_u32 s27, 0
    s_cbranch_scc1 L_slow2_a21
    v_max_f32 v18, 0, v18
    v_sub_f32 v19, 0, v18
    v_exp_f32 v19, v19
    s_nop 7
    s_nop 7
    v_accvgpr_read_b32 v20, a64
    v_accvgpr_read_b32 v21, a65
    v_accvgpr_read_b32 v22, a66
    v_accvgpr_read_b32 v23, a67
    v_mul_f32 v20, v20, v19
    v_mul_f32 v21, v21, v19
    v_mul_f32 v22, v22, v19
    v_mul_f32 v23, v23, v19
    v_accvgpr_write_b32 a64, v20
    v_accvgpr_write_b32 a65, v21
    v_accvgpr_write_b32 a66, v22
    v_accvgpr_write_b32 a67, v23
    v_accvgpr_read_b32 v20, a68
    v_accvgpr_read_b32 v21, a69
    v_accvgpr_read_b32 v22, a70
    v_accvgpr_read_b32 v23, a71
    v_mul_f32 v20, v20, v19
    v_mul_f32 v21, v21, v19
    v_mul_f32 v22, v22, v19
    v_mul_f32 v23, v23, v19
    v_accvgpr_write_b32 a68, v20
    v_accvgpr_write_b32 a69, v21
    v_accvgpr_write_b32 a70, v22
    v_accvgpr_write_b32 a71, v23
    v_accvgpr_read_b32 v20, a72
    v_accvgpr_read_b32 v21, a73
    v_accvgpr_read_b32 v22, a74
    v_accvgpr_read_b32 v23, a75
    v_mul_f32 v20, v20, v19
    v_mul_f32 v21, v21, v19
    v_mul_f32 v22, v22, v19
    v_mul_f32 v23, v23, v19
    v_accvgpr_write_b32 a72, v20
    v_accvgpr_write_b32 a73, v21
    v_accvgpr_write_b32 a74, v22
    v_accvgpr_write_b32 a75, v23
    v_accvgpr_read_b32 v20, a76
    v_accvgpr_read_b32 v21, a77
    v_accvgpr_read_b32 v22, a78
    v_accvgpr_read_b32 v23, a79
    v_mul_f32 v20, v20, v19
    v_mul_f32 v21, v21, v19
    v_mul_f32 v22, v22, v19
    v_mul_f32 v23, v23, v19
    v_accvgpr_write_b32 a76, v20
    v_accvgpr_write_b32 a77, v21
    v_accvgpr_write_b32 a78, v22
    v_accvgpr_write_b32 a79, v23
    v_accvgpr_read_b32 v20, a80
    v_accvgpr_read_b32 v21, a81
    v_accvgpr_read_b32 v22, a82
    v_accvgpr_read_b32 v23, a83
    v_mul_f32 v20, v20, v19
    v_mul_f32 v21, v21, v19
    v_mul_f32 v22, v22, v19
    v_mul_f32 v23, v23, v19
    v_accvgpr_write_b32 a80, v20
    v_accvgpr_write_b32 a81, v21
    v_accvgpr_write_b32 a82, v22
    v_accvgpr_write_b32 a83, v23
    v_accvgpr_read_b32 v20, a84
    v_accvgpr_read_b32 v21, a85
    v_accvgpr_read_b32 v22, a86
    v_accvgpr_read_b32 v23, a87
    v_mul_f32 v20, v20, v19
    v_mul_f32 v21, v21, v19
    v_mul_f32 v22, v22, v19
    v_mul_f32 v23, v23, v19
    v_accvgpr_write_b32 a84, v20
    v_accvgpr_write_b32 a85, v21
    v_accvgpr_write_b32 a86, v22
    v_accvgpr_write_b32 a87, v23
    v_accvgpr_read_b32 v20, a88
    v_accvgpr_read_b32 v21, a89
    v_accvgpr_read_b32 v22, a90
    v_accvgpr_read_b32 v23, a91
    v_mul_f32 v20, v20, v19
    v_mul_f32 v21, v21, v19
    v_mul_f32 v22, v22, v19
    v_mul_f32 v23, v23, v19
    v_accvgpr_write_b32 a88, v20
    v_accvgpr_write_b32 a89, v21
    v_accvgpr_write_b32 a90, v22
    v_accvgpr_write_b32 a91, v23
    v_accvgpr_read_b32 v20, a92
    v_accvgpr_read_b32 v21, a93
    v_accvgpr_read_b32 v22, a94
    v_accvgpr_read_b32 v23, a95
    v_mul_f32 v20, v20, v19
    v_mul_f32 v21, v21, v19
    v_mul_f32 v22, v22, v19
    v_mul_f32 v23, v23, v19
    v_accvgpr_write_b32 a92, v20
    v_accvgpr_write_b32 a93, v21
    v_accvgpr_write_b32 a94, v22
    v_accvgpr_write_b32 a95, v23
    v_accvgpr_read_b32 v20, a96
    v_accvgpr_read_b32 v21, a97
    v_accvgpr_read_b32 v22, a98
    v_accvgpr_read_b32 v23, a99
    v_mul_f32 v20, v20, v19
    v_mul_f32 v21, v21, v19
    v_mul_f32 v22, v22, v19
    v_mul_f32 v23, v23, v19
    v_accvgpr_write_b32 a96, v20
    v_accvgpr_write_b32 a97, v21
    v_accvgpr_write_b32 a98, v22
    v_accvgpr_write_b32 a99, v23
    v_accvgpr_read_b32 v20, a100
    v_accvgpr_read_b32 v21, a101
    v_accvgpr_read_b32 v22, a102
    v_accvgpr_read_b32 v23, a103
    v_mul_f32 v20, v20, v19
    v_mul_f32 v21, v21, v19
    v_mul_f32 v22, v22, v19
    v_mul_f32 v23, v23, v19
    v_accvgpr_write_b32 a100, v20
    v_accvgpr_write_b32 a101, v21
    v_accvgpr_write_b32 a102, v22
    v_accvgpr_write_b32 a103, v23
    v_accvgpr_read_b32 v20, a104
    v_accvgpr_read_b32 v21, a105
    v_accvgpr_read_b32 v22, a106
    v_accvgpr_read_b32 v23, a107
    v_mul_f32 v20, v20, v19
    v_mul_f32 v21, v21, v19
    v_mul_f32 v22, v22, v19
    v_mul_f32 v23, v23, v19
    v_accvgpr_write_b32 a104, v20
    v_accvgpr_write_b32 a105, v21
    v_accvgpr_write_b32 a106, v22
    v_accvgpr_write_b32 a107, v23
    v_accvgpr_read_b32 v20, a108
    v_accvgpr_read_b32 v21, a109
    v_accvgpr_read_b32 v22, a110
    v_accvgpr_read_b32 v23, a111
    v_mul_f32 v20, v20, v19
    v_mul_f32 v21, v21, v19
    v_mul_f32 v22, v22, v19
    v_mul_f32 v23, v23, v19
    v_accvgpr_write_b32 a108, v20
    v_accvgpr_write_b32 a109, v21
    v_accvgpr_write_b32 a110, v22
    v_accvgpr_write_b32 a111, v23
    v_accvgpr_read_b32 v20, a112
    v_accvgpr_read_b32 v21, a113
    v_accvgpr_read_b32 v22, a114
    v_accvgpr_read_b32 v23, a115
    v_mul_f32 v20, v20, v19
    v_mul_f32 v21, v21, v19
    v_mul_f32 v22, v22, v19
    v_mul_f32 v23, v23, v19
    v_accvgpr_write_b32 a112, v20
    v_accvgpr_write_b32 a113, v21
    v_accvgpr_write_b32 a114, v22
    v_accvgpr_write_b32 a115, v23
    v_accvgpr_read_b32 v20, a116
    v_accvgpr_read_b32 v21, a117
    v_accvgpr_read_b32 v22, a118
    v_accvgpr_read_b32 v23, a119
    v_mul_f32 v20, v20, v19
    v_mul_f32 v21, v21, v19
    v_mul_f32 v22, v22, v19
    v_mul_f32 v23, v23, v19
    v_accvgpr_write_b32 a116, v20
    v_accvgpr_write_b32 a117, v21
    v_accvgpr_write_b32 a118, v22
    v_accvgpr_write_b32 a119, v23
    v_accvgpr_read_b32 v20, a120
    v_accvgpr_read_b32 v21, a121
    v_accvgpr_read_b32 v22, a122
    v_accvgpr_read_b32 v23, a123
    v_mul_f32 v20, v20, v19
    v_mul_f32 v21, v21, v19
    v_mul_f32 v22, v22, v19
    v_mul_f32 v23, v23, v19
    v_accvgpr_write_b32 a120, v20
    v_accvgpr_write_b32 a121, v21
    v_accvgpr_write_b32 a122, v22
    v_accvgpr_write_b32 a123, v23
    v_accvgpr_read_b32 v20, a124
    v_accvgpr_read_b32 v21, a125
    v_accvgpr_read_b32 v22, a126
    v_accvgpr_read_b32 v23, a127
    v_mul_f32 v20, v20, v19
    v_mul_f32 v21, v21, v19
    v_mul_f32 v22, v22, v19
    v_mul_f32 v23, v23, v19
    v_accvgpr_write_b32 a124, v20
    v_accvgpr_write_b32 a125, v21
    v_accvgpr_write_b32 a126, v22
    v_accvgpr_write_b32 a127, v23
    v_accvgpr_read_b32 v20, a144
    v_accvgpr_read_b32 v21, a145
    v_accvgpr_read_b32 v22, a146
    v_accvgpr_read_b32 v23, a147
    v_mul_f32 v20, v20, v19
    v_mul_f32 v21, v21, v19
    v_mul_f32 v22, v22, v19
    v_mul_f32 v23, v23, v19
    v_accvgpr_write_b32 a144, v20
    v_accvgpr_write_b32 a145, v21
    v_accvgpr_write_b32 a146, v22
    v_accvgpr_write_b32 a147, v23
L_slow2_a21:
    v_sub_f32 v112, v112, v18
    v_sub_f32 v113, v113, v18
    v_sub_f32 v114, v114, v18
    v_sub_f32 v115, v115, v18
    v_sub_f32 v116, v116, v18
    v_sub_f32 v117, v117, v18
    v_sub_f32 v118, v118, v18
    v_sub_f32 v119, v119, v18
    v_sub_f32 v120, v120, v18
    v_sub_f32 v121, v121, v18
    v_sub_f32 v122, v122, v18
    v_sub_f32 v123, v123, v18
    v_sub_f32 v124, v124, v18
    v_sub_f32 v125, v125, v18
    v_sub_f32 v126, v126, v18
    v_sub_f32 v127, v127, v18
    v_sub_f32 v208, v208, v18
    v_sub_f32 v209, v209, v18
    v_sub_f32 v210, v210, v18
    v_sub_f32 v211, v211, v18
    v_sub_f32 v212, v212, v18
    v_sub_f32 v213, v213, v18
    v_sub_f32 v214, v214, v18
    v_sub_f32 v215, v215, v18
    v_sub_f32 v216, v216, v18
    v_sub_f32 v217, v217, v18
    v_sub_f32 v218, v218, v18
    v_sub_f32 v219, v219, v18
    v_sub_f32 v220, v220, v18
    v_sub_f32 v221, v221, v18
    v_sub_f32 v222, v222, v18
    v_sub_f32 v223, v223, v18
    s_nop 1
    s_branch L_back_a21
L_slow_a30:
    v_mov_b32 v18, v17
    v_mov_b32 v19, v17
    s_nop 1
    v_permlane32_swap_b32 v18, v19
    s_nop 1
    v_max_f32 v18, v18, v19
    s_cmp_eq_u32 s27, 0
    s_cbranch_scc1 L_slow2_a30
    v_max_f32 v18, 0, v18
    v_sub_f32 v19, 0, v18
    v_exp_f32 v19, v19
    s_nop 7
    s_nop 7
    v_accvgpr_read_b32 v20, a0
    v_accvgpr_read_b32 v21, a1
    v_accvgpr_read_b32 v22, a2
    v_accvgpr_read_b32 v23, a3
    v_mul_f32 v20, v20, v19
    v_mul_f32 v21, v21, v19
    v_mul_f32 v22, v22, v19
    v_mul_f32 v23, v23, v19
    v_accvgpr_write_b32 a0, v20
    v_accvgpr_write_b32 a1, v21
    v_accvgpr_write_b32 a2, v22
    v_accvgpr_write_b32 a3, v23
    v_accvgpr_read_b32 v20, a4
    v_accvgpr_read_b32 v21, a5
    v_accvgpr_read_b32 v22, a6
    v_accvgpr_read_b32 v23, a7
    v_mul_f32 v20, v20, v19
    v_mul_f32 v21, v21, v19
    v_mul_f32 v22, v22, v19
    v_mul_f32 v23, v23, v19
    v_accvgpr_write_b32 a4, v20
    v_accvgpr_write_b32 a5, v21
    v_accvgpr_write_b32 a6, v22
    v_accvgpr_write_b32 a7, v23
    v_accvgpr_read_b32 v20, a8
    v_accvgpr_read_b32 v21, a9
    v_accvgpr_read_b32 v22, a10
    v_accvgpr_read_b32 v23, a11
    v_mul_f32 v20, v20, v19
    v_mul_f32 v21, v21, v19
    v_mul_f32 v22, v22, v19
    v_mul_f32 v23, v23, v19
    v_accvgpr_write_b32 a8, v20
    v_accvgpr_write_b32 a9, v21
    v_accvgpr_write_b32 a10, v22
    v_accvgpr_write_b32 a11, v23
    v_accvgpr_read_b32 v20, a12
    v_accvgpr_read_b32 v21, a13
    v_accvgpr_read_b32 v22, a14
    v_accvgpr_read_b32 v23, a15
    v_mul_f32 v20, v20, v19
    v_mul_f32 v21, v21, v19
    v_mul_f32 v22, v22, v19
    v_mul_f32 v23, v23, v19
    v_accvgpr_write_b32 a12, v20
    v_accvgpr_write_b32 a13, v21
    v_accvgpr_write_b32 a14, v22
    v_accvgpr_write_b32 a15, v23
    v_accvgpr_read_b32 v20, a16
    v_accvgpr_read_b32 v21, a17
    v_accvgpr_read_b32 v22, a18
    v_accvgpr_read_b32 v23, a19
    v_mul_f32 v20, v20, v19
    v_mul_f32 v21, v21, v19
    v_mul_f32 v22, v22, v19
    v_mul_f32 v23, v23, v19
    v_accvgpr_write_b32 a16, v20
    v_accvgpr_write_b32 a17, v21
    v_accvgpr_write_b32 a18, v22
    v_accvgpr_write_b32 a19, v23
    v_accvgpr_read_b32 v20, a20
    v_accvgpr_read_b32 v21, a21
    v_accvgpr_read_b32 v22, a22
    v_accvgpr_read_b32 v23, a23
    v_mul_f32 v20, v20, v19
    v_mul_f32 v21, v21, v19
    v_mul_f32 v22, v22, v19
    v_mul_f32 v23, v23, v19
    v_accvgpr_write_b32 a20, v20
    v_accvgpr_write_b32 a21, v21
    v_accvgpr_write_b32 a22, v22
    v_accvgpr_write_b32 a23, v23
    v_accvgpr_read_b32 v20, a24
    v_accvgpr_read_b32 v21, a25
    v_accvgpr_read_b32 v22, a26
    v_accvgpr_read_b32 v23, a27
    v_mul_f32 v20, v20, v19
    v_mul_f32 v21, v21, v19
    v_mul_f32 v22, v22, v19
    v_mul_f32 v23, v23, v19
    v_accvgpr_write_b32 a24, v20
    v_accvgpr_write_b32 a25, v21
    v_accvgpr_write_b32 a26, v22
    v_accvgpr_write_b32 a27, v23
    v_accvgpr_read_b32 v20, a28
    v_accvgpr_read_b32 v21, a29
    v_accvgpr_read_b32 v22, a30
    v_accvgpr_read_b32 v23, a31
    v_mul_f32 v20, v20, v19
    v_mul_f32 v21, v21, v19
    v_mul_f32 v22, v22, v19
    v_mul_f32 v23, v23, v19
    v_accvgpr_write_b32 a28, v20
    v_accvgpr_write_b32 a29, v21
    v_accvgpr_write_b32 a30, v22
    v_accvgpr_write_b32 a31, v23
    v_accvgpr_read_b32 v20, a32
    v_accvgpr_read_b32 v21, a33
    v_accvgpr_read_b32 v22, a34
    v_accvgpr_read_b32 v23, a35
    v_mul_f32 v20, v20, v19
    v_mul_f32 v21, v21, v19
    v_mul_f32 v22, v22, v19
    v_mul_f32 v23, v23, v19
    v_accvgpr_write_b32 a32, v20
    v_accvgpr_write_b32 a33, v21
    v_accvgpr_write_b32 a34, v22
    v_accvgpr_write_b32 a35, v23
    v_accvgpr_read_b32 v20, a36
    v_accvgpr_read_b32 v21, a37
    v_accvgpr_read_b32 v22, a38
    v_accvgpr_read_b32 v23, a39
    v_mul_f32 v20, v20, v19
    v_mul_f32 v21, v21, v19
    v_mul_f32 v22, v22, v19
    v_mul_f32 v23, v23, v19
    v_accvgpr_write_b32 a36, v20
    v_accvgpr_write_b32 a37, v21
    v_accvgpr_write_b32 a38, v22
    v_accvgpr_write_b32 a39, v23
    v_accvgpr_read_b32 v20, a40
    v_accvgpr_read_b32 v21, a41
    v_accvgpr_read_b32 v22, a42
    v_accvgpr_read_b32 v23, a43
    v_mul_f32 v20, v20, v19
    v_mul_f32 v21, v21, v19
    v_mul_f32 v22, v22, v19
    v_mul_f32 v23, v23, v19
    v_accvgpr_write_b32 a40, v20
    v_accvgpr_write_b32 a41, v21
    v_accvgpr_write_b32 a42, v22
    v_accvgpr_write_b32 a43, v23
    v_accvgpr_read_b32 v20, a44
    v_accvgpr_read_b32 v21, a45
    v_accvgpr_read_b32 v22, a46
    v_accvgpr_read_b32 v23, a47
    v_mul_f32 v20, v20, v19
    v_mul_f32 v21, v21, v19
    v_mul_f32 v22, v22, v19
    v_mul_f32 v23, v23, v19
    v_accvgpr_write_b32 a44, v20
    v_accvgpr_write_b32 a45, v21
    v_accvgpr_write_b32 a46, v22
    v_accvgpr_write_b32 a47, v23
    v_accvgpr_read_b32 v20, a48
    v_accvgpr_read_b32 v21, a49
    v_accvgpr_read_b32 v22, a50
    v_accvgpr_read_b32 v23, a51
    v_mul_f32 v20, v20, v19
    v_mul_f32 v21, v21, v19
    v_mul_f32 v22, v22, v19
    v_mul_f32 v23, v23, v19
    v_accvgpr_write_b32 a48, v20
    v_accvgpr_write_b32 a49, v21
    v_accvgpr_write_b32 a50, v22
    v_accvgpr_write_b32 a51, v23
    v_accvgpr_read_b32 v20, a52
    v_accvgpr_read_b32 v21, a53
    v_accvgpr_read_b32 v22, a54
    v_accvgpr_read_b32 v23, a55
    v_mul_f32 v20, v20, v19
    v_mul_f32 v21, v21, v19
    v_mul_f32 v22, v22, v19
    v_mul_f32 v23, v23, v19
    v_accvgpr_write_b32 a52, v20
    v_accvgpr_write_b32 a53, v21
    v_accvgpr_write_b32 a54, v22
    v_accvgpr_write_b32 a55, v23
    v_accvgpr_read_b32 v20, a56
    v_accvgpr_read_b32 v21, a57
    v_accvgpr_read_b32 v22, a58
    v_accvgpr_read_b32 v23, a59
    v_mul_f32 v20, v20, v19
    v_mul_f32 v21, v21, v19
    v_mul_f32 v22, v22, v19
    v_mul_f32 v23, v23, v19
    v_accvgpr_write_b32 a56, v20
    v_accvgpr_write_b32 a57, v21
    v_accvgpr_write_b32 a58, v22
    v_accvgpr_write_b32 a59, v23
    v_accvgpr_read_b32 v20, a60
    v_accvgpr_read_b32 v21, a61
    v_accvgpr_read_b32 v22, a62
    v_accvgpr_read_b32 v23, a63
    v_mul_f32 v20, v20, v19
    v_mul_f32 v21, v21, v19
    v_mul_f32 v22, v22, v19
    v_mul_f32 v23, v23, v19
    v_accvgpr_write_b32 a60, v20
    v_accvgpr_write_b32 a61, v21
    v_accvgpr_write_b32 a62, v22
    v_accvgpr_write_b32 a63, v23
    v_accvgpr_read_b32 v20, a128
    v_accvgpr_read_b32 v21, a129
    v_accvgpr_read_b32 v22, a130
    v_accvgpr_read_b32 v23, a131
    v_mul_f32 v20, v20, v19
    v_mul_f32 v21, v21, v19
    v_mul_f32 v22, v22, v19
    v_mul_f32 v23, v23, v19
    v_accvgpr_write_b32 a128, v20
    v_accvgpr_write_b32 a129, v21
    v_accvgpr_write_b32 a130, v22
    v_accvgpr_write_b32 a131, v23
L_slow2_a30:
    v_sub_f32 v96, v96, v18
    v_sub_f32 v97, v97, v18
    v_sub_f32 v98, v98, v18
    v_sub_f32 v99, v99, v18
    v_sub_f32 v100, v100, v18
    v_sub_f32 v101, v101, v18
    v_sub_f32 v102, v102, v18
    v_sub_f32 v103, v103, v18
    v_sub_f32 v104, v104, v18
    v_sub_f32 v105, v105, v18
    v_sub_f32 v106, v106, v18
    v_sub_f32 v107, v107, v18
    v_sub_f32 v108, v108, v18
    v_sub_f32 v109, v109, v18
    v_sub_f32 v110, v110, v18
    v_sub_f32 v111, v111, v18
    v_sub_f32 v192, v192, v18
    v_sub_f32 v193, v193, v18
    v_sub_f32 v194, v194, v18
    v_sub_f32 v195, v195, v18
    v_sub_f32 v196, v196, v18
    v_sub_f32 v197, v197, v18
    v_sub_f32 v198, v198, v18
    v_sub_f32 v199, v199, v18
    v_sub_f32 v200, v200, v18
    v_sub_f32 v201, v201, v18
    v_sub_f32 v202, v202, v18
    v_sub_f32 v203, v203, v18
    v_sub_f32 v204, v204, v18
    v_sub_f32 v205, v205, v18
    v_sub_f32 v206, v206, v18
    v_sub_f32 v207, v207, v18
    s_nop 1
    s_branch L_back_a30
L_slow_a31:
    v_mov_b32 v18, v17
    v_mov_b32 v19, v17
    s_nop 1
    v_permlane32_swap_b32 v18, v19
    s_nop 1
    v_max_f32 v18, v18, v19
    s_cmp_eq_u32 s27, 0
    s_cbranch_scc1 L_slow2_a31
    v_max_f32 v18, 0, v18
    v_sub_f32 v19, 0, v18
    v_exp_f32 v19, v19
    s_nop 7
    s_nop 7
    v_accvgpr_read_b32 v20, a64
    v_accvgpr_read_b32 v21, a65
    v_accvgpr_read_b32 v22, a66
    v_accvgpr_read_b32 v23, a67
    v_mul_f32 v20, v20, v19
    v_mul_f32 v21, v21, v19
    v_mul_f32 v22, v22, v19
    v_mul_f32 v23, v23, v19
    v_accvgpr_write_b32 a64, v20
    v_accvgpr_write_b32 a65, v21
    v_accvgpr_write_b32 a66, v22
    v_accvgpr_write_b32 a67, v23
    v_accvgpr_read_b32 v20, a68
    v_accvgpr_read_b32 v21, a69
    v_accvgpr_read_b32 v22, a70
    v_accvgpr_read_b32 v23, a71
    v_mul_f32 v20, v20, v19
    v_mul_f32 v21, v21, v19
    v_mul_f32 v22, v22, v19
    v_mul_f32 v23, v23, v19
    v_accvgpr_write_b32 a68, v20
    v_accvgpr_write_b32 a69, v21
    v_accvgpr_write_b32 a70, v22
    v_accvgpr_write_b32 a71, v23
    v_accvgpr_read_b32 v20, a72
    v_accvgpr_read_b32 v21, a73
    v_accvgpr_read_b32 v22, a74
    v_accvgpr_read_b32 v23, a75
    v_mul_f32 v20, v20, v19
    v_mul_f32 v21, v21, v19
    v_mul_f32 v22, v22, v19
    v_mul_f32 v23, v23, v19
    v_accvgpr_write_b32 a72, v20
    v_accvgpr_write_b32 a73, v21
    v_accvgpr_write_b32 a74, v22
    v_accvgpr_write_b32 a75, v23
    v_accvgpr_read_b32 v20, a76
    v_accvgpr_read_b32 v21, a77
    v_accvgpr_read_b32 v22, a78
    v_accvgpr_read_b32 v23, a79
    v_mul_f32 v20, v20, v19
    v_mul_f32 v21, v21, v19
    v_mul_f32 v22, v22, v19
    v_mul_f32 v23, v23, v19
    v_accvgpr_write_b32 a76, v20
    v_accvgpr_write_b32 a77, v21
    v_accvgpr_write_b32 a78, v22
    v_accvgpr_write_b32 a79, v23
    v_accvgpr_read_b32 v20, a80
    v_accvgpr_read_b32 v21, a81
    v_accvgpr_read_b32 v22, a82
    v_accvgpr_read_b32 v23, a83
    v_mul_f32 v20, v20, v19
    v_mul_f32 v21, v21, v19
    v_mul_f32 v22, v22, v19
    v_mul_f32 v23, v23, v19
    v_accvgpr_write_b32 a80, v20
    v_accvgpr_write_b32 a81, v21
    v_accvgpr_write_b32 a82, v22
    v_accvgpr_write_b32 a83, v23
    v_accvgpr_read_b32 v20, a84
    v_accvgpr_read_b32 v21, a85
    v_accvgpr_read_b32 v22, a86
    v_accvgpr_read_b32 v23, a87
    v_mul_f32 v20, v20, v19
    v_mul_f32 v21, v21, v19
    v_mul_f32 v22, v22, v19
    v_mul_f32 v23, v23, v19
    v_accvgpr_write_b32 a84, v20
    v_accvgpr_write_b32 a85, v21
    v_accvgpr_write_b32 a86, v22
    v_accvgpr_write_b32 a87, v23
    v_accvgpr_read_b32 v20, a88
    v_accvgpr_read_b32 v21, a89
    v_accvgpr_read_b32 v22, a90
    v_accvgpr_read_b32 v23, a91
    v_mul_f32 v20, v20, v19
    v_mul_f32 v21, v21, v19
    v_mul_f32 v22, v22, v19
    v_mul_f32 v23, v23, v19
    v_accvgpr_write_b32 a88, v20
    v_accvgpr_write_b32 a89, v21
    v_accvgpr_write_b32 a90, v22
    v_accvgpr_write_b32 a91, v23
    v_accvgpr_read_b32 v20, a92
    v_accvgpr_read_b32 v21, a93
    v_accvgpr_read_b32 v22, a94
    v_accvgpr_read_b32 v23, a95
    v_mul_f32 v20, v20, v19
    v_mul_f32 v21, v21, v19
    v_mul_f32 v22, v22, v19
    v_mul_f32 v23, v23, v19
    v_accvgpr_write_b32 a92, v20
    v_accvgpr_write_b32 a93, v21
    v_accvgpr_write_b32 a94, v22
    v_accvgpr_write_b32 a95, v23
    v_accvgpr_read_b32 v20, a96
    v_accvgpr_read_b32 v21, a97
    v_accvgpr_read_b32 v22, a98
    v_accvgpr_read_b32 v23, a99
    v_mul_f32 v20, v20, v19
    v_mul_f32 v21, v21, v19
    v_mul_f32 v22, v22, v19
    v_mul_f32 v23, v23, v19
    v_accvgpr_write_b32 a96, v20
    v_accvgpr_write_b32 a97, v21
    v_accvgpr_write_b32 a98, v22
    v_accvgpr_write_b32 a99, v23
    v_accvgpr_read_b32 v20, a100
    v_accvgpr_read_b32 v21, a101
    v_accvgpr_read_b32 v22, a102
    v_accvgpr_read_b32 v23, a103
    v_mul_f32 v20, v20, v19
    v_mul_f32 v21, v21, v19
    v_mul_f32 v22, v22, v19
    v_mul_f32 v23, v23, v19
    v_accvgpr_write_b32 a100, v20
    v_accvgpr_write_b32 a101, v21
    v_accvgpr_write_b32 a102, v22
    v_accvgpr_write_b32 a103, v23
    v_accvgpr_read_b32 v20, a104
    v_accvgpr_read_b32 v21, a105
    v_accvgpr_read_b32 v22, a106
    v_accvgpr_read_b32 v23, a107
    v_mul_f32 v20, v20, v19
    v_mul_f32 v21, v21, v19
    v_mul_f32 v22, v22, v19
    v_mul_f32 v23, v23, v19
    v_accvgpr_write_b32 a104, v20
    v_accvgpr_write_b32 a105, v21
    v_accvgpr_write_b32 a106, v22
    v_accvgpr_write_b32 a107, v23
    v_accvgpr_read_b32 v20, a108
    v_accvgpr_read_b32 v21, a109
    v_accvgpr_read_b32 v22, a110
    v_accvgpr_read_b32 v23, a111
    v_mul_f32 v20, v20, v19
    v_mul_f32 v21, v21, v19
    v_mul_f32 v22, v22, v19
    v_mul_f32 v23, v23, v19
    v_accvgpr_write_b32 a108, v20
    v_accvgpr_write_b32 a109, v21
    v_accvgpr_write_b32 a110, v22
    v_accvgpr_write_b32 a111, v23
    v_accvgpr_read_b32 v20, a112
    v_accvgpr_read_b32 v21, a113
    v_accvgpr_read_b32 v22, a114
    v_accvgpr_read_b32 v23, a115
    v_mul_f32 v20, v20, v19
    v_mul_f32 v21, v21, v19
    v_mul_f32 v22, v22, v19
    v_mul_f32 v23, v23, v19
    v_accvgpr_write_b32 a112, v20
    v_accvgpr_write_b32 a113, v21
    v_accvgpr_write_b32 a114, v22
    v_accvgpr_write_b32 a115, v23
    v_accvgpr_read_b32 v20, a116
    v_accvgpr_read_b32 v21, a117
    v_accvgpr_read_b32 v22, a118
    v_accvgpr_read_b32 v23, a119
    v_mul_f32 v20, v20, v19
    v_mul_f32 v21, v21, v19
    v_mul_f32 v22, v22, v19
    v_mul_f32 v23, v23, v19
    v_accvgpr_write_b32 a116, v20
    v_accvgpr_write_b32 a117, v21
    v_accvgpr_write_b32 a118, v22
    v_accvgpr_write_b32 a119, v23
    v_accvgpr_read_b32 v20, a120
    v_accvgpr_read_b32 v21, a121
    v_accvgpr_read_b32 v22, a122
    v_accvgpr_read_b32 v23, a123
    v_mul_f32 v20, v20, v19
    v_mul_f32 v21, v21, v19
    v_mul_f32 v22, v22, v19
    v_mul_f32 v23, v23, v19
    v_accvgpr_write_b32 a120, v20
    v_accvgpr_write_b32 a121, v21
    v_accvgpr_write_b32 a122, v22
    v_accvgpr_write_b32 a123, v23
    v_accvgpr_read_b32 v20, a124
    v_accvgpr_read_b32 v21, a125
    v_accvgpr_read_b32 v22, a126
    v_accvgpr_read_b32 v23, a127
    v_mul_f32 v20, v20, v19
    v_mul_f32 v21, v21, v19
    v_mul_f32 v22, v22, v19
    v_mul_f32 v23, v23, v19
    v_accvgpr_write_b32 a124, v20
    v_accvgpr_write_b32 a125, v21
    v_accvgpr_write_b32 a126, v22
    v_accvgpr_write_b32 a127, v23
    v_accvgpr_read_b32 v20, a144
    v_accvgpr_read_b32 v21, a145
    v_accvgpr_read_b32 v22, a146
    v_accvgpr_read_b32 v23, a147
    v_mul_f32 v20, v20, v19
    v_mul_f32 v21, v21, v19
    v_mul_f32 v22, v22, v19
    v_mul_f32 v23, v23, v19
    v_accvgpr_write_b32 a144, v20
    v_accvgpr_write_b32 a145, v21
    v_accvgpr_write_b32 a146, v22
    v_accvgpr_write_b32 a147, v23
L_slow2_a31:
    v_sub_f32 v112, v112, v18
    v_sub_f32 v113, v113, v18
    v_sub_f32 v114, v114, v18
    v_sub_f32 v115, v115, v18
    v_sub_f32 v116, v116, v18
    v_sub_f32 v117, v117, v18
    v_sub_f32 v118, v118, v18
    v_sub_f32 v119, v119, v18
    v_sub_f32 v120, v120, v18
    v_sub_f32 v121, v121, v18
    v_sub_f32 v122, v122, v18
    v_sub_f32 v123, v123, v18
    v_sub_f32 v124, v124, v18
    v_sub_f32 v125, v125, v18
    v_sub_f32 v126, v126, v18
    v_sub_f32 v127, v127, v18
    v_sub_f32 v208, v208, v18
    v_sub_f32 v209, v209, v18
    v_sub_f32 v210, v210, v18
    v_sub_f32 v211, v211, v18
    v_sub_f32 v212, v212, v18
    v_sub_f32 v213, v213, v18
    v_sub_f32 v214, v214, v18
    v_sub_f32 v215, v215, v18
    v_sub_f32 v216, v216, v18
    v_sub_f32 v217, v217, v18
    v_sub_f32 v218, v218, v18
    v_sub_f32 v219, v219, v18
    v_sub_f32 v220, v220, v18
    v_sub_f32 v221, v221, v18
    v_sub_f32 v222, v222, v18
    v_sub_f32 v223, v223, v18
    s_nop 1
    s_branch L_back_a31
.section .rodata,"a"
.p2align 6
.amdhsa_kernel concat_heads__gqa_block_cached__mha_block_cached__near_ridge_kernel
  .amdhsa_next_free_vgpr 512
  .amdhsa_next_free_sgpr 102
  .amdhsa_accum_offset 256
  .amdhsa_group_segment_fixed_size 0
  .amdhsa_kernarg_size 104
  .amdhsa_user_sgpr_count 2
  .amdhsa_user_sgpr_kernarg_segment_ptr 1
  .amdhsa_system_sgpr_workgroup_id_x 1
.end_amdhsa_kernel
```
